```python
import torch

def _softmax(x, axis=-1):
    return torch.softmax(x, dim=axis)
def _gelu(x):
    return torch.nn.functional.gelu(x, approximate="tanh")
def _silu(x):
    return torch.nn.functional.silu(x)
def _sigmoid(x):
    return torch.sigmoid(x)
def _layernorm(x, axis=-1, eps=1e-5):
    m = x.mean(dim=axis, keepdim=True)
    v = x.var(dim=axis, keepdim=True, unbiased=False)
    return (x - m) / torch.sqrt(v + eps)
def _scatter_add(tgt, idx, src, axis=0):
    return tgt.clone().index_add_(axis, idx, src)
def _segment_sum(src, seg, n):
    out = torch.zeros((n,) + src.shape[1:], dtype=src.dtype)
    return out.index_add_(0, seg, src)
def _pad(x, pw):
    flat = tuple(v for pair in reversed(pw) for v in pair)
    return torch.nn.functional.pad(x, flat)

kernel_name = 'sequential_preLN__sliding_local_dilated__mixer_token_mlp__prompt'

def setup_inputs():

    _w = (lambda a: (lambda t: t.to(torch.bfloat16) if t.is_floating_point() else t)(torch.as_tensor(a)))
    def _A_setup():
        B, S, D = 1, 2048, 448
        return {
            "x": _w((lambda *s: torch.randn(*s, dtype=torch.bfloat16) * 0.05)(B, S, D)),
            "wqkv": _w((lambda *s: torch.randn(*s, dtype=torch.bfloat16) * 0.05)(D, 3 * D)),
            "wo": _w((lambda *s: torch.randn(*s, dtype=torch.bfloat16) * 0.05)(D, D)),
        }
    _A_in = _A_setup()

    def _B_setup():
        B, S, D, F = 1, 2048, 448, 1792
        return {
            "x": _w((lambda *s: torch.randn(*s, dtype=torch.bfloat16) * 0.05)(B, S, D)),
            "w1": _w((lambda *s: torch.randn(*s, dtype=torch.bfloat16) * 1.6)(S, F) * (S ** -0.5)),
            "b1": _w((lambda *s: torch.randn(*s, dtype=torch.bfloat16) * 12.8)(F) * 0.02),
            "w2": _w((lambda *s: torch.randn(*s, dtype=torch.bfloat16) * 0.4)(F, S) * (F ** -0.5)),
            "b2": _w((lambda *s: torch.randn(*s, dtype=torch.bfloat16) * 6.4)(S) * 0.02),
        }
    _B_in = _B_setup()

    return {
        "A_x": _A_in["x"],
        "A_wqkv": _A_in["wqkv"],
        "A_wo": _A_in["wo"],
        "B_x": _B_in["x"],
        "B_w1": _B_in["w1"],
        "B_b1": _B_in["b1"],
        "B_w2": _B_in["w2"],
        "B_b2": _B_in["b2"],
    }

def reference(A_x, A_wqkv, A_wo, B_x, B_w1, B_b1, B_w2, B_b2):
    def _A_ref(x, wqkv, wo):
        B, S, D = x.shape
        H = 16; Dh = D // H
        W, dil = 8, 2
        qkv = (lambda x, *d: x.permute(*d))((x @ wqkv).reshape(B, S, 3, H, Dh), 2, 0, 3, 1, 4)
        q, k, v = qkv[0], qkv[1], qkv[2]
        scale = Dh ** -0.5
        pos = torch.arange(S)
        off = torch.arange(W) * dil
        idx = pos[:, None] - off[None, :]
        mask = idx >= 0
        idx_c = torch.where(mask, idx, 0).reshape(-1)
        kg = k[:, :, idx_c, :].reshape(B, H, S, W, Dh)
        vg = v[:, :, idx_c, :].reshape(B, H, S, W, Dh)
        logits = torch.einsum("bhsd,bhswd->bhsw", q, kg) * scale
        logits = torch.where(mask[None, None, :, :], logits, -1e9)
        attn = _softmax(logits, axis=-1)
        o = torch.einsum("bhsw,bhswd->bhsd", attn, vg)
        return (lambda x, *d: x.permute(*d))(o, 0, 2, 1, 3).reshape(B, S, D) @ wo

    def _B_ref(x, w1, b1, w2, b2):
        B, S, D = x.shape
        h = _layernorm(x, axis=-1)
        u = torch.einsum("bsd,sf->bdf", h, w1) + b1
        u = _gelu(u)
        y = torch.einsum("bdf,fs->bds", u, w2) + b2
        return (lambda x, *d: x.permute(*d))(y, 0, 2, 1)

    x = A_x
    h = x + _A_ref(_layernorm(x, axis=-1), A_wqkv, A_wo)
    h2 = h + _B_ref(_layernorm(h, axis=-1), B_w1, B_b1, B_w2, B_b2)
    return h2
```

```asm
; @launch grid=(256,1,1) block=(256,1,1) lds=163840
.amdgcn_target "amdgcn-amd-amdhsa--gfx950"
.text
.globl sequential_preLN__sliding_local_dilated__mixer_token_mlp__prompt_kernel
.p2align 8
.type sequential_preLN__sliding_local_dilated__mixer_token_mlp__prompt_kernel,@function
sequential_preLN__sliding_local_dilated__mixer_token_mlp__prompt_kernel:
    s_cmp_ge_u32 s2, 256
    s_cbranch_scc1 L_exit
    s_load_dwordx4 s[4:7], s[0:1], 0
    s_load_dwordx2 s[8:9], s[0:1], 16
    s_load_dwordx2 s[10:11], s[0:1], 64
    s_load_dwordx8 s[12:19], s[0:1], 32
    s_load_dwordx2 s[74:75], s[0:1], 80
    s_getpc_b64 s[66:67]
L_pc:
    v_and_b32 v1, 63, v0
    v_lshrrev_b32 v2, 6, v0
    s_nop 0
    v_readfirstlane_b32 s56, v2
    s_cmp_lt_u32 s2, 128
    s_cbranch_scc1 L_loc_1
    s_lshr_b32 s59, s2, 3
    s_sub_u32 s59, s59, 16
    s_lshl_b32 s59, s59, 2
    s_add_u32 s59, s59, s56
    s_mul_i32 s59, s59, 8
    v_min_u32 v3, 7, v1
    v_add_lshl_u32 v3, s59, v3, 7
    v_min_u32 v3, L_exit-L_pc, v3
    global_load_dword v250, v3, s[66:67]
L_loc_1:
    s_and_b32 s58, s2, 7
    s_lshr_b32 s59, s2, 3
    s_and_b32 s69, s58, 1
    s_lshr_b32 s70, s58, 1
    s_add_u32 s71, s69, 23
    s_sub_u32 s61, s59, s69
    s_sub_u32 s72, s61, 7
    s_add_u32 s61, s61, 9
    s_cmp_ge_u32 s59, s71
    s_cselect_b32 s61, s72, s61
    s_cselect_b32 s3, 2, 1
    s_cmp_lt_u32 s59, 16
    s_cselect_b32 s61, s59, s61
    s_cselect_b32 s3, 0, s3
    s_mul_i32 s72, s69, 25
    s_add_u32 s72, s72, s61
    s_mul_i32 s63, s72, 9363
    s_lshr_b32 s63, s63, 16
    s_mul_i32 s60, s63, 7
    s_sub_u32 s60, s72, s60
    s_mul_i32 s72, s70, 7
    s_add_u32 s62, s60, s72
    s_mov_b32 s71, s61
    s_mul_i32 s72, s69, 28
    s_add_u32 s72, s72, s71
    s_lshr_b32 s65, s72, 3
    s_and_b32 s64, s72, 7
    s_lshl_b32 s70, s70, 3
    s_add_u32 s64, s64, s70
    s_cmp_lt_u32 s61, 28
    s_cselect_b32 s64, s64, -1
    v_mov_b32 v2, 0
    s_mov_b32 s77, 0
    s_cmp_eq_u32 s3, 1
    s_cbranch_scc1 L_roleB
    s_cmp_eq_u32 s3, 2
    s_cbranch_scc1 L_roleC
    s_lshr_b32 s66, s59, 3
    s_lshl_b32 s76, s58, 1
    s_add_u32 s66, s66, s76
    s_and_b32 s67, s59, 7
    v_lshrrev_b32 v2, 4, v1
    v_and_b32 v3, 15, v1
    v_lshrrev_b32 v32, 3, v1
    v_and_b32 v33, 7, v1
    v_mov_b32 v41, 0x7fff0000
    v_and_b32 v36, 1, v2
    v_lshlrev_b32 v36, 1, v36
    v_xor_b32 v36, v36, v33
    v_mul_u32_u24 v37, 2688, v32
    v_lshl_add_u32 v9, v36, 4, v37
    v_cmp_ne_u32 vcc, 7, v36
    s_nop 1
    v_cndmask_b32 v9, v41, v9, vcc
    s_mul_i32 s70, s56, 43008
    s_mul_i32 s76, s67, 112
    s_add_u32 s70, s70, s76
    s_lshl_b32 s72, s56, 11
    s_add_u32 s72, s72, 18432
    s_waitcnt lgkmcnt(0)
    s_mov_b32 s24, s6
    s_mov_b32 s25, s7
    s_mov_b32 s26, 0x126000
    s_mov_b32 s27, 0x00020000
    s_mov_b32 s20, s4
    s_mov_b32 s21, s5
    s_mov_b32 s22, 0x1c0000
    s_mov_b32 s23, 0x00020000
    s_add_u32 m0, s72, 86016
    s_nop 0
    buffer_load_dwordx4 v9, s[24:27], s70 offen lds
    v_xor_b32 v36, 4, v36
    v_lshl_add_u32 v12, v36, 4, v37
    v_add_u32 v12, 21504, v12
    v_cmp_ne_u32 vcc, 7, v36
    s_nop 1
    v_cndmask_b32 v12, v41, v12, vcc
    s_add_u32 m0, s72, 87040
    s_nop 0
    buffer_load_dwordx4 v12, s[24:27], s70 offen lds
    s_mov_b32 s40, s74
    s_mov_b32 s41, s75
    s_mov_b32 s42, 0x800000
    s_mov_b32 s43, 0x00020000
    v_mov_b32 v40, 0
    buffer_load_dword v252, v40, s[40:43], 0 offen sc1
    s_mov_b32 s28, s8
    s_mov_b32 s29, s9
    s_mov_b32 s30, 0x62000
    s_mov_b32 s31, 0x00020000
    s_mov_b32 s44, s10
    s_mov_b32 s45, s11
    s_mov_b32 s46, 0x1c0000
    s_mov_b32 s47, 0x00020000
    s_mov_b32 s32, s12
    s_mov_b32 s33, s13
    s_mov_b32 s34, 0x700000
    s_mov_b32 s35, 0x00020000
    s_mov_b32 s48, s14
    s_mov_b32 s49, s15
    s_mov_b32 s50, 0xe00
    s_mov_b32 s51, 0x00020000
    s_mov_b32 s36, s16
    s_mov_b32 s37, s17
    s_mov_b32 s38, 0x700000
    s_mov_b32 s39, 0x00020000
    s_mov_b32 s52, s18
    s_mov_b32 s53, s19
    s_mov_b32 s54, 0x1000
    s_mov_b32 s55, 0x00020000
    v_add_u32 v10, 896, v9
    s_add_u32 m0, s72, 94208
    s_nop 0
    buffer_load_dwordx4 v10, s[24:27], s70 offen lds
    v_add_u32 v13, 896, v12
    s_add_u32 m0, s72, 95232
    s_nop 0
    buffer_load_dwordx4 v13, s[24:27], s70 offen lds
    v_add_u32 v11, 1792, v9
    s_add_u32 m0, s72, 102400
    s_nop 0
    buffer_load_dwordx4 v11, s[24:27], s70 offen lds
    v_add_u32 v14, 1792, v12
    s_add_u32 m0, s72, 103424
    s_nop 0
    buffer_load_dwordx4 v14, s[24:27], s70 offen lds
    s_add_u32 s70, s70, 172032
    v_xor_b32 v34, v33, v2
    v_mul_u32_u24 v35, 896, v32
    v_lshl_add_u32 v4, v34, 4, v35
    s_lshl_b32 s68, s66, 7
    s_sub_u32 s69, s68, 16
    s_max_i32 s69, s69, 0
    s_mul_i32 s69, s69, 896
    s_lshl_b32 s76, s56, 5
    s_add_u32 s68, s68, s76
    s_mul_i32 s68, s68, 896
    s_lshl_b32 s71, s56, 12
    s_add_u32 s71, s71, 2048
    s_add_u32 m0, s71, 86016
    s_nop 0
    buffer_load_dwordx4 v4, s[20:23], s68 offen lds
    v_xor_b32 v36, 4, v34
    v_lshl_add_u32 v5, v36, 4, v35
    v_add_u32 v5, 7168, v5
    s_add_u32 m0, s71, 87040
    s_nop 0
    buffer_load_dwordx4 v5, s[20:23], s68 offen lds
    v_add_u32 v6, 14336, v4
    s_add_u32 m0, s71, 88064
    s_nop 0
    buffer_load_dwordx4 v6, s[20:23], s68 offen lds
    v_add_u32 v7, 14336, v5
    s_add_u32 m0, s71, 89088
    s_nop 0
    buffer_load_dwordx4 v7, s[20:23], s68 offen lds
    s_add_u32 s68, s68, 128
    s_and_b32 s73, s56, 1
    s_lshl_b32 s73, s73, 10
    s_bitcmp1_b32 s56, 0
    s_cselect_b64 s[4:5], -1, 0
    v_cndmask_b32 v8, v4, v5, s[4:5]
    s_add_u32 m0, s73, 86016
    s_nop 0
    buffer_load_dwordx4 v8, s[20:23], s69 offen lds
    s_add_u32 s69, s69, 128
    s_add_u32 m0, s72, 0
    s_nop 0
    buffer_load_dwordx4 v9, s[24:27], s70 offen lds
    v_mov_b32 v36, 0x3f803f80
    v_mov_b32 v37, 0x3f803f80
    v_mov_b32 v38, 0x3f803f80
    v_mov_b32 v39, 0x3f803f80
    v_lshrrev_b32 v32, 4, v0
    v_min_u32 v32, 11, v32
    v_lshrrev_b32 v33, 1, v32
    v_and_b32 v32, 1, v32
    v_lshlrev_b32 v32, 9, v32
    v_lshl_add_u32 v32, v33, 12, v32
    v_lshl_add_u32 v32, v3, 4, v32
    v_add_u32 v32, 129024, v32
    ds_write_b128 v32, v[36:39]
    v_lshrrev_b32 v41, 1, v3
    v_xor_b32 v41, v41, v2
    v_lshlrev_b32 v41, 4, v41
    v_lshl_add_u32 v44, v3, 7, v41
    v_xor_b32 v45, 64, v44
    v_cmp_eq_u32 s[4:5], 0, v3
    s_add_u32 m0, s72, 1024
    s_nop 0
    buffer_load_dwordx4 v12, s[24:27], s70 offen lds
    v_add_u32 v46, 129024, v44
    s_add_u32 s74, s71, 0
    v_add_u32 v176, s74, v44
    v_add_u32 v47, 0, v44
    v_cndmask_b32 v178, v47, v46, s[4:5]
    s_add_u32 s74, s71, 43008
    v_add_u32 v184, s74, v44
    v_add_u32 v47, 43008, v44
    v_cndmask_b32 v186, v47, v46, s[4:5]
    s_add_u32 s74, s71, 86016
    v_add_u32 v192, s74, v44
    v_add_u32 v47, 86016, v44
    v_cndmask_b32 v194, v47, v46, s[4:5]
    v_add_u32 v46, 129024, v45
    s_add_u32 s74, s71, 0
    v_add_u32 v177, s74, v45
    v_add_u32 v47, 0, v45
    v_cndmask_b32 v179, v47, v46, s[4:5]
    s_add_u32 s74, s71, 43008
    s_add_u32 m0, s72, 8192
    s_nop 0
    buffer_load_dwordx4 v10, s[24:27], s70 offen lds
    v_add_u32 v185, s74, v45
    v_add_u32 v47, 43008, v45
    v_cndmask_b32 v187, v47, v46, s[4:5]
    s_add_u32 s74, s71, 86016
    v_add_u32 v193, s74, v45
    v_add_u32 v47, 86016, v45
    v_cndmask_b32 v195, v47, v46, s[4:5]
    v_bfe_u32 v41, v1, 3, 1
    v_and_b32 v42, 1, v2
    v_lshl_or_b32 v41, v42, 1, v41
    v_lshlrev_b32 v41, 5, v41
    v_lshrrev_b32 v42, 2, v3
    v_lshl_add_u32 v42, v2, 3, v42
    v_lshlrev_b32 v42, 7, v42
    v_and_b32 v43, 3, v1
    v_cmp_eq_u32 s[6:7], 3, v43
    v_lshlrev_b32 v43, 3, v43
    s_and_b32 s74, s56, 1
    s_xor_b32 s74, s74, 0
    s_mul_i32 s75, s74, 56
    s_add_u32 m0, s72, 9216
    s_nop 0
    buffer_load_dwordx4 v13, s[24:27], s70 offen lds
    s_lshl_b32 s74, s74, 3
    s_sub_u32 s74, 120, s74
    v_add_u32 v44, s75, v43
    v_xor_b32 v44, v44, v41
    v_add_u32 v44, v44, v42
    v_add_u32 v180, 18432, v44
    v_add_u32 v188, 61440, v44
    v_add_u32 v196, 104448, v44
    v_add_u32 v44, s75, v43
    v_add_u32 v44, 32, v44
    v_xor_b32 v45, s74, v41
    v_add_u32 v45, v45, v42
    v_and_b32 v45, 0xff, v45
    v_add_u32 v45, 129024, v45
    v_xor_b32 v44, v44, v41
    v_add_u32 v44, v44, v42
    v_add_u32 v181, 18432, v44
    v_cndmask_b32 v181, v181, v45, s[6:7]
    v_add_u32 v189, 61440, v44
    s_add_u32 m0, s72, 16384
    s_nop 0
    buffer_load_dwordx4 v11, s[24:27], s70 offen lds
    v_cndmask_b32 v189, v189, v45, s[6:7]
    v_add_u32 v197, 104448, v44
    v_cndmask_b32 v197, v197, v45, s[6:7]
    s_and_b32 s74, s56, 1
    s_xor_b32 s74, s74, 1
    s_mul_i32 s75, s74, 56
    s_lshl_b32 s74, s74, 3
    s_sub_u32 s74, 120, s74
    v_add_u32 v44, s75, v43
    v_xor_b32 v44, v44, v41
    v_add_u32 v44, v44, v42
    v_add_u32 v182, 18432, v44
    v_add_u32 v190, 61440, v44
    v_add_u32 v198, 104448, v44
    v_add_u32 v44, s75, v43
    v_add_u32 v44, 32, v44
    v_xor_b32 v45, s74, v41
    v_add_u32 v45, v45, v42
    v_and_b32 v45, 0xff, v45
    s_add_u32 m0, s72, 17408
    s_nop 0
    buffer_load_dwordx4 v14, s[24:27], s70 offen lds
    s_add_u32 s70, s70, 172032
    v_add_u32 v45, 129024, v45
    v_xor_b32 v44, v44, v41
    v_add_u32 v44, v44, v42
    v_add_u32 v183, 18432, v44
    v_cndmask_b32 v183, v183, v45, s[6:7]
    v_add_u32 v191, 61440, v44
    v_cndmask_b32 v191, v191, v45, s[6:7]
    v_add_u32 v199, 104448, v44
    v_cndmask_b32 v199, v199, v45, s[6:7]
    v_lshrrev_b32 v28, 2, v3
    v_lshl_add_u32 v232, v28, 4, v3
    v_lshlrev_b32 v232, 2, v232
    v_lshlrev_b32 v234, 2, v3
    v_add_u32 v233, 192, v234
    v_mov_b32 v246, 0x3f803f80
    v_and_b32 v28, 1, v1
    v_cmp_eq_u32 s[10:11], 1, v28
    v_and_b32 v28, 2, v1
    v_cmp_eq_u32 s[12:13], 2, v28
    v_cmp_eq_u32 s[14:15], 3, v2
    s_add_u32 m0, s71, 0
    s_nop 0
    buffer_load_dwordx4 v4, s[20:23], s68 offen lds
    v_cmp_le_u32 s[16:17], 12, v3
    v_and_b32 v28, 1, v2
    v_cmp_eq_u32 s[18:19], 1, v28
    s_and_b32 s74, s56, 1
    s_mul_i32 s74, s74, 384
    s_add_u32 s74, s74, 0
    s_xor_b32 s75, s74, 384
    v_lshl_add_u32 v235, v2, 4, s74
    v_add_u32 v236, s74, v234
    v_lshl_add_u32 v237, v2, 4, s75
    v_add_u32 v238, s75, v234
    s_mul_i32 s74, s56, 384
    s_add_u32 s74, s74, 768
    v_lshl_add_u32 v239, v28, 6, v234
    v_add_u32 v239, s74, v239
    v_lshl_add_u32 v240, v2, 4, s74
    s_and_b32 s74, s56, 1
    s_lshl_b32 s74, s74, 11
    v_lshlrev_b32 v28, 4, v1
    s_add_u32 m0, s71, 1024
    s_nop 0
    buffer_load_dwordx4 v5, s[20:23], s68 offen lds
    v_add_u32 v29, s74, v28
    v_xor_b32 v30, 0x800, v29
    s_lshl_b32 s74, s56, 12
    s_add_u32 s74, s74, 4096
    v_add_u32 v241, s74, v29
    v_add_u32 v242, s74, v30
    v_add_u32 v243, 4096, v29
    v_add_u32 v29, 1024, v28
    v_mov_b32 v30, 0x7fff0000
    v_cndmask_b32 v29, v29, v30, s[14:15]
    s_bitcmp1_b32 s56, 0
    s_cselect_b64 s[8:9], -1, 0
    v_cndmask_b32 v244, v28, v29, s[8:9]
    v_cndmask_b32 v245, v29, v28, s[8:9]
    v_lshlrev_b32 v28, 2, v2
    v_sub_u32 v28, v3, v28
    v_mov_b32 v29, 0xf149f2ca
    s_or_b32 s74, s66, s56
    s_cmp_eq_u32 s74, 0
    s_cselect_b64 s[8:9], -1, 0
    v_add_u32 v30, 16, v28
    s_add_u32 m0, s71, 2048
    s_nop 0
    buffer_load_dwordx4 v6, s[20:23], s68 offen lds
    v_and_b32 v30, 0xfffffff1, v30
    v_cmp_eq_u32 vcc, 0, v30
    s_nop 1
    v_cndmask_b32 v224, v29, 0, vcc
    v_add_u32 v30, 0, v28
    v_and_b32 v30, 0xfffffff1, v30
    v_cmp_eq_u32 vcc, 0, v30
    s_nop 1
    v_cndmask_b32 v228, v29, 0, vcc
    v_cndmask_b32 v220, v224, v29, s[8:9]
    v_add_u32 v30, 15, v28
    v_and_b32 v30, 0xfffffff1, v30
    v_cmp_eq_u32 vcc, 0, v30
    s_nop 1
    v_cndmask_b32 v225, v29, 0, vcc
    v_add_u32 v30, -1, v28
    v_and_b32 v30, 0xfffffff1, v30
    v_cmp_eq_u32 vcc, 0, v30
    s_nop 1
    v_cndmask_b32 v229, v29, 0, vcc
    v_cndmask_b32 v221, v225, v29, s[8:9]
    v_add_u32 v30, 14, v28
    v_and_b32 v30, 0xfffffff1, v30
    v_cmp_eq_u32 vcc, 0, v30
    s_add_u32 m0, s71, 3072
    s_nop 0
    buffer_load_dwordx4 v7, s[20:23], s68 offen lds
    s_add_u32 s68, s68, 128
    v_cndmask_b32 v226, v29, 0, vcc
    v_add_u32 v30, -2, v28
    v_and_b32 v30, 0xfffffff1, v30
    v_cmp_eq_u32 vcc, 0, v30
    s_nop 1
    v_cndmask_b32 v230, v29, 0, vcc
    v_cndmask_b32 v222, v226, v29, s[8:9]
    v_add_u32 v30, 13, v28
    v_and_b32 v30, 0xfffffff1, v30
    v_cmp_eq_u32 vcc, 0, v30
    s_nop 1
    v_cndmask_b32 v227, v29, 0, vcc
    v_add_u32 v30, -3, v28
    v_and_b32 v30, 0xfffffff1, v30
    v_cmp_eq_u32 vcc, 0, v30
    s_nop 1
    v_cndmask_b32 v231, v29, 0, vcc
    v_cndmask_b32 v223, v227, v29, s[8:9]
    v_cmp_eq_u32 vcc, 0, v224
    s_nop 1
    v_cndmask_b32 v28, 0, -1, vcc
    v_cmp_eq_u32 vcc, 0, v225
    s_nop 1
    v_cndmask_b32 v29, 0, -1, vcc
    s_add_u32 m0, s73, 0
    s_nop 0
    buffer_load_dwordx4 v8, s[20:23], s69 offen lds
    s_add_u32 s69, s69, 128
    v_lshrrev_b32 v28, 16, v28
    v_lshl_or_b32 v0, v29, 16, v28
    v_cmp_eq_u32 vcc, 0, v226
    s_nop 1
    v_cndmask_b32 v28, 0, -1, vcc
    v_cmp_eq_u32 vcc, 0, v227
    s_nop 1
    v_cndmask_b32 v29, 0, -1, vcc
    v_lshrrev_b32 v28, 16, v28
    v_lshl_or_b32 v15, v29, 16, v28
    v_cmp_eq_u32 vcc, 0, v228
    s_nop 1
    v_cndmask_b32 v28, 0, -1, vcc
    v_cmp_eq_u32 vcc, 0, v229
    s_nop 1
    v_cndmask_b32 v29, 0, -1, vcc
    v_lshrrev_b32 v28, 16, v28
    v_lshl_or_b32 v251, v29, 16, v28
    v_cmp_eq_u32 vcc, 0, v230
    s_nop 1
    v_cndmask_b32 v28, 0, -1, vcc
    v_cmp_eq_u32 vcc, 0, v231
    s_nop 1
    v_cndmask_b32 v29, 0, -1, vcc
    v_lshrrev_b32 v28, 16, v28
    v_lshl_or_b32 v253, v29, 16, v28
    s_waitcnt vmcnt(11)
    s_waitcnt lgkmcnt(0)
    s_barrier
    ds_read_b128 v[152:155], v192
    ds_read_b128 v[156:159], v192 offset:2048
    ds_read_b64_tr_b16 a[0:1], v196 offset:0
    ds_read_b64_tr_b16 a[2:3], v196 offset:512
    ds_read_b64_tr_b16 a[4:5], v197 offset:0
    ds_read_b64_tr_b16 a[6:7], v197 offset:512
    ds_read_b64_tr_b16 a[8:9], v198 offset:0
    ds_read_b64_tr_b16 a[10:11], v198 offset:512
    ds_read_b64_tr_b16 a[12:13], v199 offset:0
    ds_read_b64_tr_b16 a[14:15], v199 offset:512
    ds_read_b64_tr_b16 a[16:17], v196 offset:8192
    ds_read_b64_tr_b16 a[18:19], v196 offset:8704
    ds_read_b64_tr_b16 a[20:21], v197 offset:8192
    ds_read_b64_tr_b16 a[22:23], v197 offset:8704
    ds_read_b64_tr_b16 a[24:25], v198 offset:8192
    ds_read_b64_tr_b16 a[26:27], v198 offset:8704
    ds_read_b64_tr_b16 a[28:29], v199 offset:8192
    ds_read_b64_tr_b16 a[30:31], v199 offset:8704
    ds_read_b64_tr_b16 a[32:33], v196 offset:16384
    ds_read_b64_tr_b16 a[34:35], v196 offset:16896
    ds_read_b64_tr_b16 a[36:37], v197 offset:16384
    ds_read_b64_tr_b16 a[38:39], v197 offset:16896
    ds_read_b64_tr_b16 a[40:41], v198 offset:16384
    ds_read_b64_tr_b16 a[42:43], v198 offset:16896
    ds_read_b64_tr_b16 a[44:45], v199 offset:16384
    ds_read_b64_tr_b16 a[46:47], v199 offset:16896
    ds_read_b128 v[160:163], v194
    v_readfirstlane_b32 s57, v252
    s_mul_i32 s57, s57, 0x19660d
    s_add_u32 s57, s57, 0x3c6ef35f
    s_cmp_lg_u32 s56, 0
    s_cbranch_scc1 L_pub_2
    s_lshl_b32 s76, s2, 7
    s_add_u32 s76, s76, 98304
    v_mov_b32 v254, s57
    v_mov_b32 v255, 0
    s_mov_b64 exec, 1
    buffer_store_dword v254, v255, s[40:43], s76 offen sc1
    s_mov_b64 exec, -1
L_pub_2:
    s_waitcnt lgkmcnt(15)
    v_mfma_f32_16x16x32_bf16 v[32:35], a[0:3], v[152:155], 0
    ds_read_b128 v[164:167], v193
    ds_read_b128 v[168:171], v193 offset:2048
    v_mfma_f32_16x16x32_bf16 v[80:83], a[0:3], v[156:159], 0
    ds_read_b64_tr_b16 a[48:49], v196 offset:4096
    v_mfma_f32_16x16x32_bf16 v[36:39], a[4:7], v[152:155], 0
    s_add_u32 m0, s72, 43008
    ds_read_b64_tr_b16 a[50:51], v196 offset:4608
    v_mfma_f32_16x16x32_bf16 v[84:87], a[4:7], v[156:159], 0
    ds_read_b64_tr_b16 a[52:53], v197 offset:4096
    v_mfma_f32_16x16x32_bf16 v[40:43], a[8:11], v[152:155], 0
    buffer_load_dwordx4 v9, s[24:27], s70 offen lds
    ds_read_b64_tr_b16 a[54:55], v197 offset:4608
    v_mfma_f32_16x16x32_bf16 v[88:91], a[8:11], v[156:159], 0
    ds_read_b64_tr_b16 a[56:57], v198 offset:4096
    v_mfma_f32_16x16x32_bf16 v[44:47], a[12:15], v[152:155], 0
    s_add_u32 m0, s72, 44032
    ds_read_b64_tr_b16 a[58:59], v198 offset:4608
    v_mfma_f32_16x16x32_bf16 v[92:95], a[12:15], v[156:159], 0
    ds_read_b64_tr_b16 a[60:61], v199 offset:4096
    s_waitcnt lgkmcnt(15)
    v_mfma_f32_16x16x32_bf16 v[48:51], a[16:19], v[152:155], 0
    buffer_load_dwordx4 v12, s[24:27], s70 offen lds
    ds_read_b64_tr_b16 a[62:63], v199 offset:4608
    v_mfma_f32_16x16x32_bf16 v[96:99], a[16:19], v[156:159], 0
    ds_read_b64_tr_b16 a[64:65], v196 offset:12288
    v_mfma_f32_16x16x32_bf16 v[52:55], a[20:23], v[152:155], 0
    ds_read_b64_tr_b16 a[66:67], v196 offset:12800
    s_add_u32 m0, s71, 43008
    v_mfma_f32_16x16x32_bf16 v[100:103], a[20:23], v[156:159], 0
    ds_read_b64_tr_b16 a[68:69], v197 offset:12288
    v_mfma_f32_16x16x32_bf16 v[56:59], a[24:27], v[152:155], 0
    ds_read_b64_tr_b16 a[70:71], v197 offset:12800
    buffer_load_dwordx4 v4, s[20:23], s68 offen lds
    v_mfma_f32_16x16x32_bf16 v[104:107], a[24:27], v[156:159], 0
    ds_read_b64_tr_b16 a[72:73], v198 offset:12288
    v_mfma_f32_16x16x32_bf16 v[60:63], a[28:31], v[152:155], 0
    ds_read_b64_tr_b16 a[74:75], v198 offset:12800
    s_add_u32 m0, s72, 51200
    v_mfma_f32_16x16x32_bf16 v[108:111], a[28:31], v[156:159], 0
    ds_read_b64_tr_b16 a[76:77], v199 offset:12288
    s_waitcnt lgkmcnt(15)
    v_mfma_f32_16x16x32_bf16 v[64:67], v[152:155], a[32:35], 0
    ds_read_b64_tr_b16 a[78:79], v199 offset:12800
    buffer_load_dwordx4 v10, s[24:27], s70 offen lds
    v_mfma_f32_16x16x32_bf16 v[112:115], v[156:159], a[32:35], 0
    ds_read_b64_tr_b16 a[80:81], v196 offset:20480
    v_mfma_f32_16x16x32_bf16 v[68:71], v[152:155], a[36:39], 0
    ds_read_b64_tr_b16 a[82:83], v196 offset:20992
    ds_read_b64_tr_b16 a[84:85], v197 offset:20480
    v_mfma_f32_16x16x32_bf16 v[116:119], v[156:159], a[36:39], 0
    s_add_u32 m0, s71, 44032
    v_mfma_f32_16x16x32_bf16 v[72:75], v[152:155], a[40:43], 0
    ds_read_b64_tr_b16 a[86:87], v197 offset:20992
    ds_read_b64_tr_b16 a[88:89], v198 offset:20480
    v_mfma_f32_16x16x32_bf16 v[120:123], v[156:159], a[40:43], 0
    buffer_load_dwordx4 v5, s[20:23], s68 offen lds
    v_mfma_f32_16x16x32_bf16 v[76:79], v[152:155], a[44:47], 0
    ds_read_b64_tr_b16 a[90:91], v198 offset:20992
    ds_read_b64_tr_b16 a[92:93], v199 offset:20480
    v_mfma_f32_16x16x32_bf16 v[124:127], v[156:159], a[44:47], 0
    s_add_u32 m0, s72, 52224
    v_mfma_f32_16x16x32_bf16 v[128:131], v[152:155], v[152:155], 0
    ds_read_b64_tr_b16 a[94:95], v199 offset:20992
    ds_read_b128 v[172:175], v195
    v_mfma_f32_16x16x32_bf16 v[132:135], v[156:159], v[156:159], 0
    buffer_load_dwordx4 v13, s[24:27], s70 offen lds
    v_mfma_f32_16x16x32_bf16 v[136:139], v[160:163], v[160:163], 0
    s_cmp_ge_u32 s56, 2
    s_cbranch_scc1 L_beta_3
    v_mfma_f32_16x16x32_bf16 v[140:143], a[0:3], v[160:163], 0
    v_mfma_f32_16x16x32_bf16 v[144:147], a[4:7], v[160:163], 0
    v_mfma_f32_16x16x32_bf16 v[148:151], a[16:19], v[160:163], 0
    s_branch L_join_4
L_beta_3:
    v_mfma_f32_16x16x32_bf16 v[140:143], a[20:23], v[160:163], 0
    v_mfma_f32_16x16x32_bf16 v[144:147], v[160:163], a[32:35], 0
    v_mfma_f32_16x16x32_bf16 v[148:151], v[160:163], a[36:39], 0
L_join_4:
    s_waitcnt lgkmcnt(15)
    v_mfma_f32_16x16x32_bf16 v[32:35], a[48:51], v[164:167], v[32:35]
    s_add_u32 m0, s71, 45056
    v_mfma_f32_16x16x32_bf16 v[80:83], a[48:51], v[168:171], v[80:83]
    v_mfma_f32_16x16x32_bf16 v[36:39], a[52:55], v[164:167], v[36:39]
    v_mfma_f32_16x16x32_bf16 v[84:87], a[52:55], v[168:171], v[84:87]
    v_mfma_f32_16x16x32_bf16 v[40:43], a[56:59], v[164:167], v[40:43]
    buffer_load_dwordx4 v6, s[20:23], s68 offen lds
    v_mfma_f32_16x16x32_bf16 v[88:91], a[56:59], v[168:171], v[88:91]
    v_mfma_f32_16x16x32_bf16 v[44:47], a[60:63], v[164:167], v[44:47]
    v_mfma_f32_16x16x32_bf16 v[92:95], a[60:63], v[168:171], v[92:95]
    s_waitcnt lgkmcnt(9)
    v_mfma_f32_16x16x32_bf16 v[48:51], a[64:67], v[164:167], v[48:51]
    s_waitcnt vmcnt(7) lgkmcnt(0)
    s_barrier
    v_mfma_f32_16x16x32_bf16 v[96:99], a[64:67], v[168:171], v[96:99]
    ds_read_b128 v[152:155], v176
    ds_read_b128 v[156:159], v176 offset:2048
    v_mfma_f32_16x16x32_bf16 v[52:55], a[68:71], v[164:167], v[52:55]
    ds_read_b64_tr_b16 a[0:1], v180 offset:0
    ds_read_b64_tr_b16 a[2:3], v180 offset:512
    v_mfma_f32_16x16x32_bf16 v[100:103], a[68:71], v[168:171], v[100:103]
    s_add_u32 m0, s72, 59392
    ds_read_b64_tr_b16 a[4:5], v181 offset:0
    v_mfma_f32_16x16x32_bf16 v[56:59], a[72:75], v[164:167], v[56:59]
    ds_read_b64_tr_b16 a[6:7], v181 offset:512
    ds_read_b64_tr_b16 a[8:9], v182 offset:0
    v_mfma_f32_16x16x32_bf16 v[104:107], a[72:75], v[168:171], v[104:107]
    buffer_load_dwordx4 v11, s[24:27], s70 offen lds
    ds_read_b64_tr_b16 a[10:11], v182 offset:512
    v_mfma_f32_16x16x32_bf16 v[60:63], a[76:79], v[164:167], v[60:63]
    ds_read_b64_tr_b16 a[12:13], v183 offset:0
    ds_read_b64_tr_b16 a[14:15], v183 offset:512
    v_mfma_f32_16x16x32_bf16 v[108:111], a[76:79], v[168:171], v[108:111]
    ds_read_b64_tr_b16 a[16:17], v180 offset:8192
    s_add_u32 m0, s72, 60416
    s_waitcnt lgkmcnt(11)
    v_mfma_f32_16x16x32_bf16 v[64:67], v[164:167], a[80:83], v[64:67]
    ds_read_b64_tr_b16 a[18:19], v180 offset:8704
    ds_read_b64_tr_b16 a[20:21], v181 offset:8192
    v_mfma_f32_16x16x32_bf16 v[112:115], v[168:171], a[80:83], v[112:115]
    ds_read_b64_tr_b16 a[22:23], v181 offset:8704
    buffer_load_dwordx4 v14, s[24:27], s70 offen lds
    s_add_u32 s70, s70, 172032
    v_mfma_f32_16x16x32_bf16 v[68:71], v[164:167], a[84:87], v[68:71]
    ds_read_b64_tr_b16 a[24:25], v182 offset:8192
    ds_read_b64_tr_b16 a[26:27], v182 offset:8704
    v_mfma_f32_16x16x32_bf16 v[116:119], v[168:171], a[84:87], v[116:119]
    ds_read_b64_tr_b16 a[28:29], v183 offset:8192
    s_add_u32 m0, s71, 46080
    v_mfma_f32_16x16x32_bf16 v[72:75], v[164:167], a[88:91], v[72:75]
    ds_read_b64_tr_b16 a[30:31], v183 offset:8704
    ds_read_b64_tr_b16 a[32:33], v180 offset:16384
    v_mfma_f32_16x16x32_bf16 v[120:123], v[168:171], a[88:91], v[120:123]
    ds_read_b64_tr_b16 a[34:35], v180 offset:16896
    ds_read_b64_tr_b16 a[36:37], v181 offset:16384
    v_mfma_f32_16x16x32_bf16 v[76:79], v[164:167], a[92:95], v[76:79]
    buffer_load_dwordx4 v7, s[20:23], s68 offen lds
    s_add_u32 s68, s68, 128
    ds_read_b64_tr_b16 a[38:39], v181 offset:16896
    v_mfma_f32_16x16x32_bf16 v[124:127], v[168:171], a[92:95], v[124:127]
    ds_read_b64_tr_b16 a[40:41], v182 offset:16384
    ds_read_b64_tr_b16 a[42:43], v182 offset:16896
    v_mfma_f32_16x16x32_bf16 v[128:131], v[164:167], v[164:167], v[128:131]
    s_add_u32 m0, s73, 43008
    ds_read_b64_tr_b16 a[44:45], v183 offset:16384
    v_mfma_f32_16x16x32_bf16 v[132:135], v[168:171], v[168:171], v[132:135]
    ds_read_b64_tr_b16 a[46:47], v183 offset:16896
    ds_read_b128 v[160:163], v178
    v_mfma_f32_16x16x32_bf16 v[136:139], v[172:175], v[172:175], v[136:139]
    buffer_load_dwordx4 v8, s[20:23], s69 offen lds
    s_add_u32 s69, s69, 128
    s_cmp_ge_u32 s56, 2
    s_cbranch_scc1 L_beta_5
    v_mfma_f32_16x16x32_bf16 v[140:143], a[48:51], v[172:175], v[140:143]
    v_mfma_f32_16x16x32_bf16 v[144:147], a[52:55], v[172:175], v[144:147]
    v_mfma_f32_16x16x32_bf16 v[148:151], a[64:67], v[172:175], v[148:151]
    s_branch L_join_6
L_beta_5:
    v_mfma_f32_16x16x32_bf16 v[140:143], a[68:71], v[172:175], v[140:143]
    v_mfma_f32_16x16x32_bf16 v[144:147], v[172:175], a[80:83], v[144:147]
    v_mfma_f32_16x16x32_bf16 v[148:151], v[172:175], a[84:87], v[148:151]
L_join_6:
    s_waitcnt lgkmcnt(15)
    v_mfma_f32_16x16x32_bf16 v[32:35], a[0:3], v[152:155], v[32:35]
    ds_read_b128 v[164:167], v177
    ds_read_b128 v[168:171], v177 offset:2048
    v_mfma_f32_16x16x32_bf16 v[80:83], a[0:3], v[156:159], v[80:83]
    ds_read_b64_tr_b16 a[48:49], v180 offset:4096
    v_mfma_f32_16x16x32_bf16 v[36:39], a[4:7], v[152:155], v[36:39]
    s_add_u32 m0, s72, 86016
    ds_read_b64_tr_b16 a[50:51], v180 offset:4608
    v_mfma_f32_16x16x32_bf16 v[84:87], a[4:7], v[156:159], v[84:87]
    ds_read_b64_tr_b16 a[52:53], v181 offset:4096
    v_mfma_f32_16x16x32_bf16 v[40:43], a[8:11], v[152:155], v[40:43]
    buffer_load_dwordx4 v9, s[24:27], s70 offen lds
    ds_read_b64_tr_b16 a[54:55], v181 offset:4608
    v_mfma_f32_16x16x32_bf16 v[88:91], a[8:11], v[156:159], v[88:91]
    ds_read_b64_tr_b16 a[56:57], v182 offset:4096
    v_mfma_f32_16x16x32_bf16 v[44:47], a[12:15], v[152:155], v[44:47]
    s_add_u32 m0, s72, 87040
    ds_read_b64_tr_b16 a[58:59], v182 offset:4608
    v_mfma_f32_16x16x32_bf16 v[92:95], a[12:15], v[156:159], v[92:95]
    ds_read_b64_tr_b16 a[60:61], v183 offset:4096
    s_waitcnt lgkmcnt(15)
    v_mfma_f32_16x16x32_bf16 v[48:51], a[16:19], v[152:155], v[48:51]
    buffer_load_dwordx4 v12, s[24:27], s70 offen lds
    ds_read_b64_tr_b16 a[62:63], v183 offset:4608
    v_mfma_f32_16x16x32_bf16 v[96:99], a[16:19], v[156:159], v[96:99]
    ds_read_b64_tr_b16 a[64:65], v180 offset:12288
    v_mfma_f32_16x16x32_bf16 v[52:55], a[20:23], v[152:155], v[52:55]
    ds_read_b64_tr_b16 a[66:67], v180 offset:12800
    s_add_u32 m0, s71, 86016
    v_mfma_f32_16x16x32_bf16 v[100:103], a[20:23], v[156:159], v[100:103]
    ds_read_b64_tr_b16 a[68:69], v181 offset:12288
    v_mfma_f32_16x16x32_bf16 v[56:59], a[24:27], v[152:155], v[56:59]
    ds_read_b64_tr_b16 a[70:71], v181 offset:12800
    buffer_load_dwordx4 v4, s[20:23], s68 offen lds
    v_mfma_f32_16x16x32_bf16 v[104:107], a[24:27], v[156:159], v[104:107]
    ds_read_b64_tr_b16 a[72:73], v182 offset:12288
    v_mfma_f32_16x16x32_bf16 v[60:63], a[28:31], v[152:155], v[60:63]
    ds_read_b64_tr_b16 a[74:75], v182 offset:12800
    s_add_u32 m0, s72, 94208
    v_mfma_f32_16x16x32_bf16 v[108:111], a[28:31], v[156:159], v[108:111]
    ds_read_b64_tr_b16 a[76:77], v183 offset:12288
    s_waitcnt lgkmcnt(15)
    v_mfma_f32_16x16x32_bf16 v[64:67], v[152:155], a[32:35], v[64:67]
    ds_read_b64_tr_b16 a[78:79], v183 offset:12800
    buffer_load_dwordx4 v10, s[24:27], s70 offen lds
    v_mfma_f32_16x16x32_bf16 v[112:115], v[156:159], a[32:35], v[112:115]
    ds_read_b64_tr_b16 a[80:81], v180 offset:20480
    v_mfma_f32_16x16x32_bf16 v[68:71], v[152:155], a[36:39], v[68:71]
    ds_read_b64_tr_b16 a[82:83], v180 offset:20992
    ds_read_b64_tr_b16 a[84:85], v181 offset:20480
    v_mfma_f32_16x16x32_bf16 v[116:119], v[156:159], a[36:39], v[116:119]
    s_add_u32 m0, s71, 87040
    v_mfma_f32_16x16x32_bf16 v[72:75], v[152:155], a[40:43], v[72:75]
    ds_read_b64_tr_b16 a[86:87], v181 offset:20992
    ds_read_b64_tr_b16 a[88:89], v182 offset:20480
    v_mfma_f32_16x16x32_bf16 v[120:123], v[156:159], a[40:43], v[120:123]
    buffer_load_dwordx4 v5, s[20:23], s68 offen lds
    v_mfma_f32_16x16x32_bf16 v[76:79], v[152:155], a[44:47], v[76:79]
    ds_read_b64_tr_b16 a[90:91], v182 offset:20992
    ds_read_b64_tr_b16 a[92:93], v183 offset:20480
    v_mfma_f32_16x16x32_bf16 v[124:127], v[156:159], a[44:47], v[124:127]
    s_add_u32 m0, s72, 95232
    v_mfma_f32_16x16x32_bf16 v[128:131], v[152:155], v[152:155], v[128:131]
    ds_read_b64_tr_b16 a[94:95], v183 offset:20992
    ds_read_b128 v[172:175], v179
    v_mfma_f32_16x16x32_bf16 v[132:135], v[156:159], v[156:159], v[132:135]
    buffer_load_dwordx4 v13, s[24:27], s70 offen lds
    v_mfma_f32_16x16x32_bf16 v[136:139], v[160:163], v[160:163], v[136:139]
    s_cmp_ge_u32 s56, 2
    s_cbranch_scc1 L_beta_7
    v_mfma_f32_16x16x32_bf16 v[140:143], a[0:3], v[160:163], v[140:143]
    v_mfma_f32_16x16x32_bf16 v[144:147], a[4:7], v[160:163], v[144:147]
    v_mfma_f32_16x16x32_bf16 v[148:151], a[16:19], v[160:163], v[148:151]
    s_branch L_join_8
L_beta_7:
    v_mfma_f32_16x16x32_bf16 v[140:143], a[20:23], v[160:163], v[140:143]
    v_mfma_f32_16x16x32_bf16 v[144:147], v[160:163], a[32:35], v[144:147]
    v_mfma_f32_16x16x32_bf16 v[148:151], v[160:163], a[36:39], v[148:151]
L_join_8:
    s_waitcnt lgkmcnt(15)
    v_mfma_f32_16x16x32_bf16 v[32:35], a[48:51], v[164:167], v[32:35]
    s_add_u32 m0, s71, 88064
    v_mfma_f32_16x16x32_bf16 v[80:83], a[48:51], v[168:171], v[80:83]
    v_mfma_f32_16x16x32_bf16 v[36:39], a[52:55], v[164:167], v[36:39]
    v_mfma_f32_16x16x32_bf16 v[84:87], a[52:55], v[168:171], v[84:87]
    v_mfma_f32_16x16x32_bf16 v[40:43], a[56:59], v[164:167], v[40:43]
    buffer_load_dwordx4 v6, s[20:23], s68 offen lds
    v_mfma_f32_16x16x32_bf16 v[88:91], a[56:59], v[168:171], v[88:91]
    v_mfma_f32_16x16x32_bf16 v[44:47], a[60:63], v[164:167], v[44:47]
    v_mfma_f32_16x16x32_bf16 v[92:95], a[60:63], v[168:171], v[92:95]
    s_waitcnt lgkmcnt(9)
    v_mfma_f32_16x16x32_bf16 v[48:51], a[64:67], v[164:167], v[48:51]
    s_waitcnt vmcnt(7) lgkmcnt(0)
    s_barrier
    v_mfma_f32_16x16x32_bf16 v[96:99], a[64:67], v[168:171], v[96:99]
    ds_read_b128 v[152:155], v184
    ds_read_b128 v[156:159], v184 offset:2048
    v_mfma_f32_16x16x32_bf16 v[52:55], a[68:71], v[164:167], v[52:55]
    ds_read_b64_tr_b16 a[0:1], v188 offset:0
    ds_read_b64_tr_b16 a[2:3], v188 offset:512
    v_mfma_f32_16x16x32_bf16 v[100:103], a[68:71], v[168:171], v[100:103]
    s_add_u32 m0, s72, 102400
    ds_read_b64_tr_b16 a[4:5], v189 offset:0
    v_mfma_f32_16x16x32_bf16 v[56:59], a[72:75], v[164:167], v[56:59]
    ds_read_b64_tr_b16 a[6:7], v189 offset:512
    ds_read_b64_tr_b16 a[8:9], v190 offset:0
    v_mfma_f32_16x16x32_bf16 v[104:107], a[72:75], v[168:171], v[104:107]
    buffer_load_dwordx4 v11, s[24:27], s70 offen lds
    ds_read_b64_tr_b16 a[10:11], v190 offset:512
    v_mfma_f32_16x16x32_bf16 v[60:63], a[76:79], v[164:167], v[60:63]
    ds_read_b64_tr_b16 a[12:13], v191 offset:0
    ds_read_b64_tr_b16 a[14:15], v191 offset:512
    v_mfma_f32_16x16x32_bf16 v[108:111], a[76:79], v[168:171], v[108:111]
    ds_read_b64_tr_b16 a[16:17], v188 offset:8192
    s_add_u32 m0, s72, 103424
    s_waitcnt lgkmcnt(11)
    v_mfma_f32_16x16x32_bf16 v[64:67], v[164:167], a[80:83], v[64:67]
    ds_read_b64_tr_b16 a[18:19], v188 offset:8704
    ds_read_b64_tr_b16 a[20:21], v189 offset:8192
    v_mfma_f32_16x16x32_bf16 v[112:115], v[168:171], a[80:83], v[112:115]
    ds_read_b64_tr_b16 a[22:23], v189 offset:8704
    buffer_load_dwordx4 v14, s[24:27], s70 offen lds
    s_add_u32 s70, s70, 172032
    v_mfma_f32_16x16x32_bf16 v[68:71], v[164:167], a[84:87], v[68:71]
    ds_read_b64_tr_b16 a[24:25], v190 offset:8192
    ds_read_b64_tr_b16 a[26:27], v190 offset:8704
    v_mfma_f32_16x16x32_bf16 v[116:119], v[168:171], a[84:87], v[116:119]
    ds_read_b64_tr_b16 a[28:29], v191 offset:8192
    s_add_u32 m0, s71, 89088
    v_mfma_f32_16x16x32_bf16 v[72:75], v[164:167], a[88:91], v[72:75]
    ds_read_b64_tr_b16 a[30:31], v191 offset:8704
    ds_read_b64_tr_b16 a[32:33], v188 offset:16384
    v_mfma_f32_16x16x32_bf16 v[120:123], v[168:171], a[88:91], v[120:123]
    ds_read_b64_tr_b16 a[34:35], v188 offset:16896
    ds_read_b64_tr_b16 a[36:37], v189 offset:16384
    v_mfma_f32_16x16x32_bf16 v[76:79], v[164:167], a[92:95], v[76:79]
    buffer_load_dwordx4 v7, s[20:23], s68 offen lds
    s_add_u32 s68, s68, 128
    ds_read_b64_tr_b16 a[38:39], v189 offset:16896
    v_mfma_f32_16x16x32_bf16 v[124:127], v[168:171], a[92:95], v[124:127]
    ds_read_b64_tr_b16 a[40:41], v190 offset:16384
    ds_read_b64_tr_b16 a[42:43], v190 offset:16896
    v_mfma_f32_16x16x32_bf16 v[128:131], v[164:167], v[164:167], v[128:131]
    s_add_u32 m0, s73, 86016
    ds_read_b64_tr_b16 a[44:45], v191 offset:16384
    v_mfma_f32_16x16x32_bf16 v[132:135], v[168:171], v[168:171], v[132:135]
    ds_read_b64_tr_b16 a[46:47], v191 offset:16896
    ds_read_b128 v[160:163], v186
    v_mfma_f32_16x16x32_bf16 v[136:139], v[172:175], v[172:175], v[136:139]
    buffer_load_dwordx4 v8, s[20:23], s69 offen lds
    s_add_u32 s69, s69, 128
    s_cmp_ge_u32 s56, 2
    s_cbranch_scc1 L_beta_9
    v_mfma_f32_16x16x32_bf16 v[140:143], a[48:51], v[172:175], v[140:143]
    v_mfma_f32_16x16x32_bf16 v[144:147], a[52:55], v[172:175], v[144:147]
    v_mfma_f32_16x16x32_bf16 v[148:151], a[64:67], v[172:175], v[148:151]
    s_branch L_join_10
L_beta_9:
    v_mfma_f32_16x16x32_bf16 v[140:143], a[68:71], v[172:175], v[140:143]
    v_mfma_f32_16x16x32_bf16 v[144:147], v[172:175], a[80:83], v[144:147]
    v_mfma_f32_16x16x32_bf16 v[148:151], v[172:175], a[84:87], v[148:151]
L_join_10:
    s_waitcnt lgkmcnt(15)
    v_mfma_f32_16x16x32_bf16 v[32:35], a[0:3], v[152:155], v[32:35]
    ds_read_b128 v[164:167], v185
    ds_read_b128 v[168:171], v185 offset:2048
    v_mfma_f32_16x16x32_bf16 v[80:83], a[0:3], v[156:159], v[80:83]
    ds_read_b64_tr_b16 a[48:49], v188 offset:4096
    v_mfma_f32_16x16x32_bf16 v[36:39], a[4:7], v[152:155], v[36:39]
    s_add_u32 m0, s72, 0
    ds_read_b64_tr_b16 a[50:51], v188 offset:4608
    v_mfma_f32_16x16x32_bf16 v[84:87], a[4:7], v[156:159], v[84:87]
    ds_read_b64_tr_b16 a[52:53], v189 offset:4096
    v_mfma_f32_16x16x32_bf16 v[40:43], a[8:11], v[152:155], v[40:43]
    buffer_load_dwordx4 v9, s[24:27], s70 offen lds
    ds_read_b64_tr_b16 a[54:55], v189 offset:4608
    v_mfma_f32_16x16x32_bf16 v[88:91], a[8:11], v[156:159], v[88:91]
    ds_read_b64_tr_b16 a[56:57], v190 offset:4096
    v_mfma_f32_16x16x32_bf16 v[44:47], a[12:15], v[152:155], v[44:47]
    s_add_u32 m0, s72, 1024
    ds_read_b64_tr_b16 a[58:59], v190 offset:4608
    v_mfma_f32_16x16x32_bf16 v[92:95], a[12:15], v[156:159], v[92:95]
    ds_read_b64_tr_b16 a[60:61], v191 offset:4096
    s_waitcnt lgkmcnt(15)
    v_mfma_f32_16x16x32_bf16 v[48:51], a[16:19], v[152:155], v[48:51]
    buffer_load_dwordx4 v12, s[24:27], s70 offen lds
    ds_read_b64_tr_b16 a[62:63], v191 offset:4608
    v_mfma_f32_16x16x32_bf16 v[96:99], a[16:19], v[156:159], v[96:99]
    ds_read_b64_tr_b16 a[64:65], v188 offset:12288
    v_mfma_f32_16x16x32_bf16 v[52:55], a[20:23], v[152:155], v[52:55]
    ds_read_b64_tr_b16 a[66:67], v188 offset:12800
    s_add_u32 m0, s71, 0
    v_mfma_f32_16x16x32_bf16 v[100:103], a[20:23], v[156:159], v[100:103]
    ds_read_b64_tr_b16 a[68:69], v189 offset:12288
    v_mfma_f32_16x16x32_bf16 v[56:59], a[24:27], v[152:155], v[56:59]
    ds_read_b64_tr_b16 a[70:71], v189 offset:12800
    buffer_load_dwordx4 v4, s[20:23], s68 offen lds
    v_mfma_f32_16x16x32_bf16 v[104:107], a[24:27], v[156:159], v[104:107]
    ds_read_b64_tr_b16 a[72:73], v190 offset:12288
    v_mfma_f32_16x16x32_bf16 v[60:63], a[28:31], v[152:155], v[60:63]
    ds_read_b64_tr_b16 a[74:75], v190 offset:12800
    s_add_u32 m0, s72, 8192
    v_mfma_f32_16x16x32_bf16 v[108:111], a[28:31], v[156:159], v[108:111]
    ds_read_b64_tr_b16 a[76:77], v191 offset:12288
    s_waitcnt lgkmcnt(15)
    v_mfma_f32_16x16x32_bf16 v[64:67], v[152:155], a[32:35], v[64:67]
    ds_read_b64_tr_b16 a[78:79], v191 offset:12800
    buffer_load_dwordx4 v10, s[24:27], s70 offen lds
    v_mfma_f32_16x16x32_bf16 v[112:115], v[156:159], a[32:35], v[112:115]
    ds_read_b64_tr_b16 a[80:81], v188 offset:20480
    v_mfma_f32_16x16x32_bf16 v[68:71], v[152:155], a[36:39], v[68:71]
    ds_read_b64_tr_b16 a[82:83], v188 offset:20992
    ds_read_b64_tr_b16 a[84:85], v189 offset:20480
    v_mfma_f32_16x16x32_bf16 v[116:119], v[156:159], a[36:39], v[116:119]
    s_add_u32 m0, s71, 1024
    v_mfma_f32_16x16x32_bf16 v[72:75], v[152:155], a[40:43], v[72:75]
    ds_read_b64_tr_b16 a[86:87], v189 offset:20992
    ds_read_b64_tr_b16 a[88:89], v190 offset:20480
    v_mfma_f32_16x16x32_bf16 v[120:123], v[156:159], a[40:43], v[120:123]
    buffer_load_dwordx4 v5, s[20:23], s68 offen lds
    v_mfma_f32_16x16x32_bf16 v[76:79], v[152:155], a[44:47], v[76:79]
    ds_read_b64_tr_b16 a[90:91], v190 offset:20992
    ds_read_b64_tr_b16 a[92:93], v191 offset:20480
    v_mfma_f32_16x16x32_bf16 v[124:127], v[156:159], a[44:47], v[124:127]
    s_add_u32 m0, s72, 9216
    v_mfma_f32_16x16x32_bf16 v[128:131], v[152:155], v[152:155], v[128:131]
    ds_read_b64_tr_b16 a[94:95], v191 offset:20992
    ds_read_b128 v[172:175], v187
    v_mfma_f32_16x16x32_bf16 v[132:135], v[156:159], v[156:159], v[132:135]
    buffer_load_dwordx4 v13, s[24:27], s70 offen lds
    v_mfma_f32_16x16x32_bf16 v[136:139], v[160:163], v[160:163], v[136:139]
    s_cmp_ge_u32 s56, 2
    s_cbranch_scc1 L_beta_11
    v_mfma_f32_16x16x32_bf16 v[140:143], a[0:3], v[160:163], v[140:143]
    v_mfma_f32_16x16x32_bf16 v[144:147], a[4:7], v[160:163], v[144:147]
    v_mfma_f32_16x16x32_bf16 v[148:151], a[16:19], v[160:163], v[148:151]
    s_branch L_join_12
L_beta_11:
    v_mfma_f32_16x16x32_bf16 v[140:143], a[20:23], v[160:163], v[140:143]
    v_mfma_f32_16x16x32_bf16 v[144:147], v[160:163], a[32:35], v[144:147]
    v_mfma_f32_16x16x32_bf16 v[148:151], v[160:163], a[36:39], v[148:151]
L_join_12:
    s_waitcnt lgkmcnt(15)
    v_mfma_f32_16x16x32_bf16 v[32:35], a[48:51], v[164:167], v[32:35]
    s_add_u32 m0, s71, 2048
    v_mfma_f32_16x16x32_bf16 v[80:83], a[48:51], v[168:171], v[80:83]
    v_mfma_f32_16x16x32_bf16 v[36:39], a[52:55], v[164:167], v[36:39]
    v_mfma_f32_16x16x32_bf16 v[84:87], a[52:55], v[168:171], v[84:87]
    v_mfma_f32_16x16x32_bf16 v[40:43], a[56:59], v[164:167], v[40:43]
    buffer_load_dwordx4 v6, s[20:23], s68 offen lds
    v_mfma_f32_16x16x32_bf16 v[88:91], a[56:59], v[168:171], v[88:91]
    v_mfma_f32_16x16x32_bf16 v[44:47], a[60:63], v[164:167], v[44:47]
    v_mfma_f32_16x16x32_bf16 v[92:95], a[60:63], v[168:171], v[92:95]
    s_waitcnt lgkmcnt(9)
    v_mfma_f32_16x16x32_bf16 v[48:51], a[64:67], v[164:167], v[48:51]
    s_waitcnt vmcnt(7) lgkmcnt(0)
    s_barrier
    v_mfma_f32_16x16x32_bf16 v[96:99], a[64:67], v[168:171], v[96:99]
    ds_read_b128 v[152:155], v192
    ds_read_b128 v[156:159], v192 offset:2048
    v_mfma_f32_16x16x32_bf16 v[52:55], a[68:71], v[164:167], v[52:55]
    ds_read_b64_tr_b16 a[0:1], v196 offset:0
    ds_read_b64_tr_b16 a[2:3], v196 offset:512
    v_mfma_f32_16x16x32_bf16 v[100:103], a[68:71], v[168:171], v[100:103]
    s_add_u32 m0, s72, 16384
    ds_read_b64_tr_b16 a[4:5], v197 offset:0
    v_mfma_f32_16x16x32_bf16 v[56:59], a[72:75], v[164:167], v[56:59]
    ds_read_b64_tr_b16 a[6:7], v197 offset:512
    ds_read_b64_tr_b16 a[8:9], v198 offset:0
    v_mfma_f32_16x16x32_bf16 v[104:107], a[72:75], v[168:171], v[104:107]
    buffer_load_dwordx4 v11, s[24:27], s70 offen lds
    ds_read_b64_tr_b16 a[10:11], v198 offset:512
    v_mfma_f32_16x16x32_bf16 v[60:63], a[76:79], v[164:167], v[60:63]
    ds_read_b64_tr_b16 a[12:13], v199 offset:0
    ds_read_b64_tr_b16 a[14:15], v199 offset:512
    v_mfma_f32_16x16x32_bf16 v[108:111], a[76:79], v[168:171], v[108:111]
    ds_read_b64_tr_b16 a[16:17], v196 offset:8192
    s_add_u32 m0, s72, 17408
    s_waitcnt lgkmcnt(11)
    v_mfma_f32_16x16x32_bf16 v[64:67], v[164:167], a[80:83], v[64:67]
    ds_read_b64_tr_b16 a[18:19], v196 offset:8704
    ds_read_b64_tr_b16 a[20:21], v197 offset:8192
    v_mfma_f32_16x16x32_bf16 v[112:115], v[168:171], a[80:83], v[112:115]
    ds_read_b64_tr_b16 a[22:23], v197 offset:8704
    buffer_load_dwordx4 v14, s[24:27], s70 offen lds
    s_add_u32 s70, s70, 172032
    v_mfma_f32_16x16x32_bf16 v[68:71], v[164:167], a[84:87], v[68:71]
    ds_read_b64_tr_b16 a[24:25], v198 offset:8192
    ds_read_b64_tr_b16 a[26:27], v198 offset:8704
    v_mfma_f32_16x16x32_bf16 v[116:119], v[168:171], a[84:87], v[116:119]
    ds_read_b64_tr_b16 a[28:29], v199 offset:8192
    s_add_u32 m0, s71, 3072
    v_mfma_f32_16x16x32_bf16 v[72:75], v[164:167], a[88:91], v[72:75]
    ds_read_b64_tr_b16 a[30:31], v199 offset:8704
    ds_read_b64_tr_b16 a[32:33], v196 offset:16384
    v_mfma_f32_16x16x32_bf16 v[120:123], v[168:171], a[88:91], v[120:123]
    ds_read_b64_tr_b16 a[34:35], v196 offset:16896
    ds_read_b64_tr_b16 a[36:37], v197 offset:16384
    v_mfma_f32_16x16x32_bf16 v[76:79], v[164:167], a[92:95], v[76:79]
    buffer_load_dwordx4 v7, s[20:23], s68 offen lds
    s_add_u32 s68, s68, 128
    ds_read_b64_tr_b16 a[38:39], v197 offset:16896
    v_mfma_f32_16x16x32_bf16 v[124:127], v[168:171], a[92:95], v[124:127]
    ds_read_b64_tr_b16 a[40:41], v198 offset:16384
    ds_read_b64_tr_b16 a[42:43], v198 offset:16896
    v_mfma_f32_16x16x32_bf16 v[128:131], v[164:167], v[164:167], v[128:131]
    s_add_u32 m0, s73, 0
    ds_read_b64_tr_b16 a[44:45], v199 offset:16384
    v_mfma_f32_16x16x32_bf16 v[132:135], v[168:171], v[168:171], v[132:135]
    ds_read_b64_tr_b16 a[46:47], v199 offset:16896
    ds_read_b128 v[160:163], v194
    v_mfma_f32_16x16x32_bf16 v[136:139], v[172:175], v[172:175], v[136:139]
    buffer_load_dwordx4 v8, s[20:23], s69 offen lds
    s_add_u32 s69, s69, 128
    s_cmp_ge_u32 s56, 2
    s_cbranch_scc1 L_beta_13
    v_mfma_f32_16x16x32_bf16 v[140:143], a[48:51], v[172:175], v[140:143]
    v_mfma_f32_16x16x32_bf16 v[144:147], a[52:55], v[172:175], v[144:147]
    v_mfma_f32_16x16x32_bf16 v[148:151], a[64:67], v[172:175], v[148:151]
    s_branch L_join_14
L_beta_13:
    v_mfma_f32_16x16x32_bf16 v[140:143], a[68:71], v[172:175], v[140:143]
    v_mfma_f32_16x16x32_bf16 v[144:147], v[172:175], a[80:83], v[144:147]
    v_mfma_f32_16x16x32_bf16 v[148:151], v[172:175], a[84:87], v[148:151]
L_join_14:
    s_waitcnt lgkmcnt(15)
    v_mfma_f32_16x16x32_bf16 v[32:35], a[0:3], v[152:155], v[32:35]
    ds_read_b128 v[164:167], v193
    ds_read_b128 v[168:171], v193 offset:2048
    v_mfma_f32_16x16x32_bf16 v[80:83], a[0:3], v[156:159], v[80:83]
    ds_read_b64_tr_b16 a[48:49], v196 offset:4096
    v_mfma_f32_16x16x32_bf16 v[36:39], a[4:7], v[152:155], v[36:39]
    s_add_u32 m0, s72, 43008
    ds_read_b64_tr_b16 a[50:51], v196 offset:4608
    v_mfma_f32_16x16x32_bf16 v[84:87], a[4:7], v[156:159], v[84:87]
    ds_read_b64_tr_b16 a[52:53], v197 offset:4096
    v_mfma_f32_16x16x32_bf16 v[40:43], a[8:11], v[152:155], v[40:43]
    buffer_load_dwordx4 v9, s[24:27], s70 offen lds
    ds_read_b64_tr_b16 a[54:55], v197 offset:4608
    v_mfma_f32_16x16x32_bf16 v[88:91], a[8:11], v[156:159], v[88:91]
    ds_read_b64_tr_b16 a[56:57], v198 offset:4096
    v_mfma_f32_16x16x32_bf16 v[44:47], a[12:15], v[152:155], v[44:47]
    s_add_u32 m0, s72, 44032
    ds_read_b64_tr_b16 a[58:59], v198 offset:4608
    v_mfma_f32_16x16x32_bf16 v[92:95], a[12:15], v[156:159], v[92:95]
    ds_read_b64_tr_b16 a[60:61], v199 offset:4096
    s_waitcnt lgkmcnt(15)
    v_mfma_f32_16x16x32_bf16 v[48:51], a[16:19], v[152:155], v[48:51]
    buffer_load_dwordx4 v12, s[24:27], s70 offen lds
    ds_read_b64_tr_b16 a[62:63], v199 offset:4608
    v_mfma_f32_16x16x32_bf16 v[96:99], a[16:19], v[156:159], v[96:99]
    ds_read_b64_tr_b16 a[64:65], v196 offset:12288
    v_mfma_f32_16x16x32_bf16 v[52:55], a[20:23], v[152:155], v[52:55]
    ds_read_b64_tr_b16 a[66:67], v196 offset:12800
    s_add_u32 m0, s71, 43008
    v_mfma_f32_16x16x32_bf16 v[100:103], a[20:23], v[156:159], v[100:103]
    ds_read_b64_tr_b16 a[68:69], v197 offset:12288
    v_mfma_f32_16x16x32_bf16 v[56:59], a[24:27], v[152:155], v[56:59]
    ds_read_b64_tr_b16 a[70:71], v197 offset:12800
    buffer_load_dwordx4 v4, s[20:23], s68 offen lds
    v_mfma_f32_16x16x32_bf16 v[104:107], a[24:27], v[156:159], v[104:107]
    ds_read_b64_tr_b16 a[72:73], v198 offset:12288
    v_mfma_f32_16x16x32_bf16 v[60:63], a[28:31], v[152:155], v[60:63]
    ds_read_b64_tr_b16 a[74:75], v198 offset:12800
    s_add_u32 m0, s72, 51200
    v_mfma_f32_16x16x32_bf16 v[108:111], a[28:31], v[156:159], v[108:111]
    ds_read_b64_tr_b16 a[76:77], v199 offset:12288
    s_waitcnt lgkmcnt(15)
    v_mfma_f32_16x16x32_bf16 v[64:67], v[152:155], a[32:35], v[64:67]
    ds_read_b64_tr_b16 a[78:79], v199 offset:12800
    buffer_load_dwordx4 v10, s[24:27], s70 offen lds
    v_mfma_f32_16x16x32_bf16 v[112:115], v[156:159], a[32:35], v[112:115]
    ds_read_b64_tr_b16 a[80:81], v196 offset:20480
    v_mfma_f32_16x16x32_bf16 v[68:71], v[152:155], a[36:39], v[68:71]
    ds_read_b64_tr_b16 a[82:83], v196 offset:20992
    ds_read_b64_tr_b16 a[84:85], v197 offset:20480
    v_mfma_f32_16x16x32_bf16 v[116:119], v[156:159], a[36:39], v[116:119]
    s_add_u32 m0, s71, 44032
    v_mfma_f32_16x16x32_bf16 v[72:75], v[152:155], a[40:43], v[72:75]
    ds_read_b64_tr_b16 a[86:87], v197 offset:20992
    ds_read_b64_tr_b16 a[88:89], v198 offset:20480
    v_mfma_f32_16x16x32_bf16 v[120:123], v[156:159], a[40:43], v[120:123]
    buffer_load_dwordx4 v5, s[20:23], s68 offen lds
    v_mfma_f32_16x16x32_bf16 v[76:79], v[152:155], a[44:47], v[76:79]
    ds_read_b64_tr_b16 a[90:91], v198 offset:20992
    ds_read_b64_tr_b16 a[92:93], v199 offset:20480
    v_mfma_f32_16x16x32_bf16 v[124:127], v[156:159], a[44:47], v[124:127]
    s_add_u32 m0, s72, 52224
    v_mfma_f32_16x16x32_bf16 v[128:131], v[152:155], v[152:155], v[128:131]
    ds_read_b64_tr_b16 a[94:95], v199 offset:20992
    ds_read_b128 v[172:175], v195
    v_mfma_f32_16x16x32_bf16 v[132:135], v[156:159], v[156:159], v[132:135]
    buffer_load_dwordx4 v13, s[24:27], s70 offen lds
    v_mfma_f32_16x16x32_bf16 v[136:139], v[160:163], v[160:163], v[136:139]
    s_cmp_ge_u32 s56, 2
    s_cbranch_scc1 L_beta_15
    v_mfma_f32_16x16x32_bf16 v[140:143], a[0:3], v[160:163], v[140:143]
    v_mfma_f32_16x16x32_bf16 v[144:147], a[4:7], v[160:163], v[144:147]
    v_mfma_f32_16x16x32_bf16 v[148:151], a[16:19], v[160:163], v[148:151]
    s_branch L_join_16
L_beta_15:
    v_mfma_f32_16x16x32_bf16 v[140:143], a[20:23], v[160:163], v[140:143]
    v_mfma_f32_16x16x32_bf16 v[144:147], v[160:163], a[32:35], v[144:147]
    v_mfma_f32_16x16x32_bf16 v[148:151], v[160:163], a[36:39], v[148:151]
L_join_16:
    s_waitcnt lgkmcnt(15)
    v_mfma_f32_16x16x32_bf16 v[32:35], a[48:51], v[164:167], v[32:35]
    s_add_u32 m0, s71, 45056
    v_mfma_f32_16x16x32_bf16 v[80:83], a[48:51], v[168:171], v[80:83]
    v_mfma_f32_16x16x32_bf16 v[36:39], a[52:55], v[164:167], v[36:39]
    v_mfma_f32_16x16x32_bf16 v[84:87], a[52:55], v[168:171], v[84:87]
    v_mfma_f32_16x16x32_bf16 v[40:43], a[56:59], v[164:167], v[40:43]
    buffer_load_dwordx4 v6, s[20:23], s68 offen lds
    v_mfma_f32_16x16x32_bf16 v[88:91], a[56:59], v[168:171], v[88:91]
    v_mfma_f32_16x16x32_bf16 v[44:47], a[60:63], v[164:167], v[44:47]
    v_mfma_f32_16x16x32_bf16 v[92:95], a[60:63], v[168:171], v[92:95]
    s_waitcnt lgkmcnt(9)
    v_mfma_f32_16x16x32_bf16 v[48:51], a[64:67], v[164:167], v[48:51]
    s_waitcnt vmcnt(7) lgkmcnt(0)
    s_barrier
    v_mfma_f32_16x16x32_bf16 v[96:99], a[64:67], v[168:171], v[96:99]
    ds_read_b128 v[152:155], v176
    ds_read_b128 v[156:159], v176 offset:2048
    v_mfma_f32_16x16x32_bf16 v[52:55], a[68:71], v[164:167], v[52:55]
    ds_read_b64_tr_b16 a[0:1], v180 offset:0
    ds_read_b64_tr_b16 a[2:3], v180 offset:512
    v_mfma_f32_16x16x32_bf16 v[100:103], a[68:71], v[168:171], v[100:103]
    s_add_u32 m0, s72, 59392
    ds_read_b64_tr_b16 a[4:5], v181 offset:0
    v_mfma_f32_16x16x32_bf16 v[56:59], a[72:75], v[164:167], v[56:59]
    ds_read_b64_tr_b16 a[6:7], v181 offset:512
    ds_read_b64_tr_b16 a[8:9], v182 offset:0
    v_mfma_f32_16x16x32_bf16 v[104:107], a[72:75], v[168:171], v[104:107]
    buffer_load_dwordx4 v11, s[24:27], s70 offen lds
    ds_read_b64_tr_b16 a[10:11], v182 offset:512
    v_mfma_f32_16x16x32_bf16 v[60:63], a[76:79], v[164:167], v[60:63]
    ds_read_b64_tr_b16 a[12:13], v183 offset:0
    ds_read_b64_tr_b16 a[14:15], v183 offset:512
    v_mfma_f32_16x16x32_bf16 v[108:111], a[76:79], v[168:171], v[108:111]
    ds_read_b64_tr_b16 a[16:17], v180 offset:8192
    s_add_u32 m0, s72, 60416
    s_waitcnt lgkmcnt(11)
    v_mfma_f32_16x16x32_bf16 v[64:67], v[164:167], a[80:83], v[64:67]
    ds_read_b64_tr_b16 a[18:19], v180 offset:8704
    ds_read_b64_tr_b16 a[20:21], v181 offset:8192
    v_mfma_f32_16x16x32_bf16 v[112:115], v[168:171], a[80:83], v[112:115]
    ds_read_b64_tr_b16 a[22:23], v181 offset:8704
    buffer_load_dwordx4 v14, s[24:27], s70 offen lds
    s_add_u32 s70, s70, 172032
    v_mfma_f32_16x16x32_bf16 v[68:71], v[164:167], a[84:87], v[68:71]
    ds_read_b64_tr_b16 a[24:25], v182 offset:8192
    ds_read_b64_tr_b16 a[26:27], v182 offset:8704
    v_mfma_f32_16x16x32_bf16 v[116:119], v[168:171], a[84:87], v[116:119]
    ds_read_b64_tr_b16 a[28:29], v183 offset:8192
    s_add_u32 m0, s71, 46080
    v_mfma_f32_16x16x32_bf16 v[72:75], v[164:167], a[88:91], v[72:75]
    ds_read_b64_tr_b16 a[30:31], v183 offset:8704
    ds_read_b64_tr_b16 a[32:33], v180 offset:16384
    v_mfma_f32_16x16x32_bf16 v[120:123], v[168:171], a[88:91], v[120:123]
    ds_read_b64_tr_b16 a[34:35], v180 offset:16896
    ds_read_b64_tr_b16 a[36:37], v181 offset:16384
    v_mfma_f32_16x16x32_bf16 v[76:79], v[164:167], a[92:95], v[76:79]
    buffer_load_dwordx4 v7, s[20:23], s68 offen lds
    s_add_u32 s68, s68, 128
    ds_read_b64_tr_b16 a[38:39], v181 offset:16896
    v_mfma_f32_16x16x32_bf16 v[124:127], v[168:171], a[92:95], v[124:127]
    ds_read_b64_tr_b16 a[40:41], v182 offset:16384
    ds_read_b64_tr_b16 a[42:43], v182 offset:16896
    v_mfma_f32_16x16x32_bf16 v[128:131], v[164:167], v[164:167], v[128:131]
    s_add_u32 m0, s73, 43008
    ds_read_b64_tr_b16 a[44:45], v183 offset:16384
    v_mfma_f32_16x16x32_bf16 v[132:135], v[168:171], v[168:171], v[132:135]
    ds_read_b64_tr_b16 a[46:47], v183 offset:16896
    ds_read_b128 v[160:163], v178
    v_mfma_f32_16x16x32_bf16 v[136:139], v[172:175], v[172:175], v[136:139]
    buffer_load_dwordx4 v8, s[20:23], s69 offen lds
    s_add_u32 s69, s69, 128
    s_cmp_ge_u32 s56, 2
    s_cbranch_scc1 L_beta_17
    v_mfma_f32_16x16x32_bf16 v[140:143], a[48:51], v[172:175], v[140:143]
    v_mfma_f32_16x16x32_bf16 v[144:147], a[52:55], v[172:175], v[144:147]
    v_mfma_f32_16x16x32_bf16 v[148:151], a[64:67], v[172:175], v[148:151]
    s_branch L_join_18
L_beta_17:
    v_mfma_f32_16x16x32_bf16 v[140:143], a[68:71], v[172:175], v[140:143]
    v_mfma_f32_16x16x32_bf16 v[144:147], v[172:175], a[80:83], v[144:147]
    v_mfma_f32_16x16x32_bf16 v[148:151], v[172:175], a[84:87], v[148:151]
L_join_18:
    s_waitcnt lgkmcnt(15)
    v_mfma_f32_16x16x32_bf16 v[32:35], a[0:3], v[152:155], v[32:35]
    ds_read_b128 v[164:167], v177
    ds_read_b128 v[168:171], v177 offset:2048
    v_mfma_f32_16x16x32_bf16 v[80:83], a[0:3], v[156:159], v[80:83]
    ds_read_b64_tr_b16 a[48:49], v180 offset:4096
    v_mfma_f32_16x16x32_bf16 v[36:39], a[4:7], v[152:155], v[36:39]
    s_add_u32 m0, s72, 86016
    ds_read_b64_tr_b16 a[50:51], v180 offset:4608
    v_mfma_f32_16x16x32_bf16 v[84:87], a[4:7], v[156:159], v[84:87]
    ds_read_b64_tr_b16 a[52:53], v181 offset:4096
    v_mfma_f32_16x16x32_bf16 v[40:43], a[8:11], v[152:155], v[40:43]
    buffer_load_dwordx4 v9, s[24:27], s70 offen lds
    ds_read_b64_tr_b16 a[54:55], v181 offset:4608
    v_mfma_f32_16x16x32_bf16 v[88:91], a[8:11], v[156:159], v[88:91]
    ds_read_b64_tr_b16 a[56:57], v182 offset:4096
    v_mfma_f32_16x16x32_bf16 v[44:47], a[12:15], v[152:155], v[44:47]
    s_add_u32 m0, s72, 87040
    ds_read_b64_tr_b16 a[58:59], v182 offset:4608
    v_mfma_f32_16x16x32_bf16 v[92:95], a[12:15], v[156:159], v[92:95]
    ds_read_b64_tr_b16 a[60:61], v183 offset:4096
    s_waitcnt lgkmcnt(15)
    v_mfma_f32_16x16x32_bf16 v[48:51], a[16:19], v[152:155], v[48:51]
    buffer_load_dwordx4 v12, s[24:27], s70 offen lds
    ds_read_b64_tr_b16 a[62:63], v183 offset:4608
    v_mfma_f32_16x16x32_bf16 v[96:99], a[16:19], v[156:159], v[96:99]
    ds_read_b64_tr_b16 a[64:65], v180 offset:12288
    v_mfma_f32_16x16x32_bf16 v[52:55], a[20:23], v[152:155], v[52:55]
    ds_read_b64_tr_b16 a[66:67], v180 offset:12800
    s_add_u32 m0, s71, 86016
    v_mfma_f32_16x16x32_bf16 v[100:103], a[20:23], v[156:159], v[100:103]
    ds_read_b64_tr_b16 a[68:69], v181 offset:12288
    v_mfma_f32_16x16x32_bf16 v[56:59], a[24:27], v[152:155], v[56:59]
    ds_read_b64_tr_b16 a[70:71], v181 offset:12800
    buffer_load_dwordx4 v4, s[20:23], s68 offen lds
    v_mfma_f32_16x16x32_bf16 v[104:107], a[24:27], v[156:159], v[104:107]
    ds_read_b64_tr_b16 a[72:73], v182 offset:12288
    v_mfma_f32_16x16x32_bf16 v[60:63], a[28:31], v[152:155], v[60:63]
    ds_read_b64_tr_b16 a[74:75], v182 offset:12800
    s_add_u32 m0, s72, 94208
    v_mfma_f32_16x16x32_bf16 v[108:111], a[28:31], v[156:159], v[108:111]
    ds_read_b64_tr_b16 a[76:77], v183 offset:12288
    s_waitcnt lgkmcnt(15)
    v_mfma_f32_16x16x32_bf16 v[64:67], v[152:155], a[32:35], v[64:67]
    ds_read_b64_tr_b16 a[78:79], v183 offset:12800
    buffer_load_dwordx4 v10, s[24:27], s70 offen lds
    v_mfma_f32_16x16x32_bf16 v[112:115], v[156:159], a[32:35], v[112:115]
    ds_read_b64_tr_b16 a[80:81], v180 offset:20480
    v_mfma_f32_16x16x32_bf16 v[68:71], v[152:155], a[36:39], v[68:71]
    ds_read_b64_tr_b16 a[82:83], v180 offset:20992
    ds_read_b64_tr_b16 a[84:85], v181 offset:20480
    v_mfma_f32_16x16x32_bf16 v[116:119], v[156:159], a[36:39], v[116:119]
    s_add_u32 m0, s71, 87040
    v_mfma_f32_16x16x32_bf16 v[72:75], v[152:155], a[40:43], v[72:75]
    ds_read_b64_tr_b16 a[86:87], v181 offset:20992
    ds_read_b64_tr_b16 a[88:89], v182 offset:20480
    v_mfma_f32_16x16x32_bf16 v[120:123], v[156:159], a[40:43], v[120:123]
    buffer_load_dwordx4 v5, s[20:23], s68 offen lds
    v_mfma_f32_16x16x32_bf16 v[76:79], v[152:155], a[44:47], v[76:79]
    ds_read_b64_tr_b16 a[90:91], v182 offset:20992
    ds_read_b64_tr_b16 a[92:93], v183 offset:20480
    v_mfma_f32_16x16x32_bf16 v[124:127], v[156:159], a[44:47], v[124:127]
    s_add_u32 m0, s72, 95232
    v_mfma_f32_16x16x32_bf16 v[128:131], v[152:155], v[152:155], v[128:131]
    ds_read_b64_tr_b16 a[94:95], v183 offset:20992
    ds_read_b128 v[172:175], v179
    v_mfma_f32_16x16x32_bf16 v[132:135], v[156:159], v[156:159], v[132:135]
    buffer_load_dwordx4 v13, s[24:27], s70 offen lds
    v_mfma_f32_16x16x32_bf16 v[136:139], v[160:163], v[160:163], v[136:139]
    s_cmp_ge_u32 s56, 2
    s_cbranch_scc1 L_beta_19
    v_mfma_f32_16x16x32_bf16 v[140:143], a[0:3], v[160:163], v[140:143]
    v_mfma_f32_16x16x32_bf16 v[144:147], a[4:7], v[160:163], v[144:147]
    v_mfma_f32_16x16x32_bf16 v[148:151], a[16:19], v[160:163], v[148:151]
    s_branch L_join_20
L_beta_19:
    v_mfma_f32_16x16x32_bf16 v[140:143], a[20:23], v[160:163], v[140:143]
    v_mfma_f32_16x16x32_bf16 v[144:147], v[160:163], a[32:35], v[144:147]
    v_mfma_f32_16x16x32_bf16 v[148:151], v[160:163], a[36:39], v[148:151]
L_join_20:
    s_waitcnt lgkmcnt(15)
    v_mfma_f32_16x16x32_bf16 v[32:35], a[48:51], v[164:167], v[32:35]
    s_add_u32 m0, s71, 88064
    v_mfma_f32_16x16x32_bf16 v[80:83], a[48:51], v[168:171], v[80:83]
    v_mfma_f32_16x16x32_bf16 v[36:39], a[52:55], v[164:167], v[36:39]
    v_mfma_f32_16x16x32_bf16 v[84:87], a[52:55], v[168:171], v[84:87]
    v_mfma_f32_16x16x32_bf16 v[40:43], a[56:59], v[164:167], v[40:43]
    buffer_load_dwordx4 v6, s[20:23], s68 offen lds
    v_mfma_f32_16x16x32_bf16 v[88:91], a[56:59], v[168:171], v[88:91]
    v_mfma_f32_16x16x32_bf16 v[44:47], a[60:63], v[164:167], v[44:47]
    v_mfma_f32_16x16x32_bf16 v[92:95], a[60:63], v[168:171], v[92:95]
    s_waitcnt lgkmcnt(9)
    v_mfma_f32_16x16x32_bf16 v[48:51], a[64:67], v[164:167], v[48:51]
    s_waitcnt vmcnt(7) lgkmcnt(0)
    s_barrier
    v_mfma_f32_16x16x32_bf16 v[96:99], a[64:67], v[168:171], v[96:99]
    ds_read_b128 v[152:155], v184
    ds_read_b128 v[156:159], v184 offset:2048
    v_mfma_f32_16x16x32_bf16 v[52:55], a[68:71], v[164:167], v[52:55]
    ds_read_b64_tr_b16 a[0:1], v188 offset:0
    ds_read_b64_tr_b16 a[2:3], v188 offset:512
    v_mfma_f32_16x16x32_bf16 v[100:103], a[68:71], v[168:171], v[100:103]
    s_add_u32 m0, s72, 102400
    ds_read_b64_tr_b16 a[4:5], v189 offset:0
    v_mfma_f32_16x16x32_bf16 v[56:59], a[72:75], v[164:167], v[56:59]
    ds_read_b64_tr_b16 a[6:7], v189 offset:512
    ds_read_b64_tr_b16 a[8:9], v190 offset:0
    v_mfma_f32_16x16x32_bf16 v[104:107], a[72:75], v[168:171], v[104:107]
    buffer_load_dwordx4 v11, s[24:27], s70 offen lds
    ds_read_b64_tr_b16 a[10:11], v190 offset:512
    v_mfma_f32_16x16x32_bf16 v[60:63], a[76:79], v[164:167], v[60:63]
    ds_read_b64_tr_b16 a[12:13], v191 offset:0
    ds_read_b64_tr_b16 a[14:15], v191 offset:512
    v_mfma_f32_16x16x32_bf16 v[108:111], a[76:79], v[168:171], v[108:111]
    ds_read_b64_tr_b16 a[16:17], v188 offset:8192
    s_add_u32 m0, s72, 103424
    s_waitcnt lgkmcnt(11)
    v_mfma_f32_16x16x32_bf16 v[64:67], v[164:167], a[80:83], v[64:67]
    ds_read_b64_tr_b16 a[18:19], v188 offset:8704
    ds_read_b64_tr_b16 a[20:21], v189 offset:8192
    v_mfma_f32_16x16x32_bf16 v[112:115], v[168:171], a[80:83], v[112:115]
    ds_read_b64_tr_b16 a[22:23], v189 offset:8704
    buffer_load_dwordx4 v14, s[24:27], s70 offen lds
    s_add_u32 s70, s70, 172032
    v_mfma_f32_16x16x32_bf16 v[68:71], v[164:167], a[84:87], v[68:71]
    ds_read_b64_tr_b16 a[24:25], v190 offset:8192
    ds_read_b64_tr_b16 a[26:27], v190 offset:8704
    v_mfma_f32_16x16x32_bf16 v[116:119], v[168:171], a[84:87], v[116:119]
    ds_read_b64_tr_b16 a[28:29], v191 offset:8192
    s_add_u32 m0, s71, 89088
    v_mfma_f32_16x16x32_bf16 v[72:75], v[164:167], a[88:91], v[72:75]
    ds_read_b64_tr_b16 a[30:31], v191 offset:8704
    ds_read_b64_tr_b16 a[32:33], v188 offset:16384
    v_mfma_f32_16x16x32_bf16 v[120:123], v[168:171], a[88:91], v[120:123]
    ds_read_b64_tr_b16 a[34:35], v188 offset:16896
    ds_read_b64_tr_b16 a[36:37], v189 offset:16384
    v_mfma_f32_16x16x32_bf16 v[76:79], v[164:167], a[92:95], v[76:79]
    buffer_load_dwordx4 v7, s[20:23], s68 offen lds
    s_add_u32 s68, s68, 128
    ds_read_b64_tr_b16 a[38:39], v189 offset:16896
    v_mfma_f32_16x16x32_bf16 v[124:127], v[168:171], a[92:95], v[124:127]
    ds_read_b64_tr_b16 a[40:41], v190 offset:16384
    ds_read_b64_tr_b16 a[42:43], v190 offset:16896
    v_mfma_f32_16x16x32_bf16 v[128:131], v[164:167], v[164:167], v[128:131]
    s_add_u32 m0, s73, 86016
    ds_read_b64_tr_b16 a[44:45], v191 offset:16384
    v_mfma_f32_16x16x32_bf16 v[132:135], v[168:171], v[168:171], v[132:135]
    ds_read_b64_tr_b16 a[46:47], v191 offset:16896
    ds_read_b128 v[160:163], v186
    v_mfma_f32_16x16x32_bf16 v[136:139], v[172:175], v[172:175], v[136:139]
    buffer_load_dwordx4 v8, s[20:23], s69 offen lds
    s_add_u32 s69, s69, 128
    s_cmp_ge_u32 s56, 2
    s_cbranch_scc1 L_beta_21
    v_mfma_f32_16x16x32_bf16 v[140:143], a[48:51], v[172:175], v[140:143]
    v_mfma_f32_16x16x32_bf16 v[144:147], a[52:55], v[172:175], v[144:147]
    v_mfma_f32_16x16x32_bf16 v[148:151], a[64:67], v[172:175], v[148:151]
    s_branch L_join_22
L_beta_21:
    v_mfma_f32_16x16x32_bf16 v[140:143], a[68:71], v[172:175], v[140:143]
    v_mfma_f32_16x16x32_bf16 v[144:147], v[172:175], a[80:83], v[144:147]
    v_mfma_f32_16x16x32_bf16 v[148:151], v[172:175], a[84:87], v[148:151]
L_join_22:
    s_waitcnt lgkmcnt(15)
    v_mfma_f32_16x16x32_bf16 v[32:35], a[0:3], v[152:155], v[32:35]
    ds_read_b128 v[164:167], v185
    ds_read_b128 v[168:171], v185 offset:2048
    v_mfma_f32_16x16x32_bf16 v[80:83], a[0:3], v[156:159], v[80:83]
    ds_read_b64_tr_b16 a[48:49], v188 offset:4096
    v_mfma_f32_16x16x32_bf16 v[36:39], a[4:7], v[152:155], v[36:39]
    ds_read_b64_tr_b16 a[50:51], v188 offset:4608
    v_mfma_f32_16x16x32_bf16 v[84:87], a[4:7], v[156:159], v[84:87]
    ds_read_b64_tr_b16 a[52:53], v189 offset:4096
    v_mfma_f32_16x16x32_bf16 v[40:43], a[8:11], v[152:155], v[40:43]
    ds_read_b64_tr_b16 a[54:55], v189 offset:4608
    v_mfma_f32_16x16x32_bf16 v[88:91], a[8:11], v[156:159], v[88:91]
    ds_read_b64_tr_b16 a[56:57], v190 offset:4096
    v_mfma_f32_16x16x32_bf16 v[44:47], a[12:15], v[152:155], v[44:47]
    ds_read_b64_tr_b16 a[58:59], v190 offset:4608
    v_mfma_f32_16x16x32_bf16 v[92:95], a[12:15], v[156:159], v[92:95]
    ds_read_b64_tr_b16 a[60:61], v191 offset:4096
    s_waitcnt lgkmcnt(15)
    v_mfma_f32_16x16x32_bf16 v[48:51], a[16:19], v[152:155], v[48:51]
    ds_read_b64_tr_b16 a[62:63], v191 offset:4608
    v_mfma_f32_16x16x32_bf16 v[96:99], a[16:19], v[156:159], v[96:99]
    ds_read_b64_tr_b16 a[64:65], v188 offset:12288
    v_mfma_f32_16x16x32_bf16 v[52:55], a[20:23], v[152:155], v[52:55]
    ds_read_b64_tr_b16 a[66:67], v188 offset:12800
    v_mfma_f32_16x16x32_bf16 v[100:103], a[20:23], v[156:159], v[100:103]
    ds_read_b64_tr_b16 a[68:69], v189 offset:12288
    v_mfma_f32_16x16x32_bf16 v[56:59], a[24:27], v[152:155], v[56:59]
    ds_read_b64_tr_b16 a[70:71], v189 offset:12800
    v_mfma_f32_16x16x32_bf16 v[104:107], a[24:27], v[156:159], v[104:107]
    ds_read_b64_tr_b16 a[72:73], v190 offset:12288
    v_mfma_f32_16x16x32_bf16 v[60:63], a[28:31], v[152:155], v[60:63]
    ds_read_b64_tr_b16 a[74:75], v190 offset:12800
    v_mfma_f32_16x16x32_bf16 v[108:111], a[28:31], v[156:159], v[108:111]
    ds_read_b64_tr_b16 a[76:77], v191 offset:12288
    s_waitcnt lgkmcnt(15)
    v_mfma_f32_16x16x32_bf16 v[64:67], v[152:155], a[32:35], v[64:67]
    ds_read_b64_tr_b16 a[78:79], v191 offset:12800
    v_mfma_f32_16x16x32_bf16 v[112:115], v[156:159], a[32:35], v[112:115]
    ds_read_b64_tr_b16 a[80:81], v188 offset:20480
    v_mfma_f32_16x16x32_bf16 v[68:71], v[152:155], a[36:39], v[68:71]
    ds_read_b64_tr_b16 a[82:83], v188 offset:20992
    v_mfma_f32_16x16x32_bf16 v[116:119], v[156:159], a[36:39], v[116:119]
    ds_read_b64_tr_b16 a[84:85], v189 offset:20480
    v_mfma_f32_16x16x32_bf16 v[72:75], v[152:155], a[40:43], v[72:75]
    ds_read_b64_tr_b16 a[86:87], v189 offset:20992
    v_mfma_f32_16x16x32_bf16 v[120:123], v[156:159], a[40:43], v[120:123]
    ds_read_b64_tr_b16 a[88:89], v190 offset:20480
    v_mfma_f32_16x16x32_bf16 v[76:79], v[152:155], a[44:47], v[76:79]
    ds_read_b64_tr_b16 a[90:91], v190 offset:20992
    v_mfma_f32_16x16x32_bf16 v[124:127], v[156:159], a[44:47], v[124:127]
    ds_read_b64_tr_b16 a[92:93], v191 offset:20480
    v_mfma_f32_16x16x32_bf16 v[128:131], v[152:155], v[152:155], v[128:131]
    ds_read_b64_tr_b16 a[94:95], v191 offset:20992
    v_mfma_f32_16x16x32_bf16 v[132:135], v[156:159], v[156:159], v[132:135]
    ds_read_b128 v[172:175], v187
    v_mfma_f32_16x16x32_bf16 v[136:139], v[160:163], v[160:163], v[136:139]
    s_cmp_ge_u32 s56, 2
    s_cbranch_scc1 L_beta_23
    v_mfma_f32_16x16x32_bf16 v[140:143], a[0:3], v[160:163], v[140:143]
    v_mfma_f32_16x16x32_bf16 v[144:147], a[4:7], v[160:163], v[144:147]
    v_mfma_f32_16x16x32_bf16 v[148:151], a[16:19], v[160:163], v[148:151]
    s_branch L_join_24
L_beta_23:
    v_mfma_f32_16x16x32_bf16 v[140:143], a[20:23], v[160:163], v[140:143]
    v_mfma_f32_16x16x32_bf16 v[144:147], v[160:163], a[32:35], v[144:147]
    v_mfma_f32_16x16x32_bf16 v[148:151], v[160:163], a[36:39], v[148:151]
L_join_24:
    s_waitcnt lgkmcnt(15)
    v_mfma_f32_16x16x32_bf16 v[32:35], a[48:51], v[164:167], v[32:35]
    v_mfma_f32_16x16x32_bf16 v[80:83], a[48:51], v[168:171], v[80:83]
    v_mfma_f32_16x16x32_bf16 v[36:39], a[52:55], v[164:167], v[36:39]
    v_mfma_f32_16x16x32_bf16 v[84:87], a[52:55], v[168:171], v[84:87]
    v_mfma_f32_16x16x32_bf16 v[40:43], a[56:59], v[164:167], v[40:43]
    v_mfma_f32_16x16x32_bf16 v[88:91], a[56:59], v[168:171], v[88:91]
    v_mfma_f32_16x16x32_bf16 v[44:47], a[60:63], v[164:167], v[44:47]
    v_mfma_f32_16x16x32_bf16 v[92:95], a[60:63], v[168:171], v[92:95]
    s_waitcnt lgkmcnt(9)
    v_mfma_f32_16x16x32_bf16 v[48:51], a[64:67], v[164:167], v[48:51]
    s_waitcnt vmcnt(0) lgkmcnt(0)
    s_barrier
    s_lshl_b32 s9, s66, 2
    s_add_u32 s9, s9, s56
    s_lshl_b32 s9, s9, 8
    s_add_u32 s9, s9, 196608
    v_and_b32 v247, 1, v1
    v_lshlrev_b32 v247, 7, v247
    v_mfma_f32_16x16x32_bf16 v[96:99], a[64:67], v[168:171], v[96:99]
    ds_read_b128 v[152:155], v192
    ds_read_b128 v[156:159], v192 offset:2048
    v_mfma_f32_16x16x32_bf16 v[52:55], a[68:71], v[164:167], v[52:55]
    ds_read_b64_tr_b16 a[0:1], v196 offset:0
    v_mfma_f32_16x16x32_bf16 v[100:103], a[68:71], v[168:171], v[100:103]
    ds_read_b64_tr_b16 a[2:3], v196 offset:512
    ds_read_b64_tr_b16 a[4:5], v197 offset:0
    v_mfma_f32_16x16x32_bf16 v[56:59], a[72:75], v[164:167], v[56:59]
    ds_read_b64_tr_b16 a[6:7], v197 offset:512
    v_mfma_f32_16x16x32_bf16 v[104:107], a[72:75], v[168:171], v[104:107]
    ds_read_b64_tr_b16 a[8:9], v198 offset:0
    ds_read_b64_tr_b16 a[10:11], v198 offset:512
    v_mfma_f32_16x16x32_bf16 v[60:63], a[76:79], v[164:167], v[60:63]
    ds_read_b64_tr_b16 a[12:13], v199 offset:0
    v_mfma_f32_16x16x32_bf16 v[108:111], a[76:79], v[168:171], v[108:111]
    ds_read_b64_tr_b16 a[14:15], v199 offset:512
    ds_read_b64_tr_b16 a[16:17], v196 offset:8192
    s_waitcnt lgkmcnt(11)
    v_mfma_f32_16x16x32_bf16 v[64:67], v[164:167], a[80:83], v[64:67]
    ds_read_b64_tr_b16 a[18:19], v196 offset:8704
    v_mfma_f32_16x16x32_bf16 v[112:115], v[168:171], a[80:83], v[112:115]
    ds_read_b64_tr_b16 a[20:21], v197 offset:8192
    ds_read_b64_tr_b16 a[22:23], v197 offset:8704
    v_mfma_f32_16x16x32_bf16 v[68:71], v[164:167], a[84:87], v[68:71]
    ds_read_b64_tr_b16 a[24:25], v198 offset:8192
    v_mfma_f32_16x16x32_bf16 v[116:119], v[168:171], a[84:87], v[116:119]
    ds_read_b64_tr_b16 a[26:27], v198 offset:8704
    ds_read_b64_tr_b16 a[28:29], v199 offset:8192
    v_mfma_f32_16x16x32_bf16 v[72:75], v[164:167], a[88:91], v[72:75]
    ds_read_b64_tr_b16 a[30:31], v199 offset:8704
    v_mfma_f32_16x16x32_bf16 v[120:123], v[168:171], a[88:91], v[120:123]
    ds_read_b64_tr_b16 a[32:33], v196 offset:16384
    ds_read_b64_tr_b16 a[34:35], v196 offset:16896
    v_mfma_f32_16x16x32_bf16 v[76:79], v[164:167], a[92:95], v[76:79]
    ds_read_b64_tr_b16 a[36:37], v197 offset:16384
    v_mfma_f32_16x16x32_bf16 v[124:127], v[168:171], a[92:95], v[124:127]
    ds_read_b64_tr_b16 a[38:39], v197 offset:16896
    ds_read_b64_tr_b16 a[40:41], v198 offset:16384
    v_mfma_f32_16x16x32_bf16 v[128:131], v[164:167], v[164:167], v[128:131]
    ds_read_b64_tr_b16 a[42:43], v198 offset:16896
    v_mfma_f32_16x16x32_bf16 v[132:135], v[168:171], v[168:171], v[132:135]
    ds_read_b64_tr_b16 a[44:45], v199 offset:16384
    ds_read_b64_tr_b16 a[46:47], v199 offset:16896
    v_mfma_f32_16x16x32_bf16 v[136:139], v[172:175], v[172:175], v[136:139]
    ds_read_b128 v[160:163], v194
    s_cmp_ge_u32 s56, 2
    s_cbranch_scc1 L_beta_25
    v_mfma_f32_16x16x32_bf16 v[140:143], a[48:51], v[172:175], v[140:143]
    v_mfma_f32_16x16x32_bf16 v[144:147], a[52:55], v[172:175], v[144:147]
    v_mfma_f32_16x16x32_bf16 v[148:151], a[64:67], v[172:175], v[148:151]
    s_branch L_join_26
L_beta_25:
    v_mfma_f32_16x16x32_bf16 v[140:143], a[68:71], v[172:175], v[140:143]
    v_mfma_f32_16x16x32_bf16 v[144:147], v[172:175], a[80:83], v[144:147]
    v_mfma_f32_16x16x32_bf16 v[148:151], v[172:175], a[84:87], v[148:151]
L_join_26:
    s_waitcnt lgkmcnt(15)
    v_mfma_f32_16x16x32_bf16 v[32:35], a[0:3], v[152:155], v[32:35]
    ds_read_b128 v[164:167], v193
    ds_read_b128 v[168:171], v193 offset:2048
    v_mfma_f32_16x16x32_bf16 v[80:83], a[0:3], v[156:159], v[80:83]
    ds_read_b64_tr_b16 a[48:49], v196 offset:4096
    v_mfma_f32_16x16x32_bf16 v[36:39], a[4:7], v[152:155], v[36:39]
    ds_read_b64_tr_b16 a[50:51], v196 offset:4608
    v_mfma_f32_16x16x32_bf16 v[84:87], a[4:7], v[156:159], v[84:87]
    ds_read_b64_tr_b16 a[52:53], v197 offset:4096
    v_mfma_f32_16x16x32_bf16 v[40:43], a[8:11], v[152:155], v[40:43]
    ds_read_b64_tr_b16 a[54:55], v197 offset:4608
    v_mfma_f32_16x16x32_bf16 v[88:91], a[8:11], v[156:159], v[88:91]
    ds_read_b64_tr_b16 a[56:57], v198 offset:4096
    v_mfma_f32_16x16x32_bf16 v[44:47], a[12:15], v[152:155], v[44:47]
    ds_read_b64_tr_b16 a[58:59], v198 offset:4608
    v_mfma_f32_16x16x32_bf16 v[92:95], a[12:15], v[156:159], v[92:95]
    ds_read_b64_tr_b16 a[60:61], v199 offset:4096
    s_waitcnt lgkmcnt(15)
    v_mfma_f32_16x16x32_bf16 v[48:51], a[16:19], v[152:155], v[48:51]
    ds_read_b64_tr_b16 a[62:63], v199 offset:4608
    v_mfma_f32_16x16x32_bf16 v[96:99], a[16:19], v[156:159], v[96:99]
    ds_read_b64_tr_b16 a[64:65], v196 offset:12288
    v_mfma_f32_16x16x32_bf16 v[52:55], a[20:23], v[152:155], v[52:55]
    ds_read_b64_tr_b16 a[66:67], v196 offset:12800
    v_mfma_f32_16x16x32_bf16 v[100:103], a[20:23], v[156:159], v[100:103]
    ds_read_b64_tr_b16 a[68:69], v197 offset:12288
    v_mfma_f32_16x16x32_bf16 v[56:59], a[24:27], v[152:155], v[56:59]
    ds_read_b64_tr_b16 a[70:71], v197 offset:12800
    v_mfma_f32_16x16x32_bf16 v[104:107], a[24:27], v[156:159], v[104:107]
    ds_read_b64_tr_b16 a[72:73], v198 offset:12288
    v_mfma_f32_16x16x32_bf16 v[60:63], a[28:31], v[152:155], v[60:63]
    ds_read_b64_tr_b16 a[74:75], v198 offset:12800
    v_mfma_f32_16x16x32_bf16 v[108:111], a[28:31], v[156:159], v[108:111]
    ds_read_b64_tr_b16 a[76:77], v199 offset:12288
    s_waitcnt lgkmcnt(15)
    v_mfma_f32_16x16x32_bf16 v[64:67], v[152:155], a[32:35], v[64:67]
    ds_read_b64_tr_b16 a[78:79], v199 offset:12800
    v_mfma_f32_16x16x32_bf16 v[112:115], v[156:159], a[32:35], v[112:115]
    ds_read_b64_tr_b16 a[80:81], v196 offset:20480
    v_mfma_f32_16x16x32_bf16 v[68:71], v[152:155], a[36:39], v[68:71]
    ds_read_b64_tr_b16 a[82:83], v196 offset:20992
    v_mfma_f32_16x16x32_bf16 v[116:119], v[156:159], a[36:39], v[116:119]
    ds_read_b64_tr_b16 a[84:85], v197 offset:20480
    v_mfma_f32_16x16x32_bf16 v[72:75], v[152:155], a[40:43], v[72:75]
    ds_read_b64_tr_b16 a[86:87], v197 offset:20992
    v_mfma_f32_16x16x32_bf16 v[120:123], v[156:159], a[40:43], v[120:123]
    ds_read_b64_tr_b16 a[88:89], v198 offset:20480
    v_mfma_f32_16x16x32_bf16 v[76:79], v[152:155], a[44:47], v[76:79]
    ds_read_b64_tr_b16 a[90:91], v198 offset:20992
    v_mfma_f32_16x16x32_bf16 v[124:127], v[156:159], a[44:47], v[124:127]
    ds_read_b64_tr_b16 a[92:93], v199 offset:20480
    v_mfma_f32_16x16x32_bf16 v[128:131], v[152:155], v[152:155], v[128:131]
    ds_read_b64_tr_b16 a[94:95], v199 offset:20992
    v_mfma_f32_16x16x32_bf16 v[132:135], v[156:159], v[156:159], v[132:135]
    ds_read_b128 v[172:175], v195
    v_mfma_f32_16x16x32_bf16 v[136:139], v[160:163], v[160:163], v[136:139]
    s_cmp_ge_u32 s56, 2
    s_cbranch_scc1 L_beta_27
    v_mfma_f32_16x16x32_bf16 v[140:143], a[0:3], v[160:163], v[140:143]
    v_mfma_f32_16x16x32_bf16 v[144:147], a[4:7], v[160:163], v[144:147]
    v_mfma_f32_16x16x32_bf16 v[148:151], a[16:19], v[160:163], v[148:151]
    s_branch L_join_28
L_beta_27:
    v_mfma_f32_16x16x32_bf16 v[140:143], a[20:23], v[160:163], v[140:143]
    v_mfma_f32_16x16x32_bf16 v[144:147], v[160:163], a[32:35], v[144:147]
    v_mfma_f32_16x16x32_bf16 v[148:151], v[160:163], a[36:39], v[148:151]
L_join_28:
    s_waitcnt lgkmcnt(15)
    v_mfma_f32_16x16x32_bf16 v[32:35], a[48:51], v[164:167], v[32:35]
    v_lshrrev_b32 v28, 3, v1
    v_mfma_f32_16x16x32_bf16 v[80:83], a[48:51], v[168:171], v[80:83]
    v_and_b32 v29, 7, v1
    v_mfma_f32_16x16x32_bf16 v[36:39], a[52:55], v[164:167], v[36:39]
    v_mfma_f32_16x16x32_bf16 v[84:87], a[52:55], v[168:171], v[84:87]
    v_bfe_u32 v30, v1, 4, 1
    v_mfma_f32_16x16x32_bf16 v[40:43], a[56:59], v[164:167], v[40:43]
    v_lshlrev_b32 v30, 2, v30
    v_mfma_f32_16x16x32_bf16 v[88:91], a[56:59], v[168:171], v[88:91]
    v_mfma_f32_16x16x32_bf16 v[44:47], a[60:63], v[164:167], v[44:47]
    v_xor_b32 v29, v29, v30
    v_mfma_f32_16x16x32_bf16 v[92:95], a[60:63], v[168:171], v[92:95]
    s_waitcnt lgkmcnt(9)
    v_mfma_f32_16x16x32_bf16 v[48:51], a[64:67], v[164:167], v[48:51]
    v_mul_u32_u24 v28, 3584, v28
    v_mfma_f32_16x16x32_bf16 v[96:99], a[64:67], v[168:171], v[96:99]
    v_lshl_add_u32 v249, v29, 4, v28
    v_mfma_f32_16x16x32_bf16 v[52:55], a[68:71], v[164:167], v[52:55]
    v_mfma_f32_16x16x32_bf16 v[100:103], a[68:71], v[168:171], v[100:103]
    v_add_u32 v250, 28672, v249
    v_mfma_f32_16x16x32_bf16 v[56:59], a[72:75], v[164:167], v[56:59]
    v_mfma_f32_16x16x32_bf16 v[104:107], a[72:75], v[168:171], v[104:107]
    s_mul_i32 s70, s56, 28672
    v_mfma_f32_16x16x32_bf16 v[60:63], a[76:79], v[164:167], v[60:63]
    s_add_u32 s70, s70, 49152
    v_mfma_f32_16x16x32_bf16 v[108:111], a[76:79], v[168:171], v[108:111]
    s_waitcnt lgkmcnt(0)
    v_mfma_f32_16x16x32_bf16 v[64:67], v[164:167], a[80:83], v[64:67]
    s_mul_i32 s71, s56, 1835008
    v_mfma_f32_16x16x32_bf16 v[112:115], v[168:171], a[80:83], v[112:115]
    s_lshl_b32 s72, s62, 7
    v_mfma_f32_16x16x32_bf16 v[68:71], v[164:167], a[84:87], v[68:71]
    v_mfma_f32_16x16x32_bf16 v[116:119], v[168:171], a[84:87], v[116:119]
    s_add_u32 s71, s71, s72
    v_mfma_f32_16x16x32_bf16 v[72:75], v[164:167], a[88:91], v[72:75]
    v_mfma_f32_16x16x32_bf16 v[120:123], v[168:171], a[88:91], v[120:123]
    s_and_b32 s72, s58, 1
    v_mfma_f32_16x16x32_bf16 v[76:79], v[164:167], a[92:95], v[76:79]
    s_mul_i32 s72, s72, 917504
    v_mfma_f32_16x16x32_bf16 v[124:127], v[168:171], a[92:95], v[124:127]
    v_mfma_f32_16x16x32_bf16 v[128:131], v[164:167], v[164:167], v[128:131]
    s_add_u32 s71, s71, s72
    v_mfma_f32_16x16x32_bf16 v[132:135], v[168:171], v[168:171], v[132:135]
    v_mfma_f32_16x16x32_bf16 v[136:139], v[172:175], v[172:175], v[136:139]
    s_cmp_ge_u32 s56, 2
    s_cbranch_scc1 L_beta_29
    v_mfma_f32_16x16x32_bf16 v[140:143], a[48:51], v[172:175], v[140:143]
    v_mfma_f32_16x16x32_bf16 v[144:147], a[52:55], v[172:175], v[144:147]
    v_mfma_f32_16x16x32_bf16 v[148:151], a[64:67], v[172:175], v[148:151]
    s_branch L_join_30
L_beta_29:
    v_mfma_f32_16x16x32_bf16 v[140:143], a[68:71], v[172:175], v[140:143]
    v_mfma_f32_16x16x32_bf16 v[144:147], v[172:175], a[80:83], v[144:147]
    v_mfma_f32_16x16x32_bf16 v[148:151], v[172:175], a[84:87], v[148:151]
L_join_30:
    v_cndmask_b32 v28, v128, v129, s[10:11]
    v_cndmask_b32 v29, v130, v131, s[10:11]
    v_cndmask_b32 v12, v28, v29, s[12:13]
    ds_bpermute_b32 v161, v232, v12
    ds_bpermute_b32 v158, v233, v36
    v_cndmask_b32 v28, v132, v133, s[10:11]
    v_cndmask_b32 v29, v134, v135, s[10:11]
    v_cndmask_b32 v13, v28, v29, s[12:13]
    ds_bpermute_b32 v162, v232, v13
    ds_bpermute_b32 v159, v233, v84
    v_cndmask_b32 v28, v136, v137, s[10:11]
    v_cndmask_b32 v29, v138, v139, s[10:11]
    v_cndmask_b32 v14, v28, v29, s[12:13]
    ds_bpermute_b32 v163, v232, v14
    ds_bpermute_b32 v160, v234, v136
    s_mov_b32 s74, 0x00010001
    s_mov_b32 s75, 0x00010001
    s_mov_b64 exec, s[74:75]
    s_cmp_ge_u32 s56, 2
    s_cbranch_scc1 L_beta_31
    ds_write_b128 v235, v[140:143] offset:0
    ds_write_b128 v235, v[144:147] offset:64
    ds_write_b128 v235, v[148:151] offset:128
    s_branch L_join_32
L_beta_31:
    ds_write_b128 v235, v[140:143] offset:192
    s_mov_b64 exec, 0xffff
    ds_write_b32 v236, v144 offset:256
    ds_write_b32 v236, v148 offset:320
L_join_32:
    s_mov_b64 exec, -1
    s_mov_b32 s74, 0x3b124925
    s_mov_b32 s75, 0x3727c5ac
    s_mov_b32 s76, 0x3e8b97f6
    s_waitcnt lgkmcnt(3)
    v_mul_f32 v158, s74, v158
    v_mul_f32 v161, s74, v161
    v_mul_f32 v159, s74, v159
    v_mul_f32 v162, s74, v162
    v_mul_f32 v160, s74, v160
    v_mul_f32 v163, s74, v163
    v_fma_f32 v161, -v158, v158, v161
    v_fma_f32 v162, -v159, v159, v162
    v_fma_f32 v163, -v160, v160, v163
    s_waitcnt lgkmcnt(0)
    s_barrier
    ds_read_b128 v[196:199], v235 offset:128
    s_add_u32 m0, s70, 0
    ds_read_b128 v[200:203], v235 offset:192
    ds_read_b128 v[188:191], v235 offset:0
    ds_read_b128 v[192:195], v235 offset:64
    ds_read_b32 v4, v236 offset:256
    ds_read_b32 v5, v236 offset:320
    ds_read_b128 v[212:215], v237 offset:128
    ds_read_b128 v[216:219], v237 offset:192
    ds_read_b128 v[204:207], v237 offset:0
    ds_read_b128 v[208:211], v237 offset:64
    ds_read_b32 v6, v238 offset:256
    ds_read_b32 v7, v238 offset:320
    v_max_f32 v161, 0, v161
    v_add_f32 v161, s75, v161
    v_max_f32 v162, 0, v162
    v_add_f32 v162, s75, v162
    v_max_f32 v163, 0, v163
    v_add_f32 v163, s75, v163
    v_rsq_f32 v152, v161
    v_rsq_f32 v154, v162
    v_rsq_f32 v156, v163
    buffer_load_dwordx4 v249, s[32:35], s71 offen lds
    s_add_u32 m0, s70, 1024
    v_mul_f32 v153, -v158, v152
    v_mul_f32 v155, -v159, v154
    v_mul_f32 v157, -v160, v156
    v_cndmask_b32 v12, v152, v153, s[18:19]
    ds_write_b32 v239, v12 offset:0
    v_cndmask_b32 v13, v154, v155, s[18:19]
    ds_write_b32 v239, v13 offset:128
    v_cndmask_b32 v14, v156, v157, s[18:19]
    ds_write_b32 v239, v14 offset:256
    ds_read_b128 v[172:175], v240 offset:128
    ds_read_b128 v[176:179], v240 offset:192
    ds_read_b128 v[180:183], v240 offset:256
    ds_read_b128 v[184:187], v240 offset:320
    ds_read_b128 v[164:167], v240 offset:0
    ds_read_b128 v[168:171], v240 offset:64
    v_sub_f32 v8, 0, v158
    v_mul_f32 v9, s76, v152
    v_sub_f32 v10, 0, v159
    v_mul_f32 v11, s76, v154
    buffer_load_dwordx4 v250, s[32:35], s71 offen lds
    s_add_u32 s71, s71, 57344
    s_waitcnt lgkmcnt(9)
    v_pk_mul_f32 v[28:29], v[196:197], v[154:155] op_sel:[0,1] op_sel_hi:[1,1]
    v_pk_mul_f32 v[30:31], v[198:199], v[154:155] op_sel:[0,1] op_sel_hi:[1,1]
    v_pk_fma_f32 v[96:97], v[96:97], v[154:155], v[28:29] op_sel_hi:[1,0,1]
    v_pk_fma_f32 v[98:99], v[98:99], v[154:155], v[30:31] op_sel_hi:[1,0,1]
    v_cvt_pk_bf16_f32 v96, v96, v97
    v_cvt_pk_bf16_f32 v97, v98, v99
    v_pk_mul_f32 v[28:29], v[200:201], v[154:155] op_sel:[0,1] op_sel_hi:[1,1]
    v_pk_mul_f32 v[30:31], v[202:203], v[154:155] op_sel:[0,1] op_sel_hi:[1,1]
    v_pk_fma_f32 v[100:101], v[100:101], v[154:155], v[28:29] op_sel_hi:[1,0,1]
    v_pk_fma_f32 v[102:103], v[102:103], v[154:155], v[30:31] op_sel_hi:[1,0,1]
    v_cvt_pk_bf16_f32 v98, v100, v101
    v_cvt_pk_bf16_f32 v99, v102, v103
    ds_write_b128 v241, v[96:99] offset:4096
    v_pk_mul_f32 v[28:29], v[212:213], v[154:155] op_sel:[0,1] op_sel_hi:[1,1]
    v_pk_mul_f32 v[30:31], v[214:215], v[154:155] op_sel:[0,1] op_sel_hi:[1,1]
    v_pk_fma_f32 v[104:105], v[104:105], v[154:155], v[28:29] op_sel_hi:[1,0,1]
    v_pk_fma_f32 v[106:107], v[106:107], v[154:155], v[30:31] op_sel_hi:[1,0,1]
    s_add_u32 m0, s70, 2048
    v_cvt_pk_bf16_f32 v104, v104, v105
    v_cvt_pk_bf16_f32 v105, v106, v107
    v_pk_mul_f32 v[28:29], v[216:217], v[154:155] op_sel:[0,1] op_sel_hi:[1,1]
    v_pk_mul_f32 v[30:31], v[218:219], v[154:155] op_sel:[0,1] op_sel_hi:[1,1]
    v_pk_fma_f32 v[108:109], v[108:109], v[154:155], v[28:29] op_sel_hi:[1,0,1]
    v_pk_fma_f32 v[110:111], v[110:111], v[154:155], v[30:31] op_sel_hi:[1,0,1]
    v_cvt_pk_bf16_f32 v106, v108, v109
    v_cvt_pk_bf16_f32 v107, v110, v111
    ds_write_b128 v242, v[104:107] offset:4096
    s_waitcnt lgkmcnt(2)
    s_cmp_ge_u32 s56, 2
    s_cbranch_scc1 L_beta_33
    v_pk_mul_f32 v[28:29], v[196:197], v[156:157] op_sel:[0,1] op_sel_hi:[1,1]
    v_pk_mul_f32 v[30:31], v[198:199], v[156:157] op_sel:[0,1] op_sel_hi:[1,1]
    v_pk_fma_f32 v[148:149], v[148:149], v[156:157], v[28:29] op_sel_hi:[1,0,1]
    v_pk_fma_f32 v[150:151], v[150:151], v[156:157], v[30:31] op_sel_hi:[1,0,1]
    v_cvt_pk_bf16_f32 v148, v148, v149
    v_cvt_pk_bf16_f32 v149, v150, v151
    ds_write_b64 v243, v[148:149]
    s_branch L_join_34
L_beta_33:
    v_pk_mul_f32 v[28:29], v[200:201], v[156:157] op_sel:[0,1] op_sel_hi:[1,1]
    v_pk_mul_f32 v[30:31], v[202:203], v[156:157] op_sel:[0,1] op_sel_hi:[1,1]
    v_pk_fma_f32 v[140:141], v[140:141], v[156:157], v[28:29] op_sel_hi:[1,0,1]
    v_pk_fma_f32 v[142:143], v[142:143], v[156:157], v[30:31] op_sel_hi:[1,0,1]
    v_cvt_pk_bf16_f32 v140, v140, v141
    v_cvt_pk_bf16_f32 v141, v142, v143
    ds_write_b64 v243, v[140:141] offset:8
    v_pk_mul_f32 v[28:29], v[184:185], v[4:5] op_sel:[0,0] op_sel_hi:[1,0]
    v_pk_mul_f32 v[30:31], v[186:187], v[4:5] op_sel:[0,0] op_sel_hi:[1,0]
    v_pk_fma_f32 v[144:145], v[144:145], v[180:181], v[28:29]
    v_pk_fma_f32 v[146:147], v[146:147], v[182:183], v[30:31]
    v_cvt_pk_bf16_f32 v144, v144, v145
    v_cvt_pk_bf16_f32 v145, v146, v147
    v_pk_mul_f32 v[28:29], v[184:185], v[4:5] op_sel:[0,1] op_sel_hi:[1,1]
    v_pk_mul_f32 v[30:31], v[186:187], v[4:5] op_sel:[0,1] op_sel_hi:[1,1]
    v_pk_fma_f32 v[148:149], v[148:149], v[180:181], v[28:29]
    v_pk_fma_f32 v[150:151], v[150:151], v[182:183], v[30:31]
    v_cvt_pk_bf16_f32 v146, v148, v149
    v_cvt_pk_bf16_f32 v147, v150, v151
    v_cndmask_b32 v146, v146, v246, s[16:17]
    v_cndmask_b32 v147, v147, v246, s[16:17]
    ds_write_b128 v243, v[144:147] offset:1024
L_join_34:
    buffer_load_dwordx4 v249, s[32:35], s71 offen lds
    s_add_u32 m0, s70, 3072
    s_nop 0
    buffer_load_dwordx4 v250, s[32:35], s71 offen lds
    s_add_u32 s71, s71, 57344
    v_pk_mul_f32 v[28:29], v[176:177], v[4:5] op_sel:[0,0] op_sel_hi:[1,0]
    v_pk_mul_f32 v[30:31], v[178:179], v[4:5] op_sel:[0,0] op_sel_hi:[1,0]
    v_pk_fma_f32 v[112:113], v[112:113], v[172:173], v[28:29]
    v_pk_fma_f32 v[114:115], v[114:115], v[174:175], v[30:31]
    v_cvt_pk_bf16_f32 v132, v112, v113
    v_cvt_pk_bf16_f32 v133, v114, v115
    ds_write_b64 v241, v[132:133] offset:5120
    v_pk_mul_f32 v[28:29], v[176:177], v[4:5] op_sel:[0,1] op_sel_hi:[1,1]
    v_pk_mul_f32 v[30:31], v[178:179], v[4:5] op_sel:[0,1] op_sel_hi:[1,1]
    v_pk_fma_f32 v[116:117], v[116:117], v[172:173], v[28:29]
    v_pk_fma_f32 v[118:119], v[118:119], v[174:175], v[30:31]
    v_cvt_pk_bf16_f32 v138, v116, v117
    v_cvt_pk_bf16_f32 v139, v118, v119
    s_add_u32 m0, s70, 4096
    v_cndmask_b32 v138, v138, v246, s[16:17]
    v_cndmask_b32 v139, v139, v246, s[16:17]
    ds_write_b64 v241, v[138:139] offset:5128
    v_pk_mul_f32 v[28:29], v[176:177], v[6:7] op_sel:[0,0] op_sel_hi:[1,0]
    v_pk_mul_f32 v[30:31], v[178:179], v[6:7] op_sel:[0,0] op_sel_hi:[1,0]
    v_pk_fma_f32 v[120:121], v[120:121], v[172:173], v[28:29]
    v_pk_fma_f32 v[122:123], v[122:123], v[174:175], v[30:31]
    v_cvt_pk_bf16_f32 v20, v120, v121
    v_cvt_pk_bf16_f32 v21, v122, v123
    ds_write_b64 v242, v[20:21] offset:5120
    v_pk_mul_f32 v[28:29], v[176:177], v[6:7] op_sel:[0,1] op_sel_hi:[1,1]
    v_pk_mul_f32 v[30:31], v[178:179], v[6:7] op_sel:[0,1] op_sel_hi:[1,1]
    v_pk_fma_f32 v[124:125], v[124:125], v[172:173], v[28:29]
    v_pk_fma_f32 v[126:127], v[126:127], v[174:175], v[30:31]
    v_cvt_pk_bf16_f32 v26, v124, v125
    v_cvt_pk_bf16_f32 v27, v126, v127
    v_cndmask_b32 v26, v26, v246, s[16:17]
    v_cndmask_b32 v27, v27, v246, s[16:17]
    ds_write_b64 v242, v[26:27] offset:5128
    buffer_load_dwordx4 v249, s[32:35], s71 offen lds
    s_add_u32 m0, s70, 5120
    v_pk_mul_f32 v[28:29], v[196:197], v[152:153] op_sel:[0,1] op_sel_hi:[1,1]
    v_pk_mul_f32 v[30:31], v[198:199], v[152:153] op_sel:[0,1] op_sel_hi:[1,1]
    v_pk_fma_f32 v[48:49], v[48:49], v[152:153], v[28:29] op_sel_hi:[1,0,1]
    v_pk_fma_f32 v[50:51], v[50:51], v[152:153], v[30:31] op_sel_hi:[1,0,1]
    v_cvt_pk_bf16_f32 v48, v48, v49
    v_cvt_pk_bf16_f32 v49, v50, v51
    v_pk_mul_f32 v[28:29], v[200:201], v[152:153] op_sel:[0,1] op_sel_hi:[1,1]
    v_pk_mul_f32 v[30:31], v[202:203], v[152:153] op_sel:[0,1] op_sel_hi:[1,1]
    v_pk_fma_f32 v[52:53], v[52:53], v[152:153], v[28:29] op_sel_hi:[1,0,1]
    v_pk_fma_f32 v[54:55], v[54:55], v[152:153], v[30:31] op_sel_hi:[1,0,1]
    v_cvt_pk_bf16_f32 v50, v52, v53
    v_cvt_pk_bf16_f32 v51, v54, v55
    v_pk_mul_f32 v[28:29], v[212:213], v[152:153] op_sel:[0,1] op_sel_hi:[1,1]
    v_pk_mul_f32 v[30:31], v[214:215], v[152:153] op_sel:[0,1] op_sel_hi:[1,1]
    v_pk_fma_f32 v[56:57], v[56:57], v[152:153], v[28:29] op_sel_hi:[1,0,1]
    v_pk_fma_f32 v[58:59], v[58:59], v[152:153], v[30:31] op_sel_hi:[1,0,1]
    v_cvt_pk_bf16_f32 v56, v56, v57
    v_cvt_pk_bf16_f32 v57, v58, v59
    v_pk_mul_f32 v[28:29], v[216:217], v[152:153] op_sel:[0,1] op_sel_hi:[1,1]
    buffer_load_dwordx4 v250, s[32:35], s71 offen lds
    s_add_u32 s71, s71, 57344
    v_pk_mul_f32 v[30:31], v[218:219], v[152:153] op_sel:[0,1] op_sel_hi:[1,1]
    v_pk_fma_f32 v[60:61], v[60:61], v[152:153], v[28:29] op_sel_hi:[1,0,1]
    v_pk_fma_f32 v[62:63], v[62:63], v[152:153], v[30:31] op_sel_hi:[1,0,1]
    v_cvt_pk_bf16_f32 v58, v60, v61
    v_cvt_pk_bf16_f32 v59, v62, v63
    s_waitcnt lgkmcnt(0)
    s_barrier
    buffer_load_dword v248, v247, s[40:43], s9 offen sc1
    ds_read_b128 v[180:183], v241
    ds_read_b64 v[128:129], v241 offset:1024
    ds_read_b64 v[134:135], v241 offset:1032
    ds_read_b128 v[184:187], v242
    ds_read_b64 v[16:17], v242 offset:1024
    ds_read_b64 v[22:23], v242 offset:1032
    v_pk_fma_f32 v[80:81], v[188:189], v[10:11], v[80:81] op_sel_hi:[1,0,1]
    v_pk_fma_f32 v[82:83], v[190:191], v[10:11], v[82:83] op_sel_hi:[1,0,1]
    v_cvt_pk_bf16_f32 v80, v80, v81
    v_cvt_pk_bf16_f32 v81, v82, v83
    v_pk_fma_f32 v[84:85], v[192:193], v[10:11], v[84:85] op_sel_hi:[1,0,1]
    s_add_u32 m0, s70, 6144
    v_pk_fma_f32 v[86:87], v[194:195], v[10:11], v[86:87] op_sel_hi:[1,0,1]
    v_cvt_pk_bf16_f32 v82, v84, v85
    v_cvt_pk_bf16_f32 v83, v86, v87
    v_pk_fma_f32 v[88:89], v[204:205], v[10:11], v[88:89] op_sel_hi:[1,0,1]
    v_pk_fma_f32 v[90:91], v[206:207], v[10:11], v[90:91] op_sel_hi:[1,0,1]
    v_cvt_pk_bf16_f32 v88, v88, v89
    v_cvt_pk_bf16_f32 v89, v90, v91
    v_pk_fma_f32 v[92:93], v[208:209], v[10:11], v[92:93] op_sel_hi:[1,0,1]
    v_pk_fma_f32 v[94:95], v[210:211], v[10:11], v[94:95] op_sel_hi:[1,0,1]
    v_cvt_pk_bf16_f32 v90, v92, v93
    v_cvt_pk_bf16_f32 v91, v94, v95
    v_pk_fma_f32 v[32:33], v[188:189], v[8:9], v[32:33] op_sel_hi:[1,0,1]
    v_pk_fma_f32 v[34:35], v[190:191], v[8:9], v[34:35] op_sel_hi:[1,0,1]
    v_cvt_pk_bf16_f32 v32, v32, v33
    v_cvt_pk_bf16_f32 v33, v34, v35
    v_pk_fma_f32 v[36:37], v[192:193], v[8:9], v[36:37] op_sel_hi:[1,0,1]
    v_pk_fma_f32 v[38:39], v[194:195], v[8:9], v[38:39] op_sel_hi:[1,0,1]
    v_cvt_pk_bf16_f32 v34, v36, v37
    v_cvt_pk_bf16_f32 v35, v38, v39
    buffer_load_dwordx4 v249, s[32:35], s71 offen lds
    s_add_u32 m0, s70, 7168
    v_pk_fma_f32 v[40:41], v[204:205], v[8:9], v[40:41] op_sel_hi:[1,0,1]
    v_pk_fma_f32 v[42:43], v[206:207], v[8:9], v[42:43] op_sel_hi:[1,0,1]
    v_cvt_pk_bf16_f32 v40, v40, v41
    v_cvt_pk_bf16_f32 v41, v42, v43
    v_pk_fma_f32 v[44:45], v[208:209], v[8:9], v[44:45] op_sel_hi:[1,0,1]
    v_pk_fma_f32 v[46:47], v[210:211], v[8:9], v[46:47] op_sel_hi:[1,0,1]
    v_cvt_pk_bf16_f32 v42, v44, v45
    v_cvt_pk_bf16_f32 v43, v46, v47
    v_mfma_f32_16x16x32_bf16 v[188:191], v[48:51], v[80:83], v[224:227]
    v_mfma_f32_16x16x32_bf16 v[192:195], v[96:99], v[80:83], v[228:231]
    v_mfma_f32_16x16x32_bf16 v[196:199], v[56:59], v[88:91], v[224:227]
    v_mfma_f32_16x16x32_bf16 v[200:203], v[104:107], v[88:91], v[228:231]
    s_waitcnt lgkmcnt(0)
    v_mfma_f32_16x16x32_bf16 v[204:207], v[180:183], v[32:35], v[220:223]
    v_mfma_f32_16x16x32_bf16 v[208:211], v[48:51], v[32:35], v[228:231]
    v_mfma_f32_16x16x32_bf16 v[212:215], v[184:187], v[40:43], v[220:223]
    v_mfma_f32_16x16x32_bf16 v[216:219], v[56:59], v[40:43], v[228:231]
    v_pk_mul_f32 v[28:29], v[168:169], v[4:5] op_sel:[0,0] op_sel_hi:[1,0]
    buffer_load_dwordx4 v250, s[32:35], s71 offen lds
    s_add_u32 s71, s71, 57344
    v_pk_mul_f32 v[30:31], v[170:171], v[4:5] op_sel:[0,0] op_sel_hi:[1,0]
    v_pk_fma_f32 v[64:65], v[64:65], v[164:165], v[28:29]
    v_pk_fma_f32 v[66:67], v[66:67], v[166:167], v[30:31]
    v_cvt_pk_bf16_f32 v130, v64, v65
    v_cvt_pk_bf16_f32 v131, v66, v67
    v_pk_mul_f32 v[28:29], v[168:169], v[4:5] op_sel:[0,1] op_sel_hi:[1,1]
    v_pk_mul_f32 v[30:31], v[170:171], v[4:5] op_sel:[0,1] op_sel_hi:[1,1]
    v_pk_fma_f32 v[68:69], v[68:69], v[164:165], v[28:29]
    v_pk_fma_f32 v[70:71], v[70:71], v[166:167], v[30:31]
    v_cvt_pk_bf16_f32 v136, v68, v69
    v_cvt_pk_bf16_f32 v137, v70, v71
    v_cndmask_b32 v136, v136, v246, s[16:17]
    v_cndmask_b32 v137, v137, v246, s[16:17]
    v_pk_mul_f32 v[28:29], v[168:169], v[6:7] op_sel:[0,0] op_sel_hi:[1,0]
    v_pk_mul_f32 v[30:31], v[170:171], v[6:7] op_sel:[0,0] op_sel_hi:[1,0]
    v_pk_fma_f32 v[72:73], v[72:73], v[164:165], v[28:29]
    v_pk_fma_f32 v[74:75], v[74:75], v[166:167], v[30:31]
    v_cvt_pk_bf16_f32 v18, v72, v73
    v_cvt_pk_bf16_f32 v19, v74, v75
    s_add_u32 m0, s70, 8192
    v_pk_mul_f32 v[28:29], v[168:169], v[6:7] op_sel:[0,1] op_sel_hi:[1,1]
    v_pk_mul_f32 v[30:31], v[170:171], v[6:7] op_sel:[0,1] op_sel_hi:[1,1]
    v_pk_fma_f32 v[76:77], v[76:77], v[164:165], v[28:29]
    v_pk_fma_f32 v[78:79], v[78:79], v[166:167], v[30:31]
    v_cvt_pk_bf16_f32 v24, v76, v77
    v_cvt_pk_bf16_f32 v25, v78, v79
    v_cndmask_b32 v24, v24, v246, s[16:17]
    v_cndmask_b32 v25, v25, v246, s[16:17]
    v_max3_f32 v188, v188, v189, v192
    v_max3_f32 v190, v190, v191, v194
    v_max3_f32 v196, v196, v197, v200
    v_max3_f32 v198, v198, v199, v202
    v_max3_f32 v204, v204, v205, v208
    v_max3_f32 v206, v206, v207, v210
    v_max3_f32 v212, v212, v213, v216
    v_max3_f32 v214, v214, v215, v218
    v_max_f32 v188, v188, v193
    v_max_f32 v189, v190, v195
    buffer_load_dwordx4 v249, s[32:35], s71 offen lds
    s_add_u32 m0, s70, 9216
    v_max_f32 v196, v196, v201
    v_max_f32 v197, v198, v203
    v_max_f32 v204, v204, v209
    v_max_f32 v205, v206, v211
    v_max_f32 v212, v212, v217
    v_max_f32 v213, v214, v219
    v_max_f32 v140, v188, v189
    v_max_f32 v142, v196, v197
    v_max_f32 v144, v204, v205
    v_max_f32 v146, v212, v213
    v_mov_b32 v141, v140
    v_mov_b32 v143, v142
    v_mov_b32 v145, v144
    v_mov_b32 v147, v146
    v_permlane32_swap_b32 v140, v141
    v_permlane32_swap_b32 v142, v143
    v_permlane32_swap_b32 v144, v145
    v_permlane32_swap_b32 v146, v147
    v_max_f32 v140, v140, v141
    buffer_load_dwordx4 v250, s[32:35], s71 offen lds
    s_add_u32 s71, s71, 57344
    v_max_f32 v142, v142, v143
    v_max_f32 v144, v144, v145
    v_max_f32 v146, v146, v147
    v_mov_b32 v141, v140
    v_mov_b32 v143, v142
    v_mov_b32 v145, v144
    v_mov_b32 v147, v146
    v_permlane16_swap_b32 v140, v141
    v_permlane16_swap_b32 v142, v143
    v_permlane16_swap_b32 v144, v145
    v_permlane16_swap_b32 v146, v147
    v_max_f32 v140, v140, v141
    v_max_f32 v142, v142, v143
    v_max_f32 v144, v144, v145
    v_max_f32 v146, v146, v147
    v_mul_f32 v140, -v140, v11
    v_mul_f32 v142, -v142, v11
    v_mul_f32 v144, -v144, v9
    v_mul_f32 v146, -v146, v9
    s_add_u32 m0, s70, 10240
    v_pk_fma_f32 v[188:189], v[188:189], v[10:11], v[140:141] op_sel:[0,1,0] op_sel_hi:[1,1,0]
    v_pk_fma_f32 v[196:197], v[196:197], v[10:11], v[142:143] op_sel:[0,1,0] op_sel_hi:[1,1,0]
    v_pk_fma_f32 v[204:205], v[204:205], v[8:9], v[144:145] op_sel:[0,1,0] op_sel_hi:[1,1,0]
    v_pk_fma_f32 v[212:213], v[212:213], v[8:9], v[146:147] op_sel:[0,1,0] op_sel_hi:[1,1,0]
    v_exp_f32 v188, v188
    v_exp_f32 v189, v189
    v_exp_f32 v196, v196
    v_exp_f32 v197, v197
    v_exp_f32 v204, v204
    v_exp_f32 v205, v205
    v_exp_f32 v212, v212
    v_exp_f32 v213, v213
    v_cvt_pk_bf16_f32 v190, v188, v188
    v_cvt_pk_bf16_f32 v191, v189, v189
    v_and_b32 v152, v0, v190
    v_and_b32 v153, v15, v191
    v_and_b32 v154, v251, v190
    v_and_b32 v155, v253, v191
    s_nop 1
    v_mfma_f32_16x16x32_bf16 v[116:119], v[136:139], v[152:155], 0
    buffer_load_dwordx4 v249, s[32:35], s71 offen lds
    s_add_u32 m0, s70, 11264
    v_mfma_f32_16x16x32_bf16 v[112:115], v[130:133], v[152:155], 0
    v_cvt_pk_bf16_f32 v198, v196, v196
    v_cvt_pk_bf16_f32 v199, v197, v197
    v_and_b32 v156, v0, v198
    v_and_b32 v157, v15, v199
    v_and_b32 v158, v251, v198
    v_and_b32 v159, v253, v199
    s_nop 1
    v_mfma_f32_16x16x32_bf16 v[124:127], v[24:27], v[156:159], 0
    v_mfma_f32_16x16x32_bf16 v[120:123], v[18:21], v[156:159], 0
    ds_bpermute_b32 v140, v233, v116
    v_cvt_pk_bf16_f32 v206, v204, v204
    v_cvt_pk_bf16_f32 v207, v205, v205
    v_and_b32 v160, v0, v206
    v_and_b32 v161, v15, v207
    v_and_b32 v162, v251, v206
    v_and_b32 v163, v253, v207
    s_nop 1
    v_mfma_f32_16x16x32_bf16 v[68:71], v[134:137], v[160:163], 0
    v_mfma_f32_16x16x32_bf16 v[64:67], v[128:131], v[160:163], 0
    ds_bpermute_b32 v142, v233, v124
    buffer_load_dwordx4 v250, s[32:35], s71 offen lds
    s_add_u32 s71, s71, 57344
    v_cvt_pk_bf16_f32 v214, v212, v212
    v_cvt_pk_bf16_f32 v215, v213, v213
    v_and_b32 v164, v0, v214
    v_and_b32 v165, v15, v215
    v_and_b32 v166, v251, v214
    v_and_b32 v167, v253, v215
    s_nop 1
    v_mfma_f32_16x16x32_bf16 v[76:79], v[22:25], v[164:167], 0
    v_mfma_f32_16x16x32_bf16 v[72:75], v[16:19], v[164:167], 0
    ds_bpermute_b32 v144, v233, v68
    s_lshl_b32 s74, s66, 3
    s_lshl_b32 s75, s56, 1
    s_add_u32 s74, s74, s75
    s_mul_i32 s74, s74, 14336
    s_mul_i32 s75, s67, 1792
    s_add_u32 s74, s74, s75
    s_add_u32 s74, s74, 1048576
    s_add_u32 s75, s74, 14336
    ds_bpermute_b32 v146, v233, v76
    s_waitcnt vmcnt(6)
    v_cmp_ne_u32 vcc, s57, v248
    s_cbranch_vccz L_ok_35
    s_mov_b32 exec_lo, 0x3
    s_mov_b32 exec_hi, 0x0
L_poll_36:
    buffer_load_dword v248, v247, s[40:43], s9 offen sc1
L_poll_36_chk:
    s_add_u32 s77, s77, 1
    s_waitcnt vmcnt(0)
    v_cmp_ne_u32 vcc, s57, v248
    s_cmp_ge_u32 s77, 50000
    s_cbranch_scc1 L_seen_37
    s_and_b64 exec, exec, vcc
    s_cbranch_scc1 L_poll_36
L_seen_37:
    s_mov_b64 exec, -1
L_ok_35:
    s_waitcnt lgkmcnt(1)
    v_rcp_f32 v140, v140
    s_nop 0
    v_pk_mul_f32 v[112:113], v[112:113], v[140:141] op_sel_hi:[1,0]
    v_pk_mul_f32 v[114:115], v[114:115], v[140:141] op_sel_hi:[1,0]
    v_cvt_pk_bf16_f32 v188, v112, v113
    v_cvt_pk_bf16_f32 v189, v114, v115
    v_pk_mul_f32 v[116:117], v[116:117], v[140:141] op_sel_hi:[1,0]
    v_pk_mul_f32 v[118:119], v[118:119], v[140:141] op_sel_hi:[1,0]
    v_cvt_pk_bf16_f32 v190, v116, v117
    v_cvt_pk_bf16_f32 v191, v118, v119
    s_waitcnt lgkmcnt(2)
    v_rcp_f32 v142, v142
    s_nop 0
    v_pk_mul_f32 v[120:121], v[120:121], v[142:143] op_sel_hi:[1,0]
    v_pk_mul_f32 v[122:123], v[122:123], v[142:143] op_sel_hi:[1,0]
    v_cvt_pk_bf16_f32 v192, v120, v121
    v_cvt_pk_bf16_f32 v193, v122, v123
    v_pk_mul_f32 v[124:125], v[124:125], v[142:143] op_sel_hi:[1,0]
    v_pk_mul_f32 v[126:127], v[126:127], v[142:143] op_sel_hi:[1,0]
    v_cvt_pk_bf16_f32 v194, v124, v125
    v_cvt_pk_bf16_f32 v195, v126, v127
    v_cndmask_b32 v190, v190, v192, s[14:15]
    v_cndmask_b32 v194, v194, v188, s[14:15]
    v_cndmask_b32 v191, v191, v193, s[14:15]
    v_cndmask_b32 v195, v195, v189, s[14:15]
    buffer_store_dwordx4 v[188:191], v244, s[40:43], s75 offen sc1
    buffer_store_dwordx4 v[192:195], v245, s[40:43], s75 offen sc1
    s_waitcnt lgkmcnt(1)
    v_rcp_f32 v144, v144
    s_nop 0
    v_pk_mul_f32 v[64:65], v[64:65], v[144:145] op_sel_hi:[1,0]
    v_pk_mul_f32 v[66:67], v[66:67], v[144:145] op_sel_hi:[1,0]
    v_cvt_pk_bf16_f32 v196, v64, v65
    v_cvt_pk_bf16_f32 v197, v66, v67
    v_pk_mul_f32 v[68:69], v[68:69], v[144:145] op_sel_hi:[1,0]
    v_pk_mul_f32 v[70:71], v[70:71], v[144:145] op_sel_hi:[1,0]
    v_cvt_pk_bf16_f32 v198, v68, v69
    v_cvt_pk_bf16_f32 v199, v70, v71
    s_waitcnt lgkmcnt(0)
    v_rcp_f32 v146, v146
    s_nop 0
    v_pk_mul_f32 v[72:73], v[72:73], v[146:147] op_sel_hi:[1,0]
    v_pk_mul_f32 v[74:75], v[74:75], v[146:147] op_sel_hi:[1,0]
    v_cvt_pk_bf16_f32 v200, v72, v73
    v_cvt_pk_bf16_f32 v201, v74, v75
    v_pk_mul_f32 v[76:77], v[76:77], v[146:147] op_sel_hi:[1,0]
    v_pk_mul_f32 v[78:79], v[78:79], v[146:147] op_sel_hi:[1,0]
    v_cvt_pk_bf16_f32 v202, v76, v77
    v_cvt_pk_bf16_f32 v203, v78, v79
    v_cndmask_b32 v198, v198, v200, s[14:15]
    v_cndmask_b32 v202, v202, v196, s[14:15]
    v_cndmask_b32 v199, v199, v201, s[14:15]
    v_cndmask_b32 v203, v203, v197, s[14:15]
    buffer_store_dwordx4 v[196:199], v244, s[40:43], s74 offen sc1
    buffer_store_dwordx4 v[200:203], v245, s[40:43], s74 offen sc1
    s_lshl_b32 s9, s66, 3
    s_add_u32 s9, s9, s67
    s_lshl_b32 s9, s9, 2
    s_add_u32 s9, s9, s56
    s_lshl_b32 s9, s9, 7
    s_add_u32 s9, s9, 196608
    s_branch L_g1
L_roleB:
    s_waitcnt lgkmcnt(0)
    s_mov_b32 s24, s6
    s_mov_b32 s25, s7
    s_mov_b32 s26, 0x126000
    s_mov_b32 s27, 0x00020000
    s_mov_b32 s20, s4
    s_mov_b32 s21, s5
    s_mov_b32 s22, 0x1c0000
    s_mov_b32 s23, 0x00020000
    s_mov_b32 s40, s74
    s_mov_b32 s41, s75
    s_mov_b32 s42, 0x800000
    s_mov_b32 s43, 0x00020000
    v_mov_b32 v16, 0
    buffer_load_dword v252, v16, s[40:43], 0 offen sc1
    s_mov_b32 s28, s8
    s_mov_b32 s29, s9
    s_mov_b32 s30, 0x62000
    s_mov_b32 s31, 0x00020000
    s_mov_b32 s44, s10
    s_mov_b32 s45, s11
    s_mov_b32 s46, 0x1c0000
    s_mov_b32 s47, 0x00020000
    s_mov_b32 s32, s12
    s_mov_b32 s33, s13
    s_mov_b32 s34, 0x700000
    s_mov_b32 s35, 0x00020000
    s_mov_b32 s48, s14
    s_mov_b32 s49, s15
    s_mov_b32 s50, 0xe00
    s_mov_b32 s51, 0x00020000
    s_mov_b32 s36, s16
    s_mov_b32 s37, s17
    s_mov_b32 s38, 0x700000
    s_mov_b32 s39, 0x00020000
    s_mov_b32 s52, s18
    s_mov_b32 s53, s19
    s_mov_b32 s54, 0x1000
    s_mov_b32 s55, 0x00020000
    v_lshrrev_b32 v8, 4, v1
    v_and_b32 v9, 15, v1
    v_lshrrev_b32 v16, 3, v1
    v_and_b32 v17, 7, v1
    v_lshlrev_b32 v18, 1, v8
    v_xor_b32 v17, v17, v18
    v_mul_u32_u24 v16, 896, v16
    v_lshl_add_u32 v44, v17, 4, v16
    v_add_u32 v45, 128, v44
    v_add_u32 v46, 256, v44
    v_add_u32 v47, 384, v44
    v_add_u32 v48, 512, v44
    v_add_u32 v49, 640, v44
    v_add_u32 v50, 768, v44
    s_mul_i32 s69, s56, 7168
    s_mov_b32 s70, s69
    s_sub_u32 s67, s59, 16
    s_lshl_b32 s66, s58, 4
    s_add_u32 s71, s66, s67
    s_add_u32 s71, s71, 10
    s_lshl_b32 s4, s67, 1
    s_add_u32 s66, s66, s4
    s_and_b32 s4, s58, 1
    s_lshl_b32 s4, s4, 3
    s_or_b32 s4, s4, s67
    s_andn2_b32 s4, s4, 1
    s_cmp_eq_u32 s4, 4
    s_cselect_b32 s72, 1, 0
    s_cselect_b32 s71, s71, s66
    s_add_u32 s68, s66, 1
    s_lshl_b32 s16, s56, 10
    s_add_u32 s16, s16, 0
    s_min_u32 s16, s16, 13312
    s_lshl_b32 s17, s56, 10
    s_add_u32 s17, s17, 4096
    s_min_u32 s17, s17, 13312
    s_lshl_b32 s18, s56, 10
    s_add_u32 s18, s18, 8192
    s_min_u32 s18, s18, 13312
    s_lshl_b32 s19, s56, 10
    s_add_u32 s19, s19, 12288
    s_min_u32 s19, s19, 13312
    v_lshlrev_b32 v2, 4, v1
    s_mul_i32 s67, s66, 14336
    s_add_u32 s67, s67, s69
    s_add_u32 m0, s69, 114688
    s_nop 0
    buffer_load_dwordx4 v44, s[20:23], s67 offen lds
    s_add_u32 m0, s69, 115712
    s_nop 0
    buffer_load_dwordx4 v45, s[20:23], s67 offen lds
    s_add_u32 m0, s69, 116736
    s_nop 0
    buffer_load_dwordx4 v46, s[20:23], s67 offen lds
    s_add_u32 m0, s69, 117760
    s_nop 0
    buffer_load_dwordx4 v47, s[20:23], s67 offen lds
    s_add_u32 m0, s69, 118784
    s_nop 0
    buffer_load_dwordx4 v48, s[20:23], s67 offen lds
    s_add_u32 m0, s69, 119808
    s_nop 0
    buffer_load_dwordx4 v49, s[20:23], s67 offen lds
    s_add_u32 m0, s69, 120832
    s_nop 0
    buffer_load_dwordx4 v50, s[20:23], s67 offen lds
    s_sub_u32 s5, s59, 16
    s_min_u32 s5, s5, 6
    s_lshl_b32 s5, s5, 2
    s_add_u32 s5, s5, s56
    s_mul_i32 s5, s5, 3072
    v_min_u32 v16, 23, v1
    v_lshlrev_b32 v16, 7, v16
    buffer_load_dword v17, v16, s[28:31], s5 offen
    s_waitcnt vmcnt(0)
    s_add_u32 m0, s69, 0
    s_nop 0
    buffer_load_dwordx4 v44, s[28:31], s70 offen lds
    v_lshrrev_b32 v16, 2, v9
    s_add_u32 m0, s69, 1024
    s_nop 0
    buffer_load_dwordx4 v45, s[28:31], s70 offen lds
    v_bfe_u32 v17, v1, 1, 1
    s_lshl_b32 s4, s56, 1
    s_add_u32 m0, s69, 2048
    s_nop 0
    buffer_load_dwordx4 v46, s[28:31], s70 offen lds
    v_or_b32 v17, s4, v17
    v_and_b32 v18, 2, v16
    s_add_u32 m0, s69, 3072
    s_nop 0
    buffer_load_dwordx4 v47, s[28:31], s70 offen lds
    v_xor_b32 v17, v17, v18
    v_lshlrev_b32 v10, 4, v17
    s_add_u32 m0, s69, 4096
    s_nop 0
    buffer_load_dwordx4 v48, s[28:31], s70 offen lds
    v_and_b32 v18, 1, v1
    v_lshlrev_b32 v18, 3, v18
    s_add_u32 m0, s69, 5120
    s_nop 0
    buffer_load_dwordx4 v49, s[28:31], s70 offen lds
    v_lshl_add_u32 v11, v16, 7, v18
    v_lshlrev_b32 v12, 4, v8
    s_add_u32 m0, s69, 6144
    s_nop 0
    buffer_load_dwordx4 v50, s[28:31], s70 offen lds
    s_add_u32 s70, s70, 28672
    v_lshrrev_b32 v16, 1, v8
    v_mul_u32_u24 v16, 7168, v16
    s_add_u32 m0, s69, 28672
    s_nop 0
    buffer_load_dwordx4 v44, s[28:31], s70 offen lds
    v_and_b32 v17, 1, v8
    s_add_u32 m0, s69, 29696
    s_nop 0
    buffer_load_dwordx4 v45, s[28:31], s70 offen lds
    v_mul_u32_u24 v17, 576, v17
    v_add_u32 v16, v16, v17
    s_add_u32 m0, s69, 30720
    s_nop 0
    buffer_load_dwordx4 v46, s[28:31], s70 offen lds
    v_xad_u32 v3, v16, v10, v11
    v_add_u32 v14, 114688, v3
    s_add_u32 m0, s69, 31744
    s_nop 0
    buffer_load_dwordx4 v47, s[28:31], s70 offen lds
    v_bfe_u32 v16, v1, 4, 1
    v_lshlrev_b32 v16, 18, v16
    s_add_u32 m0, s69, 32768
    s_nop 0
    buffer_load_dwordx4 v48, s[28:31], s70 offen lds
    v_lshrrev_b32 v17, 5, v1
    v_lshl_add_u32 v16, v17, 9, v16
    s_add_u32 m0, s69, 33792
    s_nop 0
    buffer_load_dwordx4 v49, s[28:31], s70 offen lds
    v_lshl_add_u32 v16, v9, 4, v16
    s_lshr_b32 s4, s56, 1
    s_add_u32 m0, s69, 34816
    s_nop 0
    buffer_load_dwordx4 v50, s[28:31], s70 offen lds
    s_add_u32 s70, s70, 28672
    s_lshl_b32 s4, s4, 10
    s_and_b32 s5, s56, 1
    s_add_u32 m0, s69, 57344
    s_nop 0
    buffer_load_dwordx4 v44, s[28:31], s70 offen lds
    s_lshl_b32 s5, s5, 8
    s_add_u32 m0, s69, 58368
    s_nop 0
    buffer_load_dwordx4 v45, s[28:31], s70 offen lds
    s_add_u32 s4, s4, s5
    v_add_u32 v5, s4, v16
    s_add_u32 m0, s69, 59392
    s_nop 0
    buffer_load_dwordx4 v46, s[28:31], s70 offen lds
    v_add_u32 v6, 0x80000, v5
    v_add_u32 v7, 0x100000, v5
    s_add_u32 m0, s69, 60416
    s_nop 0
    buffer_load_dwordx4 v47, s[28:31], s70 offen lds
    v_add_u32 v253, 0x180000, v5
    v_mov_b32 v17, 0x7fff0000
    s_add_u32 m0, s69, 61440
    s_nop 0
    buffer_load_dwordx4 v48, s[28:31], s70 offen lds
    v_bfe_u32 v16, v1, 4, 1
    v_cmp_eq_u32 vcc, 0, v16
    s_add_u32 m0, s69, 62464
    s_nop 0
    buffer_load_dwordx4 v49, s[28:31], s70 offen lds
    v_cndmask_b32 v253, v17, v253, vcc
    v_and_b32 v16, 7, v1
    s_add_u32 m0, s69, 63488
    s_nop 0
    buffer_load_dwordx4 v50, s[28:31], s70 offen lds
    s_add_u32 s70, s70, 28672
    v_mul_u32_u24 v52, 1792, v16
    s_bfe_u32 s4, s66, 0x10001
    s_add_u32 m0, s69, 86016
    s_nop 0
    buffer_load_dwordx4 v44, s[28:31], s70 offen lds
    s_xor_b32 s4, s4, 1
    s_add_u32 m0, s69, 87040
    s_nop 0
    buffer_load_dwordx4 v45, s[28:31], s70 offen lds
    s_lshl_b32 s4, s4, 10
    v_add_u32 v52, s4, v52
    s_add_u32 m0, s69, 88064
    s_nop 0
    buffer_load_dwordx4 v46, s[28:31], s70 offen lds
    s_lshr_b32 s8, s66, 3
    s_lshl_b32 s8, s8, 12
    s_add_u32 m0, s69, 89088
    s_nop 0
    buffer_load_dwordx4 v47, s[28:31], s70 offen lds
    s_add_u32 s8, s8, 196608
    s_mov_b32 s12, 0x3b124925
    s_add_u32 m0, s69, 90112
    s_nop 0
    buffer_load_dwordx4 v48, s[28:31], s70 offen lds
    s_mov_b32 s13, 0x3b124925
    s_mov_b32 s14, 0x3727c5ac
    s_add_u32 m0, s69, 91136
    s_nop 0
    buffer_load_dwordx4 v49, s[28:31], s70 offen lds
    v_mov_b32 v56, -1
    v_mov_b32 v57, -1
    s_add_u32 m0, s69, 92160
    s_nop 0
    buffer_load_dwordx4 v50, s[28:31], s70 offen lds
    s_add_u32 s70, s70, 28672
    v_mov_b32 v58, -1
    v_mov_b32 v59, -1
    s_waitcnt vmcnt(29)
    s_barrier
    v_readfirstlane_b32 s57, v252
    s_mul_i32 s57, s57, 0x19660d
    s_add_u32 s57, s57, 0x3c6ef35f
    s_cmp_lg_u32 s56, 0
    s_cbranch_scc1 L_pub_38
    s_lshl_b32 s76, s2, 7
    s_add_u32 s76, s76, 98304
    v_mov_b32 v254, s57
    v_mov_b32 v255, 0
    s_mov_b64 exec, 1
    buffer_store_dword v254, v255, s[40:43], s76 offen sc1
    s_mov_b64 exec, -1
L_pub_38:
    ds_read_b64_tr_b16 v[28:29], v14 offset:0
    ds_read_b64_tr_b16 v[30:31], v14 offset:1024
    ds_read_b64_tr_b16 v[32:33], v14 offset:2048
    ds_read_b64_tr_b16 v[34:35], v14 offset:3072
    ds_read_b64_tr_b16 v[36:37], v14 offset:4096
    ds_read_b64_tr_b16 v[38:39], v14 offset:5120
    ds_read_b64_tr_b16 v[40:41], v14 offset:6144
    s_waitcnt lgkmcnt(0)
    v_lshlrev_b32 v60, 16, v28
    v_and_b32 v61, 0xffff0000, v28
    v_lshlrev_b32 v62, 16, v29
    v_and_b32 v63, 0xffff0000, v29
    v_lshlrev_b32 v64, 16, v30
    v_and_b32 v65, 0xffff0000, v30
    v_lshlrev_b32 v66, 16, v31
    v_and_b32 v67, 0xffff0000, v31
    v_lshlrev_b32 v68, 16, v32
    v_and_b32 v69, 0xffff0000, v32
    v_lshlrev_b32 v70, 16, v33
    v_and_b32 v71, 0xffff0000, v33
    v_lshlrev_b32 v72, 16, v34
    v_and_b32 v73, 0xffff0000, v34
    v_lshlrev_b32 v74, 16, v35
    v_and_b32 v75, 0xffff0000, v35
    v_lshlrev_b32 v76, 16, v36
    v_and_b32 v77, 0xffff0000, v36
    v_lshlrev_b32 v78, 16, v37
    v_and_b32 v79, 0xffff0000, v37
    v_lshlrev_b32 v80, 16, v38
    v_and_b32 v81, 0xffff0000, v38
    v_lshlrev_b32 v82, 16, v39
    v_and_b32 v83, 0xffff0000, v39
    v_lshlrev_b32 v84, 16, v40
    v_and_b32 v85, 0xffff0000, v40
    v_lshlrev_b32 v86, 16, v41
    v_and_b32 v87, 0xffff0000, v41
    ds_read_b64_tr_b16 v[28:29], v14 offset:14336
    ds_read_b64_tr_b16 v[30:31], v14 offset:15360
    ds_read_b64_tr_b16 v[32:33], v14 offset:16384
    ds_read_b64_tr_b16 v[34:35], v14 offset:17408
    ds_read_b64_tr_b16 v[36:37], v14 offset:18432
    ds_read_b64_tr_b16 v[38:39], v14 offset:19456
    ds_read_b64_tr_b16 v[40:41], v14 offset:20480
    s_waitcnt lgkmcnt(0)
    v_lshlrev_b32 v88, 16, v28
    v_and_b32 v89, 0xffff0000, v28
    v_lshlrev_b32 v90, 16, v29
    v_and_b32 v91, 0xffff0000, v29
    v_lshlrev_b32 v92, 16, v30
    v_and_b32 v93, 0xffff0000, v30
    v_lshlrev_b32 v94, 16, v31
    v_and_b32 v95, 0xffff0000, v31
    v_lshlrev_b32 v96, 16, v32
    v_and_b32 v97, 0xffff0000, v32
    v_lshlrev_b32 v98, 16, v33
    v_and_b32 v99, 0xffff0000, v33
    v_lshlrev_b32 v100, 16, v34
    v_and_b32 v101, 0xffff0000, v34
    v_lshlrev_b32 v102, 16, v35
    v_and_b32 v103, 0xffff0000, v35
    v_lshlrev_b32 v104, 16, v36
    v_and_b32 v105, 0xffff0000, v36
    v_lshlrev_b32 v106, 16, v37
    v_and_b32 v107, 0xffff0000, v37
    v_lshlrev_b32 v108, 16, v38
    v_and_b32 v109, 0xffff0000, v38
    v_lshlrev_b32 v110, 16, v39
    v_and_b32 v111, 0xffff0000, v39
    v_lshlrev_b32 v112, 16, v40
    v_and_b32 v113, 0xffff0000, v40
    v_lshlrev_b32 v114, 16, v41
    v_and_b32 v115, 0xffff0000, v41
    s_waitcnt vmcnt(14)
    s_waitcnt lgkmcnt(0)
    s_barrier
    s_mov_b32 s4, 0x90000
    s_mov_b32 s5, 0x790070
    v_lshrrev_b64 v[16:17], v12, s[4:5]
    v_and_b32 v16, 0xffff, v16
    v_lshlrev_b32 v16, 6, v16
    v_xad_u32 v14, v16, v10, v11
    ds_read_b64_tr_b16 a[0:1], v14 offset:0
    s_add_u32 m0, s69, 114688
    s_nop 0
    buffer_load_dwordx4 v44, s[28:31], s70 offen lds
    ds_read_b64_tr_b16 a[4:5], v14 offset:1024
    ds_read_b64_tr_b16 a[8:9], v14 offset:2048
    ds_read_b64_tr_b16 a[12:13], v14 offset:3072
    s_add_u32 m0, s69, 115712
    s_nop 0
    buffer_load_dwordx4 v45, s[28:31], s70 offen lds
    ds_read_b64_tr_b16 a[16:17], v14 offset:4096
    ds_read_b64_tr_b16 a[20:21], v14 offset:5120
    s_add_u32 m0, s69, 116736
    s_nop 0
    buffer_load_dwordx4 v46, s[28:31], s70 offen lds
    ds_read_b64_tr_b16 a[24:25], v14 offset:6144
    s_mov_b32 s4, 0xe900e0
    s_mov_b32 s5, 0x2300150
    v_lshrrev_b64 v[16:17], v12, s[4:5]
    v_and_b32 v16, 0xffff, v16
    v_lshlrev_b32 v16, 6, v16
    v_xad_u32 v15, v16, v10, v11
    s_add_u32 m0, s69, 117760
    s_nop 0
    buffer_load_dwordx4 v47, s[28:31], s70 offen lds
    ds_read_b64_tr_b16 a[2:3], v15 offset:0
    ds_read_b64_tr_b16 a[6:7], v15 offset:1024
    s_add_u32 m0, s69, 118784
    s_nop 0
    buffer_load_dwordx4 v48, s[28:31], s70 offen lds
    ds_read_b64_tr_b16 a[10:11], v15 offset:2048
    ds_read_b64_tr_b16 a[14:15], v15 offset:3072
    ds_read_b64_tr_b16 a[18:19], v15 offset:4096
    s_add_u32 m0, s69, 119808
    s_nop 0
    buffer_load_dwordx4 v49, s[28:31], s70 offen lds
    ds_read_b64_tr_b16 a[22:23], v15 offset:5120
    ds_read_b64_tr_b16 a[26:27], v15 offset:6144
    s_add_u32 m0, s69, 120832
    s_nop 0
    buffer_load_dwordx4 v50, s[28:31], s70 offen lds
    s_add_u32 s70, s70, 28672
    s_waitcnt vmcnt(14)
    s_waitcnt lgkmcnt(0)
    s_barrier
    s_mov_b32 s4, 0x1c00159
    s_mov_b32 s5, 0x31001c9
    v_lshrrev_b64 v[16:17], v12, s[4:5]
    v_and_b32 v16, 0xffff, v16
    v_lshlrev_b32 v16, 6, v16
    v_xad_u32 v14, v16, v10, v11
    ds_read_b64_tr_b16 a[28:29], v14 offset:0
    ds_read_b64_tr_b16 a[32:33], v14 offset:1024
    ds_read_b64_tr_b16 a[36:37], v14 offset:2048
    ds_read_b64_tr_b16 a[40:41], v14 offset:3072
    ds_read_b64_tr_b16 a[44:45], v14 offset:4096
    ds_read_b64_tr_b16 a[48:49], v14 offset:5120
    ds_read_b64_tr_b16 a[52:53], v14 offset:6144
    s_mov_b32 s4, 0x2a00239
    s_mov_b32 s5, 0x3f002a9
    v_lshrrev_b64 v[16:17], v12, s[4:5]
    v_and_b32 v16, 0xffff, v16
    v_lshlrev_b32 v16, 6, v16
    v_xad_u32 v15, v16, v10, v11
    ds_read_b64_tr_b16 a[30:31], v15 offset:0
    ds_read_b64_tr_b16 a[34:35], v15 offset:1024
    ds_read_b64_tr_b16 a[38:39], v15 offset:2048
    ds_read_b64_tr_b16 a[42:43], v15 offset:3072
    ds_read_b64_tr_b16 a[46:47], v15 offset:4096
    ds_read_b64_tr_b16 a[50:51], v15 offset:5120
    ds_read_b64_tr_b16 a[54:55], v15 offset:6144
    s_waitcnt vmcnt(7)
    s_waitcnt lgkmcnt(0)
    s_barrier
    s_mov_b32 s4, 0x3800319
    s_mov_b32 s5, 0x4690389
    v_lshrrev_b64 v[16:17], v12, s[4:5]
    v_and_b32 v16, 0xffff, v16
    v_lshlrev_b32 v16, 6, v16
    v_xad_u32 v14, v16, v10, v11
    ds_read_b64_tr_b16 a[56:57], v14 offset:0
    s_add_u32 m0, s69, 0
    s_nop 0
    buffer_load_dwordx4 v44, s[28:31], s70 offen lds
    ds_read_b64_tr_b16 a[60:61], v14 offset:1024
    ds_read_b64_tr_b16 a[64:65], v14 offset:2048
    ds_read_b64_tr_b16 a[68:69], v14 offset:3072
    s_add_u32 m0, s69, 1024
    s_nop 0
    buffer_load_dwordx4 v45, s[28:31], s70 offen lds
    ds_read_b64_tr_b16 a[72:73], v14 offset:4096
    ds_read_b64_tr_b16 a[76:77], v14 offset:5120
    s_add_u32 m0, s69, 2048
    s_nop 0
    buffer_load_dwordx4 v46, s[28:31], s70 offen lds
    ds_read_b64_tr_b16 a[80:81], v14 offset:6144
    s_mov_b32 s4, 0x46003f9
    s_mov_b32 s5, 0x5490540
    v_lshrrev_b64 v[16:17], v12, s[4:5]
    v_and_b32 v16, 0xffff, v16
    v_lshlrev_b32 v16, 6, v16
    v_xad_u32 v15, v16, v10, v11
    s_add_u32 m0, s69, 3072
    s_nop 0
    buffer_load_dwordx4 v47, s[28:31], s70 offen lds
    ds_read_b64_tr_b16 a[58:59], v15 offset:0
    ds_read_b64_tr_b16 a[62:63], v15 offset:1024
    s_add_u32 m0, s69, 4096
    s_nop 0
    buffer_load_dwordx4 v48, s[28:31], s70 offen lds
    ds_read_b64_tr_b16 a[66:67], v15 offset:2048
    ds_read_b64_tr_b16 a[70:71], v15 offset:3072
    ds_read_b64_tr_b16 a[74:75], v15 offset:4096
    s_add_u32 m0, s69, 5120
    s_nop 0
    buffer_load_dwordx4 v49, s[28:31], s70 offen lds
    ds_read_b64_tr_b16 a[78:79], v15 offset:5120
    ds_read_b64_tr_b16 a[82:83], v15 offset:6144
    s_add_u32 m0, s69, 6144
    s_nop 0
    buffer_load_dwordx4 v50, s[28:31], s70 offen lds
    s_add_u32 s70, s70, 28672
    s_waitcnt vmcnt(7)
    s_waitcnt lgkmcnt(0)
    s_barrier
    s_mov_b32 s4, 0x4d904d0
    s_mov_b32 s5, 0x6290620
    v_lshrrev_b64 v[16:17], v12, s[4:5]
    v_and_b32 v16, 0xffff, v16
    v_lshlrev_b32 v16, 6, v16
    v_xad_u32 v14, v16, v10, v11
    ds_read_b64_tr_b16 a[84:85], v14 offset:0
    s_add_u32 m0, s69, 28672
    s_nop 0
    buffer_load_dwordx4 v44, s[28:31], s70 offen lds
    ds_read_b64_tr_b16 a[88:89], v14 offset:1024
    ds_read_b64_tr_b16 a[92:93], v14 offset:2048
    ds_read_b64_tr_b16 a[96:97], v14 offset:3072
    s_add_u32 m0, s69, 29696
    s_nop 0
    buffer_load_dwordx4 v45, s[28:31], s70 offen lds
    ds_read_b64_tr_b16 a[100:101], v14 offset:4096
    ds_read_b64_tr_b16 a[104:105], v14 offset:5120
    s_add_u32 m0, s69, 30720
    s_nop 0
    buffer_load_dwordx4 v46, s[28:31], s70 offen lds
    ds_read_b64_tr_b16 a[108:109], v14 offset:6144
    s_mov_b32 s4, 0x5b905b0
    s_mov_b32 s5, 0x7090700
    v_lshrrev_b64 v[16:17], v12, s[4:5]
    v_and_b32 v16, 0xffff, v16
    v_lshlrev_b32 v16, 6, v16
    v_xad_u32 v15, v16, v10, v11
    s_add_u32 m0, s69, 31744
    s_nop 0
    buffer_load_dwordx4 v47, s[28:31], s70 offen lds
    ds_read_b64_tr_b16 a[86:87], v15 offset:0
    ds_read_b64_tr_b16 a[90:91], v15 offset:1024
    s_add_u32 m0, s69, 32768
    s_nop 0
    buffer_load_dwordx4 v48, s[28:31], s70 offen lds
    ds_read_b64_tr_b16 a[94:95], v15 offset:2048
    ds_read_b64_tr_b16 a[98:99], v15 offset:3072
    ds_read_b64_tr_b16 a[102:103], v15 offset:4096
    s_add_u32 m0, s69, 33792
    s_nop 0
    buffer_load_dwordx4 v49, s[28:31], s70 offen lds
    ds_read_b64_tr_b16 a[106:107], v15 offset:5120
    ds_read_b64_tr_b16 a[110:111], v15 offset:6144
    s_add_u32 m0, s69, 34816
    s_nop 0
    buffer_load_dwordx4 v50, s[28:31], s70 offen lds
    s_add_u32 s70, s70, 28672
    s_waitcnt vmcnt(7)
    s_waitcnt lgkmcnt(0)
    s_barrier
    s_mov_b32 s4, 0x6990690
    s_mov_b32 s5, 0x7e00779
    v_lshrrev_b64 v[16:17], v12, s[4:5]
    v_and_b32 v16, 0xffff, v16
    v_lshlrev_b32 v16, 6, v16
    v_xad_u32 v14, v16, v10, v11
    ds_read_b64_tr_b16 a[112:113], v14 offset:0
    s_add_u32 m0, s69, 57344
    s_nop 0
    buffer_load_dwordx4 v44, s[28:31], s70 offen lds
    ds_read_b64_tr_b16 a[116:117], v14 offset:1024
    ds_read_b64_tr_b16 a[120:121], v14 offset:2048
    ds_read_b64_tr_b16 a[124:125], v14 offset:3072
    s_add_u32 m0, s69, 58368
    s_nop 0
    buffer_load_dwordx4 v45, s[28:31], s70 offen lds
    ds_read_b64_tr_b16 a[128:129], v14 offset:4096
    ds_read_b64_tr_b16 a[132:133], v14 offset:5120
    s_add_u32 m0, s69, 59392
    s_nop 0
    buffer_load_dwordx4 v46, s[28:31], s70 offen lds
    ds_read_b64_tr_b16 a[136:137], v14 offset:6144
    s_mov_b32 s4, 0x8500770
    s_mov_b32 s5, 0x859
    v_lshrrev_b64 v[16:17], v12, s[4:5]
    v_and_b32 v16, 0xffff, v16
    v_lshlrev_b32 v16, 6, v16
    v_xad_u32 v15, v16, v10, v11
    s_add_u32 m0, s69, 60416
    s_nop 0
    buffer_load_dwordx4 v47, s[28:31], s70 offen lds
    ds_read_b64_tr_b16 a[114:115], v15 offset:0
    ds_read_b64_tr_b16 a[118:119], v15 offset:1024
    s_add_u32 m0, s69, 61440
    s_nop 0
    buffer_load_dwordx4 v48, s[28:31], s70 offen lds
    ds_read_b64_tr_b16 a[122:123], v15 offset:2048
    ds_read_b64_tr_b16 a[126:127], v15 offset:3072
    ds_read_b64_tr_b16 a[130:131], v15 offset:4096
    s_add_u32 m0, s69, 62464
    s_nop 0
    buffer_load_dwordx4 v49, s[28:31], s70 offen lds
    ds_read_b64_tr_b16 a[134:135], v15 offset:5120
    ds_read_b64_tr_b16 a[138:139], v15 offset:6144
    s_add_u32 m0, s69, 63488
    s_nop 0
    buffer_load_dwordx4 v50, s[28:31], s70 offen lds
    s_add_u32 s70, s70, 28672
    s_waitcnt vmcnt(7)
    s_waitcnt lgkmcnt(0)
    s_barrier
    s_mov_b32 s4, 0x7007e9
    s_mov_b32 s5, 0xe00079
    v_lshrrev_b64 v[16:17], v12, s[4:5]
    v_and_b32 v16, 0xffff, v16
    v_lshlrev_b32 v16, 6, v16
    v_xad_u32 v14, v16, v10, v11
    ds_read_b64_tr_b16 a[140:141], v14 offset:0
    s_add_u32 m0, s69, 86016
    s_nop 0
    buffer_load_dwordx4 v44, s[28:31], s70 offen lds
    ds_read_b64_tr_b16 a[144:145], v14 offset:1024
    ds_read_b64_tr_b16 a[148:149], v14 offset:2048
    ds_read_b64_tr_b16 a[152:153], v14 offset:3072
    s_add_u32 m0, s69, 87040
    s_nop 0
    buffer_load_dwordx4 v45, s[28:31], s70 offen lds
    ds_read_b64_tr_b16 a[156:157], v14 offset:4096
    ds_read_b64_tr_b16 a[160:161], v14 offset:5120
    s_add_u32 m0, s69, 88064
    s_nop 0
    buffer_load_dwordx4 v46, s[28:31], s70 offen lds
    ds_read_b64_tr_b16 a[164:165], v14 offset:6144
    s_mov_b32 s4, 0x1500009
    s_mov_b32 s5, 0x1c00159
    v_lshrrev_b64 v[16:17], v12, s[4:5]
    v_and_b32 v16, 0xffff, v16
    v_lshlrev_b32 v16, 6, v16
    v_xad_u32 v15, v16, v10, v11
    s_add_u32 m0, s69, 89088
    s_nop 0
    buffer_load_dwordx4 v47, s[28:31], s70 offen lds
    ds_read_b64_tr_b16 a[142:143], v15 offset:0
    ds_read_b64_tr_b16 a[146:147], v15 offset:1024
    s_add_u32 m0, s69, 90112
    s_nop 0
    buffer_load_dwordx4 v48, s[28:31], s70 offen lds
    ds_read_b64_tr_b16 a[150:151], v15 offset:2048
    ds_read_b64_tr_b16 a[154:155], v15 offset:3072
    ds_read_b64_tr_b16 a[158:159], v15 offset:4096
    s_add_u32 m0, s69, 91136
    s_nop 0
    buffer_load_dwordx4 v49, s[28:31], s70 offen lds
    ds_read_b64_tr_b16 a[162:163], v15 offset:5120
    ds_read_b64_tr_b16 a[166:167], v15 offset:6144
    s_add_u32 m0, s69, 92160
    s_nop 0
    buffer_load_dwordx4 v50, s[28:31], s70 offen lds
    s_add_u32 s70, s70, 28672
    s_waitcnt vmcnt(14)
    s_waitcnt lgkmcnt(0)
    s_barrier
    s_mov_b32 s4, 0x1c900e9
    s_mov_b32 s5, 0x2390230
    v_lshrrev_b64 v[16:17], v12, s[4:5]
    v_and_b32 v16, 0xffff, v16
    v_lshlrev_b32 v16, 6, v16
    v_xad_u32 v14, v16, v10, v11
    ds_read_b64_tr_b16 a[168:169], v14 offset:0
    s_add_u32 m0, s69, 114688
    s_nop 0
    buffer_load_dwordx4 v44, s[28:31], s70 offen lds
    ds_read_b64_tr_b16 a[172:173], v14 offset:1024
    ds_read_b64_tr_b16 a[176:177], v14 offset:2048
    ds_read_b64_tr_b16 a[180:181], v14 offset:3072
    s_add_u32 m0, s69, 115712
    s_nop 0
    buffer_load_dwordx4 v45, s[28:31], s70 offen lds
    ds_read_b64_tr_b16 a[184:185], v14 offset:4096
    ds_read_b64_tr_b16 a[188:189], v14 offset:5120
    s_add_u32 m0, s69, 116736
    s_nop 0
    buffer_load_dwordx4 v46, s[28:31], s70 offen lds
    ds_read_b64_tr_b16 a[192:193], v14 offset:6144
    s_mov_b32 s4, 0x2a902a0
    s_mov_b32 s5, 0x3190310
    v_lshrrev_b64 v[16:17], v12, s[4:5]
    v_and_b32 v16, 0xffff, v16
    v_lshlrev_b32 v16, 6, v16
    v_xad_u32 v15, v16, v10, v11
    s_add_u32 m0, s69, 117760
    s_nop 0
    buffer_load_dwordx4 v47, s[28:31], s70 offen lds
    ds_read_b64_tr_b16 a[170:171], v15 offset:0
    ds_read_b64_tr_b16 a[174:175], v15 offset:1024
    s_add_u32 m0, s69, 118784
    s_nop 0
    buffer_load_dwordx4 v48, s[28:31], s70 offen lds
    ds_read_b64_tr_b16 a[178:179], v15 offset:2048
    ds_read_b64_tr_b16 a[182:183], v15 offset:3072
    ds_read_b64_tr_b16 a[186:187], v15 offset:4096
    s_add_u32 m0, s69, 119808
    s_nop 0
    buffer_load_dwordx4 v49, s[28:31], s70 offen lds
    ds_read_b64_tr_b16 a[190:191], v15 offset:5120
    ds_read_b64_tr_b16 a[194:195], v15 offset:6144
    s_add_u32 m0, s69, 120832
    s_nop 0
    buffer_load_dwordx4 v50, s[28:31], s70 offen lds
    s_add_u32 s70, s70, 28672
    s_waitcnt vmcnt(7)
    s_waitcnt lgkmcnt(0)
    s_barrier
    s_mov_b32 s4, 0x3890380
    s_mov_b32 s5, 0x3f903f0
    v_lshrrev_b64 v[16:17], v12, s[4:5]
    s_mul_i32 s6, s66, 14336
    s_add_u32 s6, s6, 1048576
    s_add_u32 s7, s6, s16
    buffer_store_dwordx4 v[56:59], v2, s[40:43], s7 offen sc1
    v_and_b32 v16, 0xffff, v16
    v_lshlrev_b32 v16, 6, v16
    v_xad_u32 v14, v16, v10, v11
    s_add_u32 s7, s6, s17
    buffer_store_dwordx4 v[56:59], v2, s[40:43], s7 offen sc1
    ds_read_b64_tr_b16 a[196:197], v14 offset:0
    s_add_u32 s7, s6, s18
    buffer_store_dwordx4 v[56:59], v2, s[40:43], s7 offen sc1
    ds_read_b64_tr_b16 a[200:201], v14 offset:1024
    s_add_u32 s7, s6, s19
    buffer_store_dwordx4 v[56:59], v2, s[40:43], s7 offen sc1
    ds_read_b64_tr_b16 a[204:205], v14 offset:2048
    s_add_u32 m0, s69, 0
    s_nop 0
    buffer_load_dwordx4 v44, s[28:31], s70 offen lds
    ds_read_b64_tr_b16 a[208:209], v14 offset:3072
    s_add_u32 m0, s69, 1024
    s_nop 0
    buffer_load_dwordx4 v45, s[28:31], s70 offen lds
    ds_read_b64_tr_b16 a[212:213], v14 offset:4096
    s_add_u32 m0, s69, 2048
    s_nop 0
    buffer_load_dwordx4 v46, s[28:31], s70 offen lds
    ds_read_b64_tr_b16 a[216:217], v14 offset:5120
    s_add_u32 m0, s69, 3072
    s_nop 0
    buffer_load_dwordx4 v47, s[28:31], s70 offen lds
    ds_read_b64_tr_b16 a[220:221], v14 offset:6144
    s_add_u32 m0, s69, 4096
    s_nop 0
    buffer_load_dwordx4 v48, s[28:31], s70 offen lds
    s_mov_b32 s4, 0x4690460
    s_mov_b32 s5, 0x5b004d0
    v_lshrrev_b64 v[16:17], v12, s[4:5]
    s_add_u32 m0, s69, 5120
    s_nop 0
    buffer_load_dwordx4 v49, s[28:31], s70 offen lds
    v_and_b32 v16, 0xffff, v16
    v_lshlrev_b32 v16, 6, v16
    v_xad_u32 v15, v16, v10, v11
    s_add_u32 m0, s69, 6144
    s_nop 0
    buffer_load_dwordx4 v50, s[28:31], s70 offen lds
    s_add_u32 s70, s70, 28672
    ds_read_b64_tr_b16 a[198:199], v15 offset:0
    s_add_u32 m0, s69, 28672
    s_nop 0
    buffer_load_dwordx4 v44, s[28:31], s70 offen lds
    ds_read_b64_tr_b16 a[202:203], v15 offset:1024
    s_add_u32 m0, s69, 29696
    s_nop 0
    buffer_load_dwordx4 v45, s[28:31], s70 offen lds
    ds_read_b64_tr_b16 a[206:207], v15 offset:2048
    s_add_u32 m0, s69, 30720
    s_nop 0
    buffer_load_dwordx4 v46, s[28:31], s70 offen lds
    ds_read_b64_tr_b16 a[210:211], v15 offset:3072
    s_add_u32 m0, s69, 31744
    s_nop 0
    buffer_load_dwordx4 v47, s[28:31], s70 offen lds
    ds_read_b64_tr_b16 a[214:215], v15 offset:4096
    s_add_u32 m0, s69, 32768
    s_nop 0
    buffer_load_dwordx4 v48, s[28:31], s70 offen lds
    ds_read_b64_tr_b16 a[218:219], v15 offset:5120
    s_add_u32 m0, s69, 33792
    s_nop 0
    buffer_load_dwordx4 v49, s[28:31], s70 offen lds
    ds_read_b64_tr_b16 a[222:223], v15 offset:6144
    s_add_u32 m0, s69, 34816
    s_nop 0
    buffer_load_dwordx4 v50, s[28:31], s70 offen lds
    s_add_u32 s70, s70, 28672
    s_waitcnt vmcnt(18)
    s_waitcnt lgkmcnt(0)
    s_barrier
    s_mov_b32 s4, 0x54004d9
    s_mov_b32 s5, 0x6900549
    v_lshrrev_b64 v[16:17], v12, s[4:5]
    v_and_b32 v16, 0xffff, v16
    v_lshlrev_b32 v16, 6, v16
    v_xad_u32 v14, v16, v10, v11
    ds_read_b64_tr_b16 a[224:225], v14 offset:0
    ds_read_b64_tr_b16 a[228:229], v14 offset:1024
    ds_read_b64_tr_b16 a[232:233], v14 offset:2048
    s_mul_i32 s6, s68, 14336
    s_add_u32 s6, s6, 1048576
    s_add_u32 s7, s6, s16
    buffer_store_dwordx4 v[56:59], v2, s[40:43], s7 offen sc1
    ds_read_b64_tr_b16 a[236:237], v14 offset:3072
    ds_read_b64_tr_b16 a[240:241], v14 offset:4096
    ds_read_b64_tr_b16 a[244:245], v14 offset:5120
    ds_read_b64_tr_b16 a[248:249], v14 offset:6144
    s_add_u32 s7, s6, s17
    buffer_store_dwordx4 v[56:59], v2, s[40:43], s7 offen sc1
    s_mov_b32 s4, 0x62005b9
    s_mov_b32 s5, 0x7700629
    v_lshrrev_b64 v[16:17], v12, s[4:5]
    v_and_b32 v16, 0xffff, v16
    v_lshlrev_b32 v16, 6, v16
    v_xad_u32 v15, v16, v10, v11
    ds_read_b64_tr_b16 a[226:227], v15 offset:0
    ds_read_b64_tr_b16 a[230:231], v15 offset:1024
    ds_read_b64_tr_b16 a[234:235], v15 offset:2048
    s_add_u32 s7, s6, s18
    buffer_store_dwordx4 v[56:59], v2, s[40:43], s7 offen sc1
    ds_read_b64_tr_b16 a[238:239], v15 offset:3072
    ds_read_b64_tr_b16 a[242:243], v15 offset:4096
    ds_read_b64_tr_b16 a[246:247], v15 offset:5120
    ds_read_b64_tr_b16 a[250:251], v15 offset:6144
    s_add_u32 s7, s6, s19
    buffer_store_dwordx4 v[56:59], v2, s[40:43], s7 offen sc1
    s_waitcnt vmcnt(11)
    s_waitcnt lgkmcnt(0)
    s_barrier
    s_mov_b32 s4, 0x7000699
    s_mov_b32 s5, 0x7e90709
    v_lshrrev_b64 v[16:17], v12, s[4:5]
    v_and_b32 v16, 0xffff, v16
    v_lshlrev_b32 v16, 6, v16
    v_xad_u32 v14, v16, v10, v11
    s_mul_i32 s6, s71, 14336
    s_add_u32 s6, s6, 1048576
    s_cmp_eq_u32 s72, 0
    s_cselect_b32 s6, 0x7fff0000, s6
    s_add_u32 s7, s6, s16
    buffer_store_dwordx4 v[56:59], v2, s[40:43], s7 offen sc1
    ds_read_b64_tr_b16 a[252:253], v14 offset:0
    ds_read_b64_tr_b16 v[116:117], v14 offset:1024
    s_add_u32 s7, s6, s17
    buffer_store_dwordx4 v[56:59], v2, s[40:43], s7 offen sc1
    ds_read_b64_tr_b16 v[120:121], v14 offset:2048
    s_add_u32 s7, s6, s18
    buffer_store_dwordx4 v[56:59], v2, s[40:43], s7 offen sc1
    ds_read_b64_tr_b16 v[124:125], v14 offset:3072
    ds_read_b64_tr_b16 v[128:129], v14 offset:4096
    s_add_u32 s7, s6, s19
    buffer_store_dwordx4 v[56:59], v2, s[40:43], s7 offen sc1
    ds_read_b64_tr_b16 v[132:133], v14 offset:5120
    ds_read_b64_tr_b16 v[136:137], v14 offset:6144
    s_add_u32 m0, s69, 57344
    s_nop 0
    buffer_load_dwordx4 v44, s[28:31], s70 offen lds
    s_mov_b32 s4, 0x7e00779
    s_mov_b32 s5, 0x90000
    v_lshrrev_b64 v[16:17], v12, s[4:5]
    s_add_u32 m0, s69, 58368
    s_nop 0
    buffer_load_dwordx4 v45, s[28:31], s70 offen lds
    v_and_b32 v16, 0xffff, v16
    v_lshlrev_b32 v16, 6, v16
    v_xad_u32 v15, v16, v10, v11
    ds_read_b64_tr_b16 a[254:255], v15 offset:0
    s_add_u32 m0, s69, 59392
    s_nop 0
    buffer_load_dwordx4 v46, s[28:31], s70 offen lds
    ds_read_b64_tr_b16 v[118:119], v15 offset:1024
    ds_read_b64_tr_b16 v[122:123], v15 offset:2048
    s_add_u32 m0, s69, 60416
    s_nop 0
    buffer_load_dwordx4 v47, s[28:31], s70 offen lds
    ds_read_b64_tr_b16 v[126:127], v15 offset:3072
    s_add_u32 m0, s69, 61440
    s_nop 0
    buffer_load_dwordx4 v48, s[28:31], s70 offen lds
    ds_read_b64_tr_b16 v[130:131], v15 offset:4096
    ds_read_b64_tr_b16 v[134:135], v15 offset:5120
    s_add_u32 m0, s69, 62464
    s_nop 0
    buffer_load_dwordx4 v49, s[28:31], s70 offen lds
    ds_read_b64_tr_b16 v[138:139], v15 offset:6144
    s_add_u32 m0, s69, 63488
    s_nop 0
    buffer_load_dwordx4 v50, s[28:31], s70 offen lds
    s_add_u32 s70, s70, 28672
    s_waitcnt vmcnt(15)
    s_waitcnt lgkmcnt(0)
    s_barrier
    s_mov_b32 s4, 0x8590850
    s_mov_b32 s5, 0xe900e0
    v_lshrrev_b64 v[16:17], v12, s[4:5]
    v_and_b32 v16, 0xffff, v16
    v_lshlrev_b32 v16, 6, v16
    v_xad_u32 v14, v16, v10, v11
    ds_read_b64_tr_b16 v[140:141], v14 offset:0
    s_add_u32 m0, s69, 86016
    s_nop 0
    buffer_load_dwordx4 v44, s[28:31], s70 offen lds
    ds_read_b64_tr_b16 v[144:145], v14 offset:1024
    ds_read_b64_tr_b16 v[148:149], v14 offset:2048
    ds_read_b64_tr_b16 v[152:153], v14 offset:3072
    s_add_u32 m0, s69, 87040
    s_nop 0
    buffer_load_dwordx4 v45, s[28:31], s70 offen lds
    ds_read_b64_tr_b16 v[156:157], v14 offset:4096
    ds_read_b64_tr_b16 v[160:161], v14 offset:5120
    s_add_u32 m0, s69, 88064
    s_nop 0
    buffer_load_dwordx4 v46, s[28:31], s70 offen lds
    ds_read_b64_tr_b16 v[164:165], v14 offset:6144
    s_mov_b32 s4, 0x790070
    s_mov_b32 s5, 0x1c901c0
    v_lshrrev_b64 v[16:17], v12, s[4:5]
    v_and_b32 v16, 0xffff, v16
    v_lshlrev_b32 v16, 6, v16
    v_xad_u32 v15, v16, v10, v11
    s_add_u32 m0, s69, 89088
    s_nop 0
    buffer_load_dwordx4 v47, s[28:31], s70 offen lds
    ds_read_b64_tr_b16 v[142:143], v15 offset:0
    ds_read_b64_tr_b16 v[146:147], v15 offset:1024
    s_add_u32 m0, s69, 90112
    s_nop 0
    buffer_load_dwordx4 v48, s[28:31], s70 offen lds
    ds_read_b64_tr_b16 v[150:151], v15 offset:2048
    ds_read_b64_tr_b16 v[154:155], v15 offset:3072
    ds_read_b64_tr_b16 v[158:159], v15 offset:4096
    s_add_u32 m0, s69, 91136
    s_nop 0
    buffer_load_dwordx4 v49, s[28:31], s70 offen lds
    ds_read_b64_tr_b16 v[162:163], v15 offset:5120
    ds_read_b64_tr_b16 v[166:167], v15 offset:6144
    s_add_u32 m0, s69, 92160
    s_nop 0
    buffer_load_dwordx4 v50, s[28:31], s70 offen lds
    s_add_u32 s70, s70, 28672
    s_waitcnt vmcnt(14)
    s_waitcnt vmcnt(7)
    s_waitcnt lgkmcnt(0)
    s_barrier
    s_cmp_lg_u32 s56, 0
    s_cbranch_scc1 L_pub_39
    v_add_u32 v255, s66, v1
    v_mov_b32 v16, s71
    v_cmp_gt_u32 vcc, 2, v1
    s_nop 1
    v_cndmask_b32 v255, v16, v255, vcc
    v_lshlrev_b32 v255, 7, v255
    v_mov_b32 v254, s57
    s_mov_b32 s4, 196608
    s_mov_b64 exec, 7
    buffer_store_dword v254, v255, s[40:43], s4 offen sc1
    s_mov_b64 exec, -1
L_pub_39:
    s_mov_b32 s4, 0x1590150
    s_mov_b32 s5, 0x2a00239
    v_lshrrev_b64 v[16:17], v12, s[4:5]
    v_and_b32 v16, 0xffff, v16
    v_lshlrev_b32 v16, 6, v16
    v_xad_u32 v14, v16, v10, v11
    ds_read_b64_tr_b16 v[168:169], v14 offset:0
    ds_read_b64_tr_b16 v[172:173], v14 offset:1024
    ds_read_b64_tr_b16 v[176:177], v14 offset:2048
    ds_read_b64_tr_b16 v[180:181], v14 offset:3072
    ds_read_b64_tr_b16 v[184:185], v14 offset:4096
    ds_read_b64_tr_b16 v[188:189], v14 offset:5120
    ds_read_b64_tr_b16 v[192:193], v14 offset:6144
    s_mov_b32 s4, 0x3100230
    s_mov_b32 s5, 0x3800319
    v_lshrrev_b64 v[16:17], v12, s[4:5]
    v_and_b32 v16, 0xffff, v16
    v_lshlrev_b32 v16, 6, v16
    v_xad_u32 v15, v16, v10, v11
    ds_read_b64_tr_b16 v[170:171], v15 offset:0
    ds_read_b64_tr_b16 v[174:175], v15 offset:1024
    ds_read_b64_tr_b16 v[178:179], v15 offset:2048
    ds_read_b64_tr_b16 v[182:183], v15 offset:3072
    ds_read_b64_tr_b16 v[186:187], v15 offset:4096
    ds_read_b64_tr_b16 v[190:191], v15 offset:5120
    ds_read_b64_tr_b16 v[194:195], v15 offset:6144
    s_waitcnt vmcnt(0)
    s_waitcnt lgkmcnt(0)
    s_barrier
    s_mov_b32 s4, 0x3f002a9
    s_mov_b32 s5, 0x46003f9
    v_lshrrev_b64 v[16:17], v12, s[4:5]
    v_and_b32 v16, 0xffff, v16
    v_lshlrev_b32 v16, 6, v16
    v_xad_u32 v14, v16, v10, v11
    ds_read_b64_tr_b16 v[196:197], v14 offset:0
    ds_read_b64_tr_b16 v[200:201], v14 offset:1024
    ds_read_b64_tr_b16 v[204:205], v14 offset:2048
    ds_read_b64_tr_b16 v[208:209], v14 offset:3072
    ds_read_b64_tr_b16 v[212:213], v14 offset:4096
    ds_read_b64_tr_b16 v[216:217], v14 offset:5120
    ds_read_b64_tr_b16 v[220:221], v14 offset:6144
    s_mov_b32 s4, 0x4d00389
    s_mov_b32 s5, 0x54004d9
    v_lshrrev_b64 v[16:17], v12, s[4:5]
    v_and_b32 v16, 0xffff, v16
    v_lshlrev_b32 v16, 6, v16
    v_xad_u32 v15, v16, v10, v11
    ds_read_b64_tr_b16 v[198:199], v15 offset:0
    ds_read_b64_tr_b16 v[202:203], v15 offset:1024
    ds_read_b64_tr_b16 v[206:207], v15 offset:2048
    ds_read_b64_tr_b16 v[210:211], v15 offset:3072
    ds_read_b64_tr_b16 v[214:215], v15 offset:4096
    ds_read_b64_tr_b16 v[218:219], v15 offset:5120
    ds_read_b64_tr_b16 v[222:223], v15 offset:6144
    s_waitcnt vmcnt(0)
    s_waitcnt lgkmcnt(0)
    s_barrier
    s_mov_b32 s4, 0x5490469
    s_mov_b32 s5, 0x5b905b0
    v_lshrrev_b64 v[16:17], v12, s[4:5]
    v_and_b32 v16, 0xffff, v16
    v_lshlrev_b32 v16, 6, v16
    v_xad_u32 v14, v16, v10, v11
    ds_read_b64_tr_b16 v[224:225], v14 offset:0
    ds_read_b64_tr_b16 v[228:229], v14 offset:1024
    ds_read_b64_tr_b16 v[232:233], v14 offset:2048
    ds_read_b64_tr_b16 v[236:237], v14 offset:3072
    ds_read_b64_tr_b16 v[240:241], v14 offset:4096
    ds_read_b64_tr_b16 v[244:245], v14 offset:5120
    ds_read_b64_tr_b16 v[248:249], v14 offset:6144
    s_mov_b32 s4, 0x6290620
    s_mov_b32 s5, 0x6990690
    v_lshrrev_b64 v[16:17], v12, s[4:5]
    v_and_b32 v16, 0xffff, v16
    v_lshlrev_b32 v16, 6, v16
    v_xad_u32 v15, v16, v10, v11
    ds_read_b64_tr_b16 v[226:227], v15 offset:0
    ds_read_b64_tr_b16 v[230:231], v15 offset:1024
    ds_read_b64_tr_b16 v[234:235], v15 offset:2048
    ds_read_b64_tr_b16 v[238:239], v15 offset:3072
    ds_read_b64_tr_b16 v[242:243], v15 offset:4096
    ds_read_b64_tr_b16 v[246:247], v15 offset:5120
    ds_read_b64_tr_b16 v[250:251], v15 offset:6144
    s_waitcnt lgkmcnt(0)
    s_barrier
    s_cmp_eq_u32 s72, 0
    s_cbranch_scc1 L_loc_40
    s_and_b32 s4, s56, 1
    s_mul_i32 s69, s4, 7168
    s_mul_i32 s4, s71, 14336
    s_add_u32 s4, s4, s69
    s_add_u32 m0, s69, 49152
    s_nop 0
    buffer_load_dwordx4 v44, s[20:23], s4 offen lds
    s_add_u32 m0, s69, 50176
    s_nop 0
    buffer_load_dwordx4 v45, s[20:23], s4 offen lds
    s_add_u32 m0, s69, 51200
    s_nop 0
    buffer_load_dwordx4 v46, s[20:23], s4 offen lds
    s_add_u32 m0, s69, 52224
    s_nop 0
    buffer_load_dwordx4 v47, s[20:23], s4 offen lds
    s_add_u32 m0, s69, 53248
    s_nop 0
    buffer_load_dwordx4 v48, s[20:23], s4 offen lds
    s_add_u32 m0, s69, 54272
    s_nop 0
    buffer_load_dwordx4 v49, s[20:23], s4 offen lds
    s_add_u32 m0, s69, 55296
    s_nop 0
    buffer_load_dwordx4 v50, s[20:23], s4 offen lds
L_loc_40:
    v_mov_b32 v28, -1
    v_mov_b32 v29, -1
    v_mov_b32 v30, -1
    v_mov_b32 v31, -1
    s_lshr_b32 s9, s56, 1
    s_lshl_b32 s9, s9, 18
    s_and_b32 s10, s56, 1
    s_lshl_b32 s10, s10, 10
    s_add_u32 s9, s9, s10
    s_add_u32 s9, s9, 2883584
    s_lshr_b32 s11, s56, 1
    s_sub_u32 s11, 1, s11
    s_mul_i32 s11, s11, 524288
    s_lshl_b32 s7, s66, 11
    s_add_u32 s7, s7, s9
    buffer_store_dwordx4 v[28:31], v2, s[40:43], s7 offen sc1
    s_add_u32 s7, s7, 524288
    buffer_store_dwordx4 v[28:31], v2, s[40:43], s7 offen sc1
    s_add_u32 s7, s7, 524288
    buffer_store_dwordx4 v[28:31], v2, s[40:43], s7 offen sc1
    s_add_u32 s7, s7, s11
    buffer_store_dwordx4 v[28:31], v2, s[40:43], s7 offen sc1
    s_lshl_b32 s7, s68, 11
    s_add_u32 s7, s7, s9
    buffer_store_dwordx4 v[28:31], v2, s[40:43], s7 offen sc1
    s_add_u32 s7, s7, 524288
    buffer_store_dwordx4 v[28:31], v2, s[40:43], s7 offen sc1
    s_add_u32 s7, s7, 524288
    buffer_store_dwordx4 v[28:31], v2, s[40:43], s7 offen sc1
    s_add_u32 s7, s7, s11
    buffer_store_dwordx4 v[28:31], v2, s[40:43], s7 offen sc1
    s_cmp_eq_u32 s72, 0
    s_cbranch_scc1 L_loc_41
    s_lshl_b32 s7, s71, 11
    s_add_u32 s7, s7, s9
    buffer_store_dwordx4 v[28:31], v2, s[40:43], s7 offen sc1
    s_add_u32 s7, s7, 524288
    buffer_store_dwordx4 v[28:31], v2, s[40:43], s7 offen sc1
    s_add_u32 s7, s7, 524288
    buffer_store_dwordx4 v[28:31], v2, s[40:43], s7 offen sc1
    s_add_u32 s7, s7, s11
    buffer_store_dwordx4 v[28:31], v2, s[40:43], s7 offen sc1
    s_branch L_loc_42
L_loc_41:
    s_sub_u32 s10, s59, 16
    s_min_u32 s8, s10, 4
    s_add_u32 s10, s10, 5
    s_bitcmp1_b32 s58, 0
    s_cselect_b32 s10, s10, s8
    s_lshr_b32 s8, s58, 1
    s_mul_i32 s8, s8, 13
    s_add_u32 s10, s10, s8
    s_lshl_b32 s10, s10, 2
    s_add_u32 s10, s10, s56
    s_mul_i32 s10, s10, 7808
    s_add_u32 s10, s10, 4718592
    buffer_store_dwordx4 v[28:31], v2, s[40:43], s10 offen sc1
    s_add_u32 s10, s10, 1024
    buffer_store_dwordx4 v[28:31], v2, s[40:43], s10 offen sc1
    s_add_u32 s10, s10, 1024
    buffer_store_dwordx4 v[28:31], v2, s[40:43], s10 offen sc1
    s_add_u32 s10, s10, 1024
    buffer_store_dwordx4 v[28:31], v2, s[40:43], s10 offen sc1
    s_add_u32 s10, s10, 1024
    buffer_store_dwordx4 v[28:31], v2, s[40:43], s10 offen sc1
    s_add_u32 s10, s10, 1024
    buffer_store_dwordx4 v[28:31], v2, s[40:43], s10 offen sc1
    s_add_u32 s10, s10, 1024
    buffer_store_dwordx4 v[28:31], v2, s[40:43], s10 offen sc1
    s_add_u32 s10, s10, 640
    buffer_store_dwordx4 v[28:31], v2, s[40:43], s10 offen sc1
    s_add_u32 s10, s10, 640
L_loc_42:
    s_mul_i32 s4, s66, 14336
    s_add_u32 s4, s4, 1048576
    s_mul_i32 s5, s68, 14336
    s_add_u32 s5, s5, 1048576
    s_mul_i32 s6, s71, 14336
    s_add_u32 s6, s6, 1048576
    v_mov_b32 v254, s57
    v_lshlrev_b32 v255, 7, v1
    v_and_b32 v252, 48, v1
    s_mov_b32 s15, s14
    s_lshl_b32 s7, s56, 4
    s_lshl_b64 s[74:75], 1, s7
    v_bfe_u32 v0, v1, 3, 1
    v_lshl_add_u32 v0, v0, 7, v252
    s_lshl_b32 s7, s56, 8
    s_add_u32 s7, s7, 45056
    v_lshrrev_b32 v4, 2, v1
    v_lshl_add_u32 v4, v4, 4, s7
    s_waitcnt vmcnt(0)
    s_barrier
    s_cmp_lg_u32 s56, 0
    s_cbranch_scc1 L_pub_43
    s_lshl_b32 s7, s58, 3
    s_add_u32 s7, s7, s59
    s_sub_u32 s7, s7, 16
    s_lshl_b32 s7, s7, 7
    s_add_u32 s7, s7, 4096
    s_mov_b64 exec, 1
    buffer_store_dword v254, v255, s[40:43], s7 offen sc1
    s_mov_b64 exec, -1
L_pub_43:
    s_mov_b32 exec_lo, 0xff
    s_mov_b32 exec_hi, 0x0
L_poll_44:
    buffer_load_dword v53, v52, s[40:43], s4 offen sc1
L_poll_44_chk:
    s_add_u32 s77, s77, 1
    s_waitcnt vmcnt(0)
    v_cmp_eq_u32 vcc, -1, v53
    s_cmp_ge_u32 s77, 50000
    s_cbranch_scc1 L_seen_45
    s_and_b64 exec, exec, vcc
    s_cbranch_scc1 L_poll_44
L_seen_45:
    s_mov_b64 exec, -1
    s_mov_b32 s73, 0
L_o_fetch:
    v_mov_b32 v32, 0
    s_add_u32 m0, s16, 0
    s_add_u32 s11, s4, s16
    buffer_load_dwordx4 v2, s[40:43], s11 offen sc1 lds
    s_add_u32 m0, s16, 14336
    s_add_u32 s11, s5, s16
    buffer_load_dwordx4 v2, s[40:43], s11 offen sc1 lds
    s_add_u32 m0, s17, 0
    s_add_u32 s11, s4, s17
    buffer_load_dwordx4 v2, s[40:43], s11 offen sc1 lds
    s_add_u32 m0, s17, 14336
    s_add_u32 s11, s5, s17
    buffer_load_dwordx4 v2, s[40:43], s11 offen sc1 lds
    s_add_u32 m0, s18, 0
    s_add_u32 s11, s4, s18
    buffer_load_dwordx4 v2, s[40:43], s11 offen sc1 lds
    s_add_u32 m0, s18, 14336
    s_add_u32 s11, s5, s18
    buffer_load_dwordx4 v2, s[40:43], s11 offen sc1 lds
    s_add_u32 m0, s19, 0
    s_add_u32 s11, s4, s19
    buffer_load_dwordx4 v2, s[40:43], s11 offen sc1 lds
    s_add_u32 m0, s19, 14336
    s_add_u32 s11, s5, s19
    buffer_load_dwordx4 v2, s[40:43], s11 offen sc1 lds
    s_waitcnt vmcnt(6)
    s_barrier
    ds_read_b128 v[8:11], v2 offset:0
    ds_read_b128 v[12:15], v2 offset:14336
    ds_read_b128 v[16:19], v2 offset:1024
    ds_read_b128 v[20:23], v2 offset:15360
    s_waitcnt lgkmcnt(2)
    v_mfma_f32_16x16x32_bf16 v[60:63], v[8:11], a[0:3], v[60:63]
    ds_read_b128 v[24:27], v2 offset:2048
    ds_read_b128 v[28:31], v2 offset:16384
    v_mfma_f32_16x16x32_bf16 v[88:91], v[12:15], a[0:3], v[88:91]
    v_max3_u32 v32, v32, v8, v12
    v_mfma_f32_16x16x32_bf16 v[64:67], v[8:11], a[4:7], v[64:67]
    v_mfma_f32_16x16x32_bf16 v[92:95], v[12:15], a[4:7], v[92:95]
    v_mfma_f32_16x16x32_bf16 v[68:71], v[8:11], a[8:11], v[68:71]
    v_mfma_f32_16x16x32_bf16 v[96:99], v[12:15], a[8:11], v[96:99]
    v_mfma_f32_16x16x32_bf16 v[72:75], v[8:11], a[12:15], v[72:75]
    v_mfma_f32_16x16x32_bf16 v[100:103], v[12:15], a[12:15], v[100:103]
    v_mfma_f32_16x16x32_bf16 v[76:79], v[8:11], a[16:19], v[76:79]
    v_mfma_f32_16x16x32_bf16 v[104:107], v[12:15], a[16:19], v[104:107]
    v_mfma_f32_16x16x32_bf16 v[80:83], v[8:11], a[20:23], v[80:83]
    v_mfma_f32_16x16x32_bf16 v[108:111], v[12:15], a[20:23], v[108:111]
    v_mfma_f32_16x16x32_bf16 v[84:87], v[8:11], a[24:27], v[84:87]
    v_mfma_f32_16x16x32_bf16 v[112:115], v[12:15], a[24:27], v[112:115]
    s_waitcnt lgkmcnt(2)
    v_mfma_f32_16x16x32_bf16 v[60:63], v[16:19], a[28:31], v[60:63]
    ds_read_b128 v[8:11], v2 offset:3072
    ds_read_b128 v[12:15], v2 offset:17408
    v_mfma_f32_16x16x32_bf16 v[88:91], v[20:23], a[28:31], v[88:91]
    v_max3_u32 v32, v32, v16, v20
    v_mfma_f32_16x16x32_bf16 v[64:67], v[16:19], a[32:35], v[64:67]
    v_mfma_f32_16x16x32_bf16 v[92:95], v[20:23], a[32:35], v[92:95]
    v_mfma_f32_16x16x32_bf16 v[68:71], v[16:19], a[36:39], v[68:71]
    v_mfma_f32_16x16x32_bf16 v[96:99], v[20:23], a[36:39], v[96:99]
    v_mfma_f32_16x16x32_bf16 v[72:75], v[16:19], a[40:43], v[72:75]
    v_mfma_f32_16x16x32_bf16 v[100:103], v[20:23], a[40:43], v[100:103]
    v_mfma_f32_16x16x32_bf16 v[76:79], v[16:19], a[44:47], v[76:79]
    v_mfma_f32_16x16x32_bf16 v[104:107], v[20:23], a[44:47], v[104:107]
    v_mfma_f32_16x16x32_bf16 v[80:83], v[16:19], a[48:51], v[80:83]
    v_mfma_f32_16x16x32_bf16 v[108:111], v[20:23], a[48:51], v[108:111]
    v_mfma_f32_16x16x32_bf16 v[84:87], v[16:19], a[52:55], v[84:87]
    v_mfma_f32_16x16x32_bf16 v[112:115], v[20:23], a[52:55], v[112:115]
    s_waitcnt vmcnt(0)
    s_barrier
    s_waitcnt lgkmcnt(2)
    v_mfma_f32_16x16x32_bf16 v[60:63], v[24:27], a[56:59], v[60:63]
    ds_read_b128 v[16:19], v2 offset:4096
    ds_read_b128 v[20:23], v2 offset:18432
    v_mfma_f32_16x16x32_bf16 v[88:91], v[28:31], a[56:59], v[88:91]
    v_max3_u32 v32, v32, v24, v28
    v_mfma_f32_16x16x32_bf16 v[64:67], v[24:27], a[60:63], v[64:67]
    v_mfma_f32_16x16x32_bf16 v[92:95], v[28:31], a[60:63], v[92:95]
    v_mfma_f32_16x16x32_bf16 v[68:71], v[24:27], a[64:67], v[68:71]
    s_add_u32 m0, s16, 28672
    s_add_u32 s11, s6, s16
    buffer_load_dwordx4 v2, s[40:43], s11 offen sc1 lds
    v_mfma_f32_16x16x32_bf16 v[96:99], v[28:31], a[64:67], v[96:99]
    v_mfma_f32_16x16x32_bf16 v[72:75], v[24:27], a[68:71], v[72:75]
    v_mfma_f32_16x16x32_bf16 v[100:103], v[28:31], a[68:71], v[100:103]
    v_mfma_f32_16x16x32_bf16 v[76:79], v[24:27], a[72:75], v[76:79]
    v_mfma_f32_16x16x32_bf16 v[104:107], v[28:31], a[72:75], v[104:107]
    v_mfma_f32_16x16x32_bf16 v[80:83], v[24:27], a[76:79], v[80:83]
    v_mfma_f32_16x16x32_bf16 v[108:111], v[28:31], a[76:79], v[108:111]
    v_mfma_f32_16x16x32_bf16 v[84:87], v[24:27], a[80:83], v[84:87]
    v_mfma_f32_16x16x32_bf16 v[112:115], v[28:31], a[80:83], v[112:115]
    s_waitcnt lgkmcnt(2)
    v_mfma_f32_16x16x32_bf16 v[60:63], v[8:11], a[84:87], v[60:63]
    ds_read_b128 v[24:27], v2 offset:5120
    ds_read_b128 v[28:31], v2 offset:19456
    v_mfma_f32_16x16x32_bf16 v[88:91], v[12:15], a[84:87], v[88:91]
    v_max3_u32 v32, v32, v8, v12
    v_mfma_f32_16x16x32_bf16 v[64:67], v[8:11], a[88:91], v[64:67]
    v_mfma_f32_16x16x32_bf16 v[92:95], v[12:15], a[88:91], v[92:95]
    v_mfma_f32_16x16x32_bf16 v[68:71], v[8:11], a[92:95], v[68:71]
    s_add_u32 m0, s17, 28672
    s_add_u32 s11, s6, s17
    buffer_load_dwordx4 v2, s[40:43], s11 offen sc1 lds
    v_mfma_f32_16x16x32_bf16 v[96:99], v[12:15], a[92:95], v[96:99]
    v_mfma_f32_16x16x32_bf16 v[72:75], v[8:11], a[96:99], v[72:75]
    v_mfma_f32_16x16x32_bf16 v[100:103], v[12:15], a[96:99], v[100:103]
    v_mfma_f32_16x16x32_bf16 v[76:79], v[8:11], a[100:103], v[76:79]
    v_mfma_f32_16x16x32_bf16 v[104:107], v[12:15], a[100:103], v[104:107]
    v_mfma_f32_16x16x32_bf16 v[80:83], v[8:11], a[104:107], v[80:83]
    v_mfma_f32_16x16x32_bf16 v[108:111], v[12:15], a[104:107], v[108:111]
    v_mfma_f32_16x16x32_bf16 v[84:87], v[8:11], a[108:111], v[84:87]
    v_mfma_f32_16x16x32_bf16 v[112:115], v[12:15], a[108:111], v[112:115]
    s_waitcnt lgkmcnt(2)
    v_mfma_f32_16x16x32_bf16 v[60:63], v[16:19], a[112:115], v[60:63]
    ds_read_b128 v[8:11], v2 offset:6144
    ds_read_b128 v[12:15], v2 offset:20480
    v_mfma_f32_16x16x32_bf16 v[88:91], v[20:23], a[112:115], v[88:91]
    v_max3_u32 v32, v32, v16, v20
    v_mfma_f32_16x16x32_bf16 v[64:67], v[16:19], a[116:119], v[64:67]
    v_mfma_f32_16x16x32_bf16 v[92:95], v[20:23], a[116:119], v[92:95]
    v_mfma_f32_16x16x32_bf16 v[68:71], v[16:19], a[120:123], v[68:71]
    s_add_u32 m0, s18, 28672
    s_add_u32 s11, s6, s18
    buffer_load_dwordx4 v2, s[40:43], s11 offen sc1 lds
    v_mfma_f32_16x16x32_bf16 v[96:99], v[20:23], a[120:123], v[96:99]
    v_mfma_f32_16x16x32_bf16 v[72:75], v[16:19], a[124:127], v[72:75]
    v_mfma_f32_16x16x32_bf16 v[100:103], v[20:23], a[124:127], v[100:103]
    v_mfma_f32_16x16x32_bf16 v[76:79], v[16:19], a[128:131], v[76:79]
    v_mfma_f32_16x16x32_bf16 v[104:107], v[20:23], a[128:131], v[104:107]
    v_mfma_f32_16x16x32_bf16 v[80:83], v[16:19], a[132:135], v[80:83]
    v_mfma_f32_16x16x32_bf16 v[108:111], v[20:23], a[132:135], v[108:111]
    v_mfma_f32_16x16x32_bf16 v[84:87], v[16:19], a[136:139], v[84:87]
    v_mfma_f32_16x16x32_bf16 v[112:115], v[20:23], a[136:139], v[112:115]
    s_waitcnt lgkmcnt(2)
    v_mfma_f32_16x16x32_bf16 v[60:63], v[24:27], a[140:143], v[60:63]
    ds_read_b128 v[16:19], v2 offset:7168
    ds_read_b128 v[20:23], v2 offset:21504
    v_mfma_f32_16x16x32_bf16 v[88:91], v[28:31], a[140:143], v[88:91]
    v_max3_u32 v32, v32, v24, v28
    v_mfma_f32_16x16x32_bf16 v[64:67], v[24:27], a[144:147], v[64:67]
    v_mfma_f32_16x16x32_bf16 v[92:95], v[28:31], a[144:147], v[92:95]
    v_mfma_f32_16x16x32_bf16 v[68:71], v[24:27], a[148:151], v[68:71]
    s_add_u32 m0, s19, 28672
    s_add_u32 s11, s6, s19
    buffer_load_dwordx4 v2, s[40:43], s11 offen sc1 lds
    v_mfma_f32_16x16x32_bf16 v[96:99], v[28:31], a[148:151], v[96:99]
    v_mfma_f32_16x16x32_bf16 v[72:75], v[24:27], a[152:155], v[72:75]
    v_mfma_f32_16x16x32_bf16 v[100:103], v[28:31], a[152:155], v[100:103]
    v_mfma_f32_16x16x32_bf16 v[76:79], v[24:27], a[156:159], v[76:79]
    v_mfma_f32_16x16x32_bf16 v[104:107], v[28:31], a[156:159], v[104:107]
    v_mfma_f32_16x16x32_bf16 v[80:83], v[24:27], a[160:163], v[80:83]
    v_mfma_f32_16x16x32_bf16 v[108:111], v[28:31], a[160:163], v[108:111]
    v_mfma_f32_16x16x32_bf16 v[84:87], v[24:27], a[164:167], v[84:87]
    v_mfma_f32_16x16x32_bf16 v[112:115], v[28:31], a[164:167], v[112:115]
    s_waitcnt lgkmcnt(2)
    v_mfma_f32_16x16x32_bf16 v[60:63], v[8:11], a[168:171], v[60:63]
    ds_read_b128 v[24:27], v2 offset:8192
    ds_read_b128 v[28:31], v2 offset:22528
    v_mfma_f32_16x16x32_bf16 v[88:91], v[12:15], a[168:171], v[88:91]
    v_max3_u32 v32, v32, v8, v12
    v_mfma_f32_16x16x32_bf16 v[64:67], v[8:11], a[172:175], v[64:67]
    v_mfma_f32_16x16x32_bf16 v[92:95], v[12:15], a[172:175], v[92:95]
    v_mfma_f32_16x16x32_bf16 v[68:71], v[8:11], a[176:179], v[68:71]
    v_mfma_f32_16x16x32_bf16 v[96:99], v[12:15], a[176:179], v[96:99]
    v_mfma_f32_16x16x32_bf16 v[72:75], v[8:11], a[180:183], v[72:75]
    v_mfma_f32_16x16x32_bf16 v[100:103], v[12:15], a[180:183], v[100:103]
    v_mfma_f32_16x16x32_bf16 v[76:79], v[8:11], a[184:187], v[76:79]
    v_mfma_f32_16x16x32_bf16 v[104:107], v[12:15], a[184:187], v[104:107]
    v_mfma_f32_16x16x32_bf16 v[80:83], v[8:11], a[188:191], v[80:83]
    v_mfma_f32_16x16x32_bf16 v[108:111], v[12:15], a[188:191], v[108:111]
    v_mfma_f32_16x16x32_bf16 v[84:87], v[8:11], a[192:195], v[84:87]
    v_mfma_f32_16x16x32_bf16 v[112:115], v[12:15], a[192:195], v[112:115]
    s_waitcnt lgkmcnt(2)
    v_mfma_f32_16x16x32_bf16 v[60:63], v[16:19], a[196:199], v[60:63]
    ds_read_b128 v[8:11], v2 offset:9216
    ds_read_b128 v[12:15], v2 offset:23552
    v_mfma_f32_16x16x32_bf16 v[88:91], v[20:23], a[196:199], v[88:91]
    v_max3_u32 v32, v32, v16, v20
    v_mfma_f32_16x16x32_bf16 v[64:67], v[16:19], a[200:203], v[64:67]
    v_mfma_f32_16x16x32_bf16 v[92:95], v[20:23], a[200:203], v[92:95]
    v_mfma_f32_16x16x32_bf16 v[68:71], v[16:19], a[204:207], v[68:71]
    v_mfma_f32_16x16x32_bf16 v[96:99], v[20:23], a[204:207], v[96:99]
    v_mfma_f32_16x16x32_bf16 v[72:75], v[16:19], a[208:211], v[72:75]
    v_mfma_f32_16x16x32_bf16 v[100:103], v[20:23], a[208:211], v[100:103]
    v_mfma_f32_16x16x32_bf16 v[76:79], v[16:19], a[212:215], v[76:79]
    v_mfma_f32_16x16x32_bf16 v[104:107], v[20:23], a[212:215], v[104:107]
    v_mfma_f32_16x16x32_bf16 v[80:83], v[16:19], a[216:219], v[80:83]
    v_mfma_f32_16x16x32_bf16 v[108:111], v[20:23], a[216:219], v[108:111]
    v_mfma_f32_16x16x32_bf16 v[84:87], v[16:19], a[220:223], v[84:87]
    v_mfma_f32_16x16x32_bf16 v[112:115], v[20:23], a[220:223], v[112:115]
    s_waitcnt lgkmcnt(2)
    v_mfma_f32_16x16x32_bf16 v[60:63], v[24:27], a[224:227], v[60:63]
    ds_read_b128 v[16:19], v2 offset:10240
    ds_read_b128 v[20:23], v2 offset:24576
    v_mfma_f32_16x16x32_bf16 v[88:91], v[28:31], a[224:227], v[88:91]
    v_max3_u32 v32, v32, v24, v28
    v_mfma_f32_16x16x32_bf16 v[64:67], v[24:27], a[228:231], v[64:67]
    v_mfma_f32_16x16x32_bf16 v[92:95], v[28:31], a[228:231], v[92:95]
    v_mfma_f32_16x16x32_bf16 v[68:71], v[24:27], a[232:235], v[68:71]
    v_mfma_f32_16x16x32_bf16 v[96:99], v[28:31], a[232:235], v[96:99]
    v_mfma_f32_16x16x32_bf16 v[72:75], v[24:27], a[236:239], v[72:75]
    v_mfma_f32_16x16x32_bf16 v[100:103], v[28:31], a[236:239], v[100:103]
    v_mfma_f32_16x16x32_bf16 v[76:79], v[24:27], a[240:243], v[76:79]
    v_mfma_f32_16x16x32_bf16 v[104:107], v[28:31], a[240:243], v[104:107]
    v_mfma_f32_16x16x32_bf16 v[80:83], v[24:27], a[244:247], v[80:83]
    v_mfma_f32_16x16x32_bf16 v[108:111], v[28:31], a[244:247], v[108:111]
    v_mfma_f32_16x16x32_bf16 v[84:87], v[24:27], a[248:251], v[84:87]
    v_mfma_f32_16x16x32_bf16 v[112:115], v[28:31], a[248:251], v[112:115]
    s_waitcnt lgkmcnt(2)
    v_mfma_f32_16x16x32_bf16 v[60:63], v[8:11], a[252:255], v[60:63]
    ds_read_b128 v[24:27], v2 offset:11264
    ds_read_b128 v[28:31], v2 offset:25600
    v_mfma_f32_16x16x32_bf16 v[88:91], v[12:15], a[252:255], v[88:91]
    v_max3_u32 v32, v32, v8, v12
    v_mfma_f32_16x16x32_bf16 v[64:67], v[8:11], v[116:119], v[64:67]
    v_mfma_f32_16x16x32_bf16 v[92:95], v[12:15], v[116:119], v[92:95]
    v_mfma_f32_16x16x32_bf16 v[68:71], v[8:11], v[120:123], v[68:71]
    v_mfma_f32_16x16x32_bf16 v[96:99], v[12:15], v[120:123], v[96:99]
    v_mfma_f32_16x16x32_bf16 v[72:75], v[8:11], v[124:127], v[72:75]
    v_mfma_f32_16x16x32_bf16 v[100:103], v[12:15], v[124:127], v[100:103]
    v_mfma_f32_16x16x32_bf16 v[76:79], v[8:11], v[128:131], v[76:79]
    v_mfma_f32_16x16x32_bf16 v[104:107], v[12:15], v[128:131], v[104:107]
    v_mfma_f32_16x16x32_bf16 v[80:83], v[8:11], v[132:135], v[80:83]
    v_mfma_f32_16x16x32_bf16 v[108:111], v[12:15], v[132:135], v[108:111]
    v_mfma_f32_16x16x32_bf16 v[84:87], v[8:11], v[136:139], v[84:87]
    v_mfma_f32_16x16x32_bf16 v[112:115], v[12:15], v[136:139], v[112:115]
    s_waitcnt lgkmcnt(2)
    v_mfma_f32_16x16x32_bf16 v[60:63], v[16:19], v[140:143], v[60:63]
    ds_read_b128 v[8:11], v2 offset:12288
    ds_read_b128 v[12:15], v2 offset:26624
    v_mfma_f32_16x16x32_bf16 v[88:91], v[20:23], v[140:143], v[88:91]
    v_max3_u32 v32, v32, v16, v20
    v_mfma_f32_16x16x32_bf16 v[64:67], v[16:19], v[144:147], v[64:67]
    v_mfma_f32_16x16x32_bf16 v[92:95], v[20:23], v[144:147], v[92:95]
    v_mfma_f32_16x16x32_bf16 v[68:71], v[16:19], v[148:151], v[68:71]
    v_mfma_f32_16x16x32_bf16 v[96:99], v[20:23], v[148:151], v[96:99]
    v_mfma_f32_16x16x32_bf16 v[72:75], v[16:19], v[152:155], v[72:75]
    v_mfma_f32_16x16x32_bf16 v[100:103], v[20:23], v[152:155], v[100:103]
    v_mfma_f32_16x16x32_bf16 v[76:79], v[16:19], v[156:159], v[76:79]
    v_mfma_f32_16x16x32_bf16 v[104:107], v[20:23], v[156:159], v[104:107]
    v_mfma_f32_16x16x32_bf16 v[80:83], v[16:19], v[160:163], v[80:83]
    v_mfma_f32_16x16x32_bf16 v[108:111], v[20:23], v[160:163], v[108:111]
    v_mfma_f32_16x16x32_bf16 v[84:87], v[16:19], v[164:167], v[84:87]
    v_mfma_f32_16x16x32_bf16 v[112:115], v[20:23], v[164:167], v[112:115]
    s_waitcnt lgkmcnt(2)
    v_mfma_f32_16x16x32_bf16 v[60:63], v[24:27], v[168:171], v[60:63]
    ds_read_b128 v[16:19], v2 offset:13312
    ds_read_b128 v[20:23], v2 offset:27648
    v_mfma_f32_16x16x32_bf16 v[88:91], v[28:31], v[168:171], v[88:91]
    v_max3_u32 v32, v32, v24, v28
    v_mfma_f32_16x16x32_bf16 v[64:67], v[24:27], v[172:175], v[64:67]
    v_mfma_f32_16x16x32_bf16 v[92:95], v[28:31], v[172:175], v[92:95]
    v_mfma_f32_16x16x32_bf16 v[68:71], v[24:27], v[176:179], v[68:71]
    v_mfma_f32_16x16x32_bf16 v[96:99], v[28:31], v[176:179], v[96:99]
    v_mfma_f32_16x16x32_bf16 v[72:75], v[24:27], v[180:183], v[72:75]
    v_mfma_f32_16x16x32_bf16 v[100:103], v[28:31], v[180:183], v[100:103]
    v_mfma_f32_16x16x32_bf16 v[76:79], v[24:27], v[184:187], v[76:79]
    v_mfma_f32_16x16x32_bf16 v[104:107], v[28:31], v[184:187], v[104:107]
    v_mfma_f32_16x16x32_bf16 v[80:83], v[24:27], v[188:191], v[80:83]
    v_mfma_f32_16x16x32_bf16 v[108:111], v[28:31], v[188:191], v[108:111]
    v_mfma_f32_16x16x32_bf16 v[84:87], v[24:27], v[192:195], v[84:87]
    v_mfma_f32_16x16x32_bf16 v[112:115], v[28:31], v[192:195], v[112:115]
    s_waitcnt lgkmcnt(2)
    v_mfma_f32_16x16x32_bf16 v[60:63], v[8:11], v[196:199], v[60:63]
    v_mfma_f32_16x16x32_bf16 v[88:91], v[12:15], v[196:199], v[88:91]
    v_max3_u32 v32, v32, v8, v12
    v_mfma_f32_16x16x32_bf16 v[64:67], v[8:11], v[200:203], v[64:67]
    v_mfma_f32_16x16x32_bf16 v[92:95], v[12:15], v[200:203], v[92:95]
    v_mfma_f32_16x16x32_bf16 v[68:71], v[8:11], v[204:207], v[68:71]
    v_mfma_f32_16x16x32_bf16 v[96:99], v[12:15], v[204:207], v[96:99]
    v_mfma_f32_16x16x32_bf16 v[72:75], v[8:11], v[208:211], v[72:75]
    v_mfma_f32_16x16x32_bf16 v[100:103], v[12:15], v[208:211], v[100:103]
    v_mfma_f32_16x16x32_bf16 v[76:79], v[8:11], v[212:215], v[76:79]
    v_mfma_f32_16x16x32_bf16 v[104:107], v[12:15], v[212:215], v[104:107]
    v_mfma_f32_16x16x32_bf16 v[80:83], v[8:11], v[216:219], v[80:83]
    v_mfma_f32_16x16x32_bf16 v[108:111], v[12:15], v[216:219], v[108:111]
    v_mfma_f32_16x16x32_bf16 v[84:87], v[8:11], v[220:223], v[84:87]
    v_mfma_f32_16x16x32_bf16 v[112:115], v[12:15], v[220:223], v[112:115]
    s_waitcnt lgkmcnt(0)
    v_mfma_f32_16x16x32_bf16 v[60:63], v[16:19], v[224:227], v[60:63]
    v_mfma_f32_16x16x32_bf16 v[88:91], v[20:23], v[224:227], v[88:91]
    v_max3_u32 v32, v32, v16, v20
    v_mfma_f32_16x16x32_bf16 v[64:67], v[16:19], v[228:231], v[64:67]
    v_mfma_f32_16x16x32_bf16 v[92:95], v[20:23], v[228:231], v[92:95]
    v_mfma_f32_16x16x32_bf16 v[68:71], v[16:19], v[232:235], v[68:71]
    v_mfma_f32_16x16x32_bf16 v[96:99], v[20:23], v[232:235], v[96:99]
    v_mfma_f32_16x16x32_bf16 v[72:75], v[16:19], v[236:239], v[72:75]
    v_mfma_f32_16x16x32_bf16 v[100:103], v[20:23], v[236:239], v[100:103]
    v_mfma_f32_16x16x32_bf16 v[76:79], v[16:19], v[240:243], v[76:79]
    v_mfma_f32_16x16x32_bf16 v[104:107], v[20:23], v[240:243], v[104:107]
    v_mfma_f32_16x16x32_bf16 v[80:83], v[16:19], v[244:247], v[80:83]
    v_mfma_f32_16x16x32_bf16 v[108:111], v[20:23], v[244:247], v[108:111]
    v_mfma_f32_16x16x32_bf16 v[84:87], v[16:19], v[248:251], v[84:87]
    v_mfma_f32_16x16x32_bf16 v[112:115], v[20:23], v[248:251], v[112:115]
    v_cmp_eq_u32 vcc, -1, v32
    s_cbranch_vccnz L_o_redo
L_o_done:
    v_pk_mul_f32 v[12:13], v[60:61], v[60:61]
    v_pk_add_f32 v[8:9], v[60:61], v[64:65]
    v_pk_mul_f32 v[20:21], v[88:89], v[88:89]
    v_pk_add_f32 v[16:17], v[88:89], v[92:93]
    v_pk_mul_f32 v[14:15], v[62:63], v[62:63]
    v_pk_add_f32 v[10:11], v[62:63], v[66:67]
    v_pk_mul_f32 v[22:23], v[90:91], v[90:91]
    v_pk_add_f32 v[18:19], v[90:91], v[94:95]
    v_pk_fma_f32 v[12:13], v[64:65], v[64:65], v[12:13]
    v_pk_fma_f32 v[20:21], v[92:93], v[92:93], v[20:21]
    v_pk_fma_f32 v[14:15], v[66:67], v[66:67], v[14:15]
    v_pk_fma_f32 v[22:23], v[94:95], v[94:95], v[22:23]
    v_pk_add_f32 v[8:9], v[8:9], v[68:69]
    v_pk_fma_f32 v[12:13], v[68:69], v[68:69], v[12:13]
    v_pk_add_f32 v[16:17], v[16:17], v[96:97]
    v_pk_fma_f32 v[20:21], v[96:97], v[96:97], v[20:21]
    v_pk_add_f32 v[10:11], v[10:11], v[70:71]
    v_pk_fma_f32 v[14:15], v[70:71], v[70:71], v[14:15]
    v_pk_add_f32 v[18:19], v[18:19], v[98:99]
    v_pk_fma_f32 v[22:23], v[98:99], v[98:99], v[22:23]
    v_pk_add_f32 v[8:9], v[8:9], v[72:73]
    v_pk_fma_f32 v[12:13], v[72:73], v[72:73], v[12:13]
    v_pk_add_f32 v[16:17], v[16:17], v[100:101]
    v_pk_fma_f32 v[20:21], v[100:101], v[100:101], v[20:21]
    v_pk_add_f32 v[10:11], v[10:11], v[74:75]
    v_pk_fma_f32 v[14:15], v[74:75], v[74:75], v[14:15]
    v_pk_add_f32 v[18:19], v[18:19], v[102:103]
    v_pk_fma_f32 v[22:23], v[102:103], v[102:103], v[22:23]
    v_pk_add_f32 v[8:9], v[8:9], v[76:77]
    v_pk_fma_f32 v[12:13], v[76:77], v[76:77], v[12:13]
    v_pk_add_f32 v[16:17], v[16:17], v[104:105]
    v_pk_fma_f32 v[20:21], v[104:105], v[104:105], v[20:21]
    v_pk_add_f32 v[10:11], v[10:11], v[78:79]
    v_pk_fma_f32 v[14:15], v[78:79], v[78:79], v[14:15]
    v_pk_add_f32 v[18:19], v[18:19], v[106:107]
    v_pk_fma_f32 v[22:23], v[106:107], v[106:107], v[22:23]
    v_pk_add_f32 v[8:9], v[8:9], v[80:81]
    v_pk_fma_f32 v[12:13], v[80:81], v[80:81], v[12:13]
    v_pk_add_f32 v[16:17], v[16:17], v[108:109]
    v_pk_fma_f32 v[20:21], v[108:109], v[108:109], v[20:21]
    v_pk_add_f32 v[10:11], v[10:11], v[82:83]
    v_pk_fma_f32 v[14:15], v[82:83], v[82:83], v[14:15]
    v_pk_add_f32 v[18:19], v[18:19], v[110:111]
    v_pk_fma_f32 v[22:23], v[110:111], v[110:111], v[22:23]
    v_pk_add_f32 v[8:9], v[8:9], v[84:85]
    v_pk_fma_f32 v[12:13], v[84:85], v[84:85], v[12:13]
    v_pk_add_f32 v[16:17], v[16:17], v[112:113]
    v_pk_fma_f32 v[20:21], v[112:113], v[112:113], v[20:21]
    v_pk_add_f32 v[10:11], v[10:11], v[86:87]
    v_pk_fma_f32 v[14:15], v[86:87], v[86:87], v[14:15]
    v_pk_add_f32 v[18:19], v[18:19], v[114:115]
    v_pk_fma_f32 v[22:23], v[114:115], v[114:115], v[22:23]
    v_add_f32_dpp v8, v8, v8 row_ror:8 row_mask:0xf bank_mask:0x3
    v_add_f32_dpp v9, v9, v9 row_ror:8 row_mask:0xf bank_mask:0x3
    v_add_f32_dpp v10, v10, v10 row_ror:8 row_mask:0xf bank_mask:0x3
    v_add_f32_dpp v11, v11, v11 row_ror:8 row_mask:0xf bank_mask:0x3
    v_add_f32_dpp v12, v12, v12 row_ror:8 row_mask:0xf bank_mask:0x3
    v_add_f32_dpp v13, v13, v13 row_ror:8 row_mask:0xf bank_mask:0x3
    v_add_f32_dpp v14, v14, v14 row_ror:8 row_mask:0xf bank_mask:0x3
    v_add_f32_dpp v15, v15, v15 row_ror:8 row_mask:0xf bank_mask:0x3
    v_add_f32_dpp v8, v16, v16 row_ror:8 row_mask:0xf bank_mask:0xc
    v_add_f32_dpp v9, v17, v17 row_ror:8 row_mask:0xf bank_mask:0xc
    v_add_f32_dpp v10, v18, v18 row_ror:8 row_mask:0xf bank_mask:0xc
    v_add_f32_dpp v11, v19, v19 row_ror:8 row_mask:0xf bank_mask:0xc
    v_add_f32_dpp v12, v20, v20 row_ror:8 row_mask:0xf bank_mask:0xc
    v_add_f32_dpp v13, v21, v21 row_ror:8 row_mask:0xf bank_mask:0xc
    v_add_f32_dpp v14, v22, v22 row_ror:8 row_mask:0xf bank_mask:0xc
    v_add_f32_dpp v15, v23, v23 row_ror:8 row_mask:0xf bank_mask:0xc
    v_add_f32_dpp v8, v8, v8 row_half_mirror row_mask:0xf bank_mask:0x5
    v_add_f32_dpp v9, v9, v9 row_half_mirror row_mask:0xf bank_mask:0x5
    v_add_f32_dpp v10, v10, v10 row_half_mirror row_mask:0xf bank_mask:0x5
    v_add_f32_dpp v11, v11, v11 row_half_mirror row_mask:0xf bank_mask:0x5
    v_add_f32_dpp v8, v12, v12 row_half_mirror row_mask:0xf bank_mask:0xa
    v_add_f32_dpp v9, v13, v13 row_half_mirror row_mask:0xf bank_mask:0xa
    v_add_f32_dpp v10, v14, v14 row_half_mirror row_mask:0xf bank_mask:0xa
    v_add_f32_dpp v11, v15, v15 row_half_mirror row_mask:0xf bank_mask:0xa
    v_add_f32_dpp v8, v8, v8 quad_perm:[2,3,0,1] row_mask:0xf bank_mask:0xf
    v_add_f32_dpp v9, v9, v9 quad_perm:[2,3,0,1] row_mask:0xf bank_mask:0xf
    v_add_f32_dpp v10, v10, v10 quad_perm:[2,3,0,1] row_mask:0xf bank_mask:0xf
    v_add_f32_dpp v11, v11, v11 quad_perm:[2,3,0,1] row_mask:0xf bank_mask:0xf
    v_add_f32_dpp v8, v8, v8 quad_perm:[1,0,3,2] row_mask:0xf bank_mask:0xf
    v_add_f32_dpp v9, v9, v9 quad_perm:[1,0,3,2] row_mask:0xf bank_mask:0xf
    v_add_f32_dpp v10, v10, v10 quad_perm:[1,0,3,2] row_mask:0xf bank_mask:0xf
    v_add_f32_dpp v11, v11, v11 quad_perm:[1,0,3,2] row_mask:0xf bank_mask:0xf
    ds_write_b128 v4, v[8:11]
    ds_write_b128 v4, v[8:11] offset:1024
    s_lshl_b32 s10, s66, 11
    s_add_u32 s10, s10, 2883584
    s_add_u32 s11, s10, 2048
    s_lshl_b32 s9, s66, 7
    s_add_u32 s9, s9, 131072
    s_lshl_b32 s7, s56, 4
    s_mov_b32 s0, 0x1010
    s_mov_b32 s1, 0
    s_lshl_b64 s[0:1], s[0:1], s7
    s_waitcnt vmcnt(0) lgkmcnt(0)
    s_barrier
    ds_read_b128 v[24:27], v4 offset:256
    ds_read_b128 v[28:31], v4 offset:512
    ds_read_b128 v[32:35], v4 offset:768
    s_waitcnt lgkmcnt(1)
    v_pk_add_f32 v[24:25], v[24:25], v[28:29]
    v_pk_add_f32 v[26:27], v[26:27], v[30:31]
    s_waitcnt lgkmcnt(0)
    v_pk_add_f32 v[8:9], v[8:9], v[32:33]
    v_pk_add_f32 v[10:11], v[10:11], v[34:35]
    v_pk_add_f32 v[8:9], v[8:9], v[24:25]
    v_pk_add_f32 v[10:11], v[10:11], v[26:27]
    v_pk_mul_f32 v[8:9], v[8:9], s[12:13]
    v_pk_mul_f32 v[10:11], v[10:11], s[12:13]
    s_nop 0
    v_mov_b32_dpp v12, v8 row_ror:4 row_mask:0xf bank_mask:0xf
    v_mov_b32_dpp v13, v9 row_ror:4 row_mask:0xf bank_mask:0xf
    v_mov_b32_dpp v14, v10 row_ror:4 row_mask:0xf bank_mask:0xf
    v_mov_b32_dpp v15, v11 row_ror:4 row_mask:0xf bank_mask:0xf
    v_fma_f32 v16, -v12, v12, v8
    v_fma_f32 v17, -v13, v13, v9
    v_fma_f32 v18, -v14, v14, v10
    v_fma_f32 v19, -v15, v15, v11
    v_max_f32 v16, 0, v16
    v_max_f32 v17, 0, v17
    v_max_f32 v18, 0, v18
    v_max_f32 v19, 0, v19
    v_pk_add_f32 v[20:21], v[16:17], s[14:15]
    v_pk_add_f32 v[22:23], v[18:19], s[14:15]
    v_pk_fma_f32 v[20:21], v[20:21], s[14:15], v[16:17]
    v_pk_fma_f32 v[22:23], v[22:23], s[14:15], v[18:19]
    v_rsq_f32 v24, v20
    v_rsq_f32 v25, v21
    v_rsq_f32 v26, v22
    v_rsq_f32 v27, v23
    v_pk_mul_f32 v[28:29], v[12:13], v[24:25] neg_lo:[1,0] neg_hi:[1,0]
    v_pk_mul_f32 v[30:31], v[14:15], v[26:27] neg_lo:[1,0] neg_hi:[1,0]
    v_mov_b32_dpp v36, v24 row_newbcast:4 row_mask:0xf bank_mask:0xf
    v_mov_b32_dpp v37, v25 row_newbcast:4 row_mask:0xf bank_mask:0xf
    v_mov_b32_dpp v38, v26 row_newbcast:4 row_mask:0xf bank_mask:0xf
    v_mov_b32_dpp v39, v27 row_newbcast:4 row_mask:0xf bank_mask:0xf
    v_mov_b32_dpp v40, v28 row_newbcast:4 row_mask:0xf bank_mask:0xf
    v_mov_b32_dpp v41, v29 row_newbcast:4 row_mask:0xf bank_mask:0xf
    v_mov_b32_dpp v42, v30 row_newbcast:4 row_mask:0xf bank_mask:0xf
    v_mov_b32_dpp v43, v31 row_newbcast:4 row_mask:0xf bank_mask:0xf
    v_pk_fma_f32 v[60:61], v[60:61], v[36:37], v[40:41]
    v_pk_fma_f32 v[62:63], v[62:63], v[38:39], v[42:43]
    v_pk_fma_f32 v[64:65], v[64:65], v[36:37], v[40:41]
    v_pk_fma_f32 v[66:67], v[66:67], v[38:39], v[42:43]
    v_pk_fma_f32 v[68:69], v[68:69], v[36:37], v[40:41]
    v_pk_fma_f32 v[70:71], v[70:71], v[38:39], v[42:43]
    v_pk_fma_f32 v[72:73], v[72:73], v[36:37], v[40:41]
    v_pk_fma_f32 v[74:75], v[74:75], v[38:39], v[42:43]
    v_pk_fma_f32 v[76:77], v[76:77], v[36:37], v[40:41]
    v_pk_fma_f32 v[78:79], v[78:79], v[38:39], v[42:43]
    v_pk_fma_f32 v[80:81], v[80:81], v[36:37], v[40:41]
    v_pk_fma_f32 v[82:83], v[82:83], v[38:39], v[42:43]
    v_pk_fma_f32 v[84:85], v[84:85], v[36:37], v[40:41]
    v_pk_fma_f32 v[86:87], v[86:87], v[38:39], v[42:43]
    v_cvt_pk_bf16_f32 v52, v60, v61
    v_cvt_pk_bf16_f32 v54, v64, v65
    v_cvt_pk_bf16_f32 v53, v62, v63
    v_cvt_pk_bf16_f32 v55, v66, v67
    v_permlane16_swap_b32 v52, v54
    s_nop 0
    v_permlane16_swap_b32 v53, v55
    v_cvt_pk_bf16_f32 v56, v68, v69
    v_cvt_pk_bf16_f32 v58, v72, v73
    v_cvt_pk_bf16_f32 v57, v70, v71
    v_cvt_pk_bf16_f32 v59, v74, v75
    buffer_store_dwordx4 v[52:55], v5, s[40:43], s10 offen sc1
    v_permlane16_swap_b32 v56, v58
    v_permlane16_swap_b32 v57, v59
    v_cvt_pk_bf16_f32 v52, v76, v77
    v_cvt_pk_bf16_f32 v54, v80, v81
    v_cvt_pk_bf16_f32 v53, v78, v79
    v_cvt_pk_bf16_f32 v55, v82, v83
    buffer_store_dwordx4 v[56:59], v6, s[40:43], s10 offen sc1
    v_permlane16_swap_b32 v52, v54
    v_permlane16_swap_b32 v53, v55
    v_cvt_pk_bf16_f32 v56, v84, v85
    v_cvt_pk_bf16_f32 v58, v84, v85
    v_cvt_pk_bf16_f32 v57, v86, v87
    v_cvt_pk_bf16_f32 v59, v86, v87
    buffer_store_dwordx4 v[52:55], v7, s[40:43], s10 offen sc1
    v_permlane16_swap_b32 v56, v58
    v_permlane16_swap_b32 v57, v59
    buffer_store_dwordx4 v[56:59], v253, s[40:43], s10 offen sc1
    v_mov_b32_dpp v44, v24 row_newbcast:12 row_mask:0xf bank_mask:0xf
    v_mov_b32_dpp v45, v25 row_newbcast:12 row_mask:0xf bank_mask:0xf
    v_mov_b32_dpp v46, v26 row_newbcast:12 row_mask:0xf bank_mask:0xf
    v_mov_b32_dpp v47, v27 row_newbcast:12 row_mask:0xf bank_mask:0xf
    v_mov_b32_dpp v48, v28 row_newbcast:12 row_mask:0xf bank_mask:0xf
    v_mov_b32_dpp v49, v29 row_newbcast:12 row_mask:0xf bank_mask:0xf
    v_mov_b32_dpp v50, v30 row_newbcast:12 row_mask:0xf bank_mask:0xf
    v_mov_b32_dpp v51, v31 row_newbcast:12 row_mask:0xf bank_mask:0xf
    v_pk_fma_f32 v[88:89], v[88:89], v[44:45], v[48:49]
    v_pk_fma_f32 v[90:91], v[90:91], v[46:47], v[50:51]
    v_pk_fma_f32 v[92:93], v[92:93], v[44:45], v[48:49]
    v_pk_fma_f32 v[94:95], v[94:95], v[46:47], v[50:51]
    v_pk_fma_f32 v[96:97], v[96:97], v[44:45], v[48:49]
    v_pk_fma_f32 v[98:99], v[98:99], v[46:47], v[50:51]
    v_pk_fma_f32 v[100:101], v[100:101], v[44:45], v[48:49]
    v_pk_fma_f32 v[102:103], v[102:103], v[46:47], v[50:51]
    v_pk_fma_f32 v[104:105], v[104:105], v[44:45], v[48:49]
    v_pk_fma_f32 v[106:107], v[106:107], v[46:47], v[50:51]
    v_pk_fma_f32 v[108:109], v[108:109], v[44:45], v[48:49]
    v_pk_fma_f32 v[110:111], v[110:111], v[46:47], v[50:51]
    v_pk_fma_f32 v[112:113], v[112:113], v[44:45], v[48:49]
    v_pk_fma_f32 v[114:115], v[114:115], v[46:47], v[50:51]
    v_cvt_pk_bf16_f32 v52, v88, v89
    v_cvt_pk_bf16_f32 v54, v92, v93
    v_cvt_pk_bf16_f32 v53, v90, v91
    v_cvt_pk_bf16_f32 v55, v94, v95
    v_permlane16_swap_b32 v52, v54
    s_nop 0
    v_permlane16_swap_b32 v53, v55
    v_cvt_pk_bf16_f32 v56, v96, v97
    v_cvt_pk_bf16_f32 v58, v100, v101
    v_cvt_pk_bf16_f32 v57, v98, v99
    v_cvt_pk_bf16_f32 v59, v102, v103
    buffer_store_dwordx4 v[52:55], v5, s[40:43], s11 offen sc1
    v_permlane16_swap_b32 v56, v58
    v_permlane16_swap_b32 v57, v59
    v_cvt_pk_bf16_f32 v52, v104, v105
    v_cvt_pk_bf16_f32 v54, v108, v109
    v_cvt_pk_bf16_f32 v53, v106, v107
    v_cvt_pk_bf16_f32 v55, v110, v111
    buffer_store_dwordx4 v[56:59], v6, s[40:43], s11 offen sc1
    v_permlane16_swap_b32 v52, v54
    v_permlane16_swap_b32 v53, v55
    v_cvt_pk_bf16_f32 v56, v112, v113
    v_cvt_pk_bf16_f32 v58, v112, v113
    v_cvt_pk_bf16_f32 v57, v114, v115
    v_cvt_pk_bf16_f32 v59, v114, v115
    buffer_store_dwordx4 v[52:55], v7, s[40:43], s11 offen sc1
    v_permlane16_swap_b32 v56, v58
    v_permlane16_swap_b32 v57, v59
    buffer_store_dwordx4 v[56:59], v253, s[40:43], s11 offen sc1
    v_pk_mul_f32 v[16:17], v[20:21], v[24:25]
    v_pk_mul_f32 v[18:19], v[22:23], v[26:27]
    s_mov_b64 exec, s[0:1]
    buffer_store_dwordx4 v[12:15], v0, s[40:43], s9 offen sc1
    buffer_store_dwordx4 v[16:19], v0, s[40:43], s9 offen offset:64 sc1
    s_mov_b64 exec, -1
    s_cmp_lg_u32 s72, 0
    s_cbranch_scc1 L_three
    s_waitcnt vmcnt(0)
    s_barrier
    s_cmp_lg_u32 s56, 0
    s_cbranch_scc1 L_pub_46
    s_lshl_b32 s7, s66, 7
    s_add_u32 s7, s7, 32768
    s_mov_b64 exec, 3
    buffer_store_dword v254, v255, s[40:43], s7 offen sc1
    s_mov_b64 exec, -1
L_pub_46:
    s_branch L_bdone
L_three:
    s_lshl_b32 s11, s56, 7
    s_add_u32 s11, s11, 43008
    v_add_u32 v4, s11, v252
    v_add_u32 v40, s16, v2
    v_add_u32 v41, s17, v2
    v_add_u32 v42, s18, v2
    v_add_u32 v43, s19, v2
    s_branch L_chk_48
L_again_47:
    s_add_u32 m0, s16, 28672
    s_add_u32 s11, s6, s16
    buffer_load_dwordx4 v2, s[40:43], s11 offen sc1 lds
    s_add_u32 m0, s17, 28672
    s_add_u32 s11, s6, s17
    buffer_load_dwordx4 v2, s[40:43], s11 offen sc1 lds
    s_add_u32 m0, s18, 28672
    s_add_u32 s11, s6, s18
    buffer_load_dwordx4 v2, s[40:43], s11 offen sc1 lds
    s_add_u32 m0, s19, 28672
    s_add_u32 s11, s6, s19
    buffer_load_dwordx4 v2, s[40:43], s11 offen sc1 lds
    s_waitcnt vmcnt(0)
L_chk_48:
    ds_read_b32 v32, v40 offset:28672
    ds_read_b32 v33, v41 offset:28672
    ds_read_b32 v34, v42 offset:28672
    ds_read_b32 v35, v43 offset:28672
    s_add_u32 s77, s77, 1
    s_cmp_ge_u32 s77, 50000
    s_waitcnt lgkmcnt(0)
    s_cbranch_scc1 L_loc_49
    v_max3_u32 v32, v32, v33, v34
    v_max_u32 v32, v32, v35
    v_cmp_eq_u32 vcc, -1, v32
    s_cbranch_vccnz L_again_47
L_loc_49:
    s_barrier
    ds_read_b64_tr_b16 v[28:29], v3 offset:49152
    ds_read_b64_tr_b16 v[30:31], v3 offset:50176
    ds_read_b64_tr_b16 v[32:33], v3 offset:51200
    ds_read_b64_tr_b16 v[34:35], v3 offset:52224
    ds_read_b64_tr_b16 v[36:37], v3 offset:53248
    ds_read_b64_tr_b16 v[38:39], v3 offset:54272
    ds_read_b64_tr_b16 v[40:41], v3 offset:55296
    s_waitcnt lgkmcnt(0)
    v_lshlrev_b32 v60, 16, v28
    v_and_b32 v61, 0xffff0000, v28
    v_lshlrev_b32 v62, 16, v29
    v_and_b32 v63, 0xffff0000, v29
    v_lshlrev_b32 v64, 16, v30
    v_and_b32 v65, 0xffff0000, v30
    v_lshlrev_b32 v66, 16, v31
    v_and_b32 v67, 0xffff0000, v31
    v_lshlrev_b32 v68, 16, v32
    v_and_b32 v69, 0xffff0000, v32
    v_lshlrev_b32 v70, 16, v33
    v_and_b32 v71, 0xffff0000, v33
    v_lshlrev_b32 v72, 16, v34
    v_and_b32 v73, 0xffff0000, v34
    v_lshlrev_b32 v74, 16, v35
    v_and_b32 v75, 0xffff0000, v35
    v_lshlrev_b32 v76, 16, v36
    v_and_b32 v77, 0xffff0000, v36
    v_lshlrev_b32 v78, 16, v37
    v_and_b32 v79, 0xffff0000, v37
    v_lshlrev_b32 v80, 16, v38
    v_and_b32 v81, 0xffff0000, v38
    v_lshlrev_b32 v82, 16, v39
    v_and_b32 v83, 0xffff0000, v39
    v_lshlrev_b32 v84, 16, v40
    v_and_b32 v85, 0xffff0000, v40
    v_lshlrev_b32 v86, 16, v41
    v_and_b32 v87, 0xffff0000, v41
    ds_read_b128 v[8:11], v2 offset:28672
    ds_read_b128 v[12:15], v2 offset:29696
    s_waitcnt lgkmcnt(1)
    v_mfma_f32_16x16x32_bf16 v[60:63], v[8:11], a[0:3], v[60:63]
    ds_read_b128 v[16:19], v2 offset:30720
    v_mfma_f32_16x16x32_bf16 v[64:67], v[8:11], a[4:7], v[64:67]
    v_mfma_f32_16x16x32_bf16 v[68:71], v[8:11], a[8:11], v[68:71]
    v_mfma_f32_16x16x32_bf16 v[72:75], v[8:11], a[12:15], v[72:75]
    v_mfma_f32_16x16x32_bf16 v[76:79], v[8:11], a[16:19], v[76:79]
    v_mfma_f32_16x16x32_bf16 v[80:83], v[8:11], a[20:23], v[80:83]
    v_mfma_f32_16x16x32_bf16 v[84:87], v[8:11], a[24:27], v[84:87]
    s_waitcnt lgkmcnt(1)
    v_mfma_f32_16x16x32_bf16 v[60:63], v[12:15], a[28:31], v[60:63]
    ds_read_b128 v[8:11], v2 offset:31744
    v_mfma_f32_16x16x32_bf16 v[64:67], v[12:15], a[32:35], v[64:67]
    v_mfma_f32_16x16x32_bf16 v[68:71], v[12:15], a[36:39], v[68:71]
    v_mfma_f32_16x16x32_bf16 v[72:75], v[12:15], a[40:43], v[72:75]
    v_mfma_f32_16x16x32_bf16 v[76:79], v[12:15], a[44:47], v[76:79]
    v_mfma_f32_16x16x32_bf16 v[80:83], v[12:15], a[48:51], v[80:83]
    v_mfma_f32_16x16x32_bf16 v[84:87], v[12:15], a[52:55], v[84:87]
    s_waitcnt lgkmcnt(1)
    v_mfma_f32_16x16x32_bf16 v[60:63], v[16:19], a[56:59], v[60:63]
    ds_read_b128 v[12:15], v2 offset:32768
    v_mfma_f32_16x16x32_bf16 v[64:67], v[16:19], a[60:63], v[64:67]
    v_mfma_f32_16x16x32_bf16 v[68:71], v[16:19], a[64:67], v[68:71]
    v_mfma_f32_16x16x32_bf16 v[72:75], v[16:19], a[68:71], v[72:75]
    v_mfma_f32_16x16x32_bf16 v[76:79], v[16:19], a[72:75], v[76:79]
    v_mfma_f32_16x16x32_bf16 v[80:83], v[16:19], a[76:79], v[80:83]
    v_mfma_f32_16x16x32_bf16 v[84:87], v[16:19], a[80:83], v[84:87]
    s_waitcnt lgkmcnt(1)
    v_mfma_f32_16x16x32_bf16 v[60:63], v[8:11], a[84:87], v[60:63]
    ds_read_b128 v[16:19], v2 offset:33792
    v_mfma_f32_16x16x32_bf16 v[64:67], v[8:11], a[88:91], v[64:67]
    v_mfma_f32_16x16x32_bf16 v[68:71], v[8:11], a[92:95], v[68:71]
    v_mfma_f32_16x16x32_bf16 v[72:75], v[8:11], a[96:99], v[72:75]
    v_mfma_f32_16x16x32_bf16 v[76:79], v[8:11], a[100:103], v[76:79]
    v_mfma_f32_16x16x32_bf16 v[80:83], v[8:11], a[104:107], v[80:83]
    v_mfma_f32_16x16x32_bf16 v[84:87], v[8:11], a[108:111], v[84:87]
    s_waitcnt lgkmcnt(1)
    v_mfma_f32_16x16x32_bf16 v[60:63], v[12:15], a[112:115], v[60:63]
    ds_read_b128 v[8:11], v2 offset:34816
    v_mfma_f32_16x16x32_bf16 v[64:67], v[12:15], a[116:119], v[64:67]
    v_mfma_f32_16x16x32_bf16 v[68:71], v[12:15], a[120:123], v[68:71]
    v_mfma_f32_16x16x32_bf16 v[72:75], v[12:15], a[124:127], v[72:75]
    v_mfma_f32_16x16x32_bf16 v[76:79], v[12:15], a[128:131], v[76:79]
    v_mfma_f32_16x16x32_bf16 v[80:83], v[12:15], a[132:135], v[80:83]
    v_mfma_f32_16x16x32_bf16 v[84:87], v[12:15], a[136:139], v[84:87]
    s_waitcnt lgkmcnt(1)
    v_mfma_f32_16x16x32_bf16 v[60:63], v[16:19], a[140:143], v[60:63]
    ds_read_b128 v[12:15], v2 offset:35840
    v_mfma_f32_16x16x32_bf16 v[64:67], v[16:19], a[144:147], v[64:67]
    v_mfma_f32_16x16x32_bf16 v[68:71], v[16:19], a[148:151], v[68:71]
    v_mfma_f32_16x16x32_bf16 v[72:75], v[16:19], a[152:155], v[72:75]
    v_mfma_f32_16x16x32_bf16 v[76:79], v[16:19], a[156:159], v[76:79]
    v_mfma_f32_16x16x32_bf16 v[80:83], v[16:19], a[160:163], v[80:83]
    v_mfma_f32_16x16x32_bf16 v[84:87], v[16:19], a[164:167], v[84:87]
    s_waitcnt lgkmcnt(1)
    v_mfma_f32_16x16x32_bf16 v[60:63], v[8:11], a[168:171], v[60:63]
    ds_read_b128 v[16:19], v2 offset:36864
    v_mfma_f32_16x16x32_bf16 v[64:67], v[8:11], a[172:175], v[64:67]
    v_mfma_f32_16x16x32_bf16 v[68:71], v[8:11], a[176:179], v[68:71]
    v_mfma_f32_16x16x32_bf16 v[72:75], v[8:11], a[180:183], v[72:75]
    v_mfma_f32_16x16x32_bf16 v[76:79], v[8:11], a[184:187], v[76:79]
    v_mfma_f32_16x16x32_bf16 v[80:83], v[8:11], a[188:191], v[80:83]
    v_mfma_f32_16x16x32_bf16 v[84:87], v[8:11], a[192:195], v[84:87]
    s_waitcnt lgkmcnt(1)
    v_mfma_f32_16x16x32_bf16 v[60:63], v[12:15], a[196:199], v[60:63]
    ds_read_b128 v[8:11], v2 offset:37888
    s_waitcnt vmcnt(0)
    s_barrier
    s_cmp_lg_u32 s56, 0
    s_cbranch_scc1 L_pub_50
    s_lshl_b32 s7, s66, 7
    s_add_u32 s7, s7, 32768
    s_mov_b64 exec, 3
    buffer_store_dword v254, v255, s[40:43], s7 offen sc1
    s_mov_b64 exec, -1
L_pub_50:
    v_mfma_f32_16x16x32_bf16 v[64:67], v[12:15], a[200:203], v[64:67]
    v_mfma_f32_16x16x32_bf16 v[68:71], v[12:15], a[204:207], v[68:71]
    v_mfma_f32_16x16x32_bf16 v[72:75], v[12:15], a[208:211], v[72:75]
    v_mfma_f32_16x16x32_bf16 v[76:79], v[12:15], a[212:215], v[76:79]
    v_mfma_f32_16x16x32_bf16 v[80:83], v[12:15], a[216:219], v[80:83]
    v_mfma_f32_16x16x32_bf16 v[84:87], v[12:15], a[220:223], v[84:87]
    s_waitcnt lgkmcnt(1)
    v_mfma_f32_16x16x32_bf16 v[60:63], v[16:19], a[224:227], v[60:63]
    ds_read_b128 v[12:15], v2 offset:38912
    v_mfma_f32_16x16x32_bf16 v[64:67], v[16:19], a[228:231], v[64:67]
    v_mfma_f32_16x16x32_bf16 v[68:71], v[16:19], a[232:235], v[68:71]
    v_mfma_f32_16x16x32_bf16 v[72:75], v[16:19], a[236:239], v[72:75]
    v_mfma_f32_16x16x32_bf16 v[76:79], v[16:19], a[240:243], v[76:79]
    v_mfma_f32_16x16x32_bf16 v[80:83], v[16:19], a[244:247], v[80:83]
    v_mfma_f32_16x16x32_bf16 v[84:87], v[16:19], a[248:251], v[84:87]
    s_waitcnt lgkmcnt(1)
    v_mfma_f32_16x16x32_bf16 v[60:63], v[8:11], a[252:255], v[60:63]
    ds_read_b128 v[16:19], v2 offset:39936
    v_mfma_f32_16x16x32_bf16 v[64:67], v[8:11], v[116:119], v[64:67]
    v_mfma_f32_16x16x32_bf16 v[68:71], v[8:11], v[120:123], v[68:71]
    v_mfma_f32_16x16x32_bf16 v[72:75], v[8:11], v[124:127], v[72:75]
    v_mfma_f32_16x16x32_bf16 v[76:79], v[8:11], v[128:131], v[76:79]
    v_mfma_f32_16x16x32_bf16 v[80:83], v[8:11], v[132:135], v[80:83]
    v_mfma_f32_16x16x32_bf16 v[84:87], v[8:11], v[136:139], v[84:87]
    s_waitcnt lgkmcnt(1)
    v_mfma_f32_16x16x32_bf16 v[60:63], v[12:15], v[140:143], v[60:63]
    ds_read_b128 v[8:11], v2 offset:40960
    v_mfma_f32_16x16x32_bf16 v[64:67], v[12:15], v[144:147], v[64:67]
    v_mfma_f32_16x16x32_bf16 v[68:71], v[12:15], v[148:151], v[68:71]
    v_mfma_f32_16x16x32_bf16 v[72:75], v[12:15], v[152:155], v[72:75]
    v_mfma_f32_16x16x32_bf16 v[76:79], v[12:15], v[156:159], v[76:79]
    v_mfma_f32_16x16x32_bf16 v[80:83], v[12:15], v[160:163], v[80:83]
    v_mfma_f32_16x16x32_bf16 v[84:87], v[12:15], v[164:167], v[84:87]
    s_waitcnt lgkmcnt(1)
    v_mfma_f32_16x16x32_bf16 v[60:63], v[16:19], v[168:171], v[60:63]
    ds_read_b128 v[12:15], v2 offset:41984
    v_mfma_f32_16x16x32_bf16 v[64:67], v[16:19], v[172:175], v[64:67]
    v_mfma_f32_16x16x32_bf16 v[68:71], v[16:19], v[176:179], v[68:71]
    v_mfma_f32_16x16x32_bf16 v[72:75], v[16:19], v[180:183], v[72:75]
    v_mfma_f32_16x16x32_bf16 v[76:79], v[16:19], v[184:187], v[76:79]
    v_mfma_f32_16x16x32_bf16 v[80:83], v[16:19], v[188:191], v[80:83]
    v_mfma_f32_16x16x32_bf16 v[84:87], v[16:19], v[192:195], v[84:87]
    s_waitcnt lgkmcnt(1)
    v_mfma_f32_16x16x32_bf16 v[60:63], v[8:11], v[196:199], v[60:63]
    v_mfma_f32_16x16x32_bf16 v[64:67], v[8:11], v[200:203], v[64:67]
    v_mfma_f32_16x16x32_bf16 v[68:71], v[8:11], v[204:207], v[68:71]
    v_mfma_f32_16x16x32_bf16 v[72:75], v[8:11], v[208:211], v[72:75]
    v_mfma_f32_16x16x32_bf16 v[76:79], v[8:11], v[212:215], v[76:79]
    v_mfma_f32_16x16x32_bf16 v[80:83], v[8:11], v[216:219], v[80:83]
    v_mfma_f32_16x16x32_bf16 v[84:87], v[8:11], v[220:223], v[84:87]
    s_waitcnt lgkmcnt(0)
    v_mfma_f32_16x16x32_bf16 v[60:63], v[12:15], v[224:227], v[60:63]
    v_mfma_f32_16x16x32_bf16 v[64:67], v[12:15], v[228:231], v[64:67]
    v_mfma_f32_16x16x32_bf16 v[68:71], v[12:15], v[232:235], v[68:71]
    v_mfma_f32_16x16x32_bf16 v[72:75], v[12:15], v[236:239], v[72:75]
    v_mfma_f32_16x16x32_bf16 v[76:79], v[12:15], v[240:243], v[76:79]
    v_mfma_f32_16x16x32_bf16 v[80:83], v[12:15], v[244:247], v[80:83]
    v_mfma_f32_16x16x32_bf16 v[84:87], v[12:15], v[248:251], v[84:87]
    s_nop 1
    v_pk_mul_f32 v[24:25], v[60:61], v[60:61]
    v_pk_add_f32 v[20:21], v[60:61], v[64:65]
    v_pk_mul_f32 v[26:27], v[62:63], v[62:63]
    v_pk_add_f32 v[22:23], v[62:63], v[66:67]
    v_pk_fma_f32 v[24:25], v[64:65], v[64:65], v[24:25]
    v_pk_fma_f32 v[26:27], v[66:67], v[66:67], v[26:27]
    v_pk_add_f32 v[20:21], v[20:21], v[68:69]
    v_pk_fma_f32 v[24:25], v[68:69], v[68:69], v[24:25]
    v_pk_add_f32 v[22:23], v[22:23], v[70:71]
    v_pk_fma_f32 v[26:27], v[70:71], v[70:71], v[26:27]
    v_pk_add_f32 v[20:21], v[20:21], v[72:73]
    v_pk_fma_f32 v[24:25], v[72:73], v[72:73], v[24:25]
    v_pk_add_f32 v[22:23], v[22:23], v[74:75]
    v_pk_fma_f32 v[26:27], v[74:75], v[74:75], v[26:27]
    v_pk_add_f32 v[20:21], v[20:21], v[76:77]
    v_pk_fma_f32 v[24:25], v[76:77], v[76:77], v[24:25]
    v_pk_add_f32 v[22:23], v[22:23], v[78:79]
    v_pk_fma_f32 v[26:27], v[78:79], v[78:79], v[26:27]
    v_pk_add_f32 v[20:21], v[20:21], v[80:81]
    v_pk_fma_f32 v[24:25], v[80:81], v[80:81], v[24:25]
    v_pk_add_f32 v[22:23], v[22:23], v[82:83]
    v_pk_fma_f32 v[26:27], v[82:83], v[82:83], v[26:27]
    v_pk_add_f32 v[20:21], v[20:21], v[84:85]
    v_pk_fma_f32 v[24:25], v[84:85], v[84:85], v[24:25]
    v_pk_add_f32 v[22:23], v[22:23], v[86:87]
    v_pk_fma_f32 v[26:27], v[86:87], v[86:87], v[26:27]
    v_add_f32_dpp v20, v20, v20 row_ror:8 row_mask:0xf bank_mask:0xf
    v_add_f32_dpp v21, v21, v21 row_ror:8 row_mask:0xf bank_mask:0xf
    v_add_f32_dpp v22, v22, v22 row_ror:8 row_mask:0xf bank_mask:0xf
    v_add_f32_dpp v23, v23, v23 row_ror:8 row_mask:0xf bank_mask:0xf
    v_add_f32_dpp v24, v24, v24 row_ror:8 row_mask:0xf bank_mask:0xf
    v_add_f32_dpp v25, v25, v25 row_ror:8 row_mask:0xf bank_mask:0xf
    v_add_f32_dpp v26, v26, v26 row_ror:8 row_mask:0xf bank_mask:0xf
    v_add_f32_dpp v27, v27, v27 row_ror:8 row_mask:0xf bank_mask:0xf
    v_add_f32_dpp v20, v20, v20 row_ror:4 row_mask:0xf bank_mask:0xf
    v_add_f32_dpp v21, v21, v21 row_ror:4 row_mask:0xf bank_mask:0xf
    v_add_f32_dpp v22, v22, v22 row_ror:4 row_mask:0xf bank_mask:0xf
    v_add_f32_dpp v23, v23, v23 row_ror:4 row_mask:0xf bank_mask:0xf
    v_add_f32_dpp v24, v24, v24 row_ror:4 row_mask:0xf bank_mask:0xf
    v_add_f32_dpp v25, v25, v25 row_ror:4 row_mask:0xf bank_mask:0xf
    v_add_f32_dpp v26, v26, v26 row_ror:4 row_mask:0xf bank_mask:0xf
    v_add_f32_dpp v27, v27, v27 row_ror:4 row_mask:0xf bank_mask:0xf
    v_add_f32_dpp v20, v20, v20 row_ror:2 row_mask:0xf bank_mask:0xf
    v_add_f32_dpp v21, v21, v21 row_ror:2 row_mask:0xf bank_mask:0xf
    v_add_f32_dpp v22, v22, v22 row_ror:2 row_mask:0xf bank_mask:0xf
    v_add_f32_dpp v23, v23, v23 row_ror:2 row_mask:0xf bank_mask:0xf
    v_add_f32_dpp v24, v24, v24 row_ror:2 row_mask:0xf bank_mask:0xf
    v_add_f32_dpp v25, v25, v25 row_ror:2 row_mask:0xf bank_mask:0xf
    v_add_f32_dpp v26, v26, v26 row_ror:2 row_mask:0xf bank_mask:0xf
    v_add_f32_dpp v27, v27, v27 row_ror:2 row_mask:0xf bank_mask:0xf
    v_add_f32_dpp v20, v20, v20 row_ror:1 row_mask:0xf bank_mask:0xf
    v_add_f32_dpp v21, v21, v21 row_ror:1 row_mask:0xf bank_mask:0xf
    v_add_f32_dpp v22, v22, v22 row_ror:1 row_mask:0xf bank_mask:0xf
    v_add_f32_dpp v23, v23, v23 row_ror:1 row_mask:0xf bank_mask:0xf
    v_add_f32_dpp v24, v24, v24 row_ror:1 row_mask:0xf bank_mask:0xf
    v_add_f32_dpp v25, v25, v25 row_ror:1 row_mask:0xf bank_mask:0xf
    v_add_f32_dpp v26, v26, v26 row_ror:1 row_mask:0xf bank_mask:0xf
    v_add_f32_dpp v27, v27, v27 row_ror:1 row_mask:0xf bank_mask:0xf
    ds_write_b128 v4, v[20:23] offset:0
    ds_write_b128 v4, v[24:27] offset:64
    ds_write_b128 v4, v[20:23] offset:512
    ds_write_b128 v4, v[24:27] offset:576
    s_waitcnt lgkmcnt(0)
    s_barrier
    ds_read_b128 v[28:31], v4 offset:128
    ds_read_b128 v[32:35], v4 offset:192
    ds_read_b128 v[36:39], v4 offset:256
    ds_read_b128 v[40:43], v4 offset:320
    ds_read_b128 v[44:47], v4 offset:384
    ds_read_b128 v[48:51], v4 offset:448
    s_lshl_b32 s10, s71, 11
    s_add_u32 s10, s10, 2883584
    s_lshl_b32 s9, s71, 7
    s_add_u32 s9, s9, 131072
    s_waitcnt lgkmcnt(0)
    v_pk_add_f32 v[28:29], v[28:29], v[36:37]
    v_pk_add_f32 v[20:21], v[20:21], v[44:45]
    v_pk_add_f32 v[30:31], v[30:31], v[38:39]
    v_pk_add_f32 v[22:23], v[22:23], v[46:47]
    v_pk_add_f32 v[32:33], v[32:33], v[40:41]
    v_pk_add_f32 v[24:25], v[24:25], v[48:49]
    v_pk_add_f32 v[34:35], v[34:35], v[42:43]
    v_pk_add_f32 v[26:27], v[26:27], v[50:51]
    v_pk_add_f32 v[28:29], v[28:29], v[20:21]
    v_pk_add_f32 v[30:31], v[30:31], v[22:23]
    v_pk_add_f32 v[32:33], v[32:33], v[24:25]
    v_pk_add_f32 v[34:35], v[34:35], v[26:27]
    v_pk_mul_f32 v[28:29], v[28:29], s[12:13]
    v_pk_mul_f32 v[30:31], v[30:31], s[12:13]
    v_pk_mul_f32 v[32:33], v[32:33], s[12:13]
    v_pk_mul_f32 v[34:35], v[34:35], s[12:13]
    v_fma_f32 v32, -v28, v28, v32
    v_fma_f32 v33, -v29, v29, v33
    v_fma_f32 v34, -v30, v30, v34
    v_fma_f32 v35, -v31, v31, v35
    v_max_f32 v32, 0, v32
    v_max_f32 v33, 0, v33
    v_max_f32 v34, 0, v34
    v_max_f32 v35, 0, v35
    v_add_f32 v36, s14, v32
    v_add_f32 v37, s14, v33
    v_add_f32 v38, s14, v34
    v_add_f32 v39, s14, v35
    v_fma_f32 v36, s14, v36, v32
    v_fma_f32 v37, s14, v37, v33
    v_fma_f32 v38, s14, v38, v34
    v_fma_f32 v39, s14, v39, v35
    v_rsq_f32 v32, v36
    v_rsq_f32 v33, v37
    v_rsq_f32 v34, v38
    v_rsq_f32 v35, v39
    v_mul_f32 v20, v36, v32
    v_mul_f32 v21, v37, v33
    v_mul_f32 v22, v38, v34
    v_mul_f32 v23, v39, v35
    v_pk_mul_f32 v[40:41], v[28:29], v[32:33] neg_lo:[1,0] neg_hi:[1,0]
    v_pk_mul_f32 v[42:43], v[30:31], v[34:35] neg_lo:[1,0] neg_hi:[1,0]
    v_pk_fma_f32 v[60:61], v[60:61], v[32:33], v[40:41]
    v_pk_fma_f32 v[62:63], v[62:63], v[34:35], v[42:43]
    v_pk_fma_f32 v[64:65], v[64:65], v[32:33], v[40:41]
    v_pk_fma_f32 v[66:67], v[66:67], v[34:35], v[42:43]
    v_pk_fma_f32 v[68:69], v[68:69], v[32:33], v[40:41]
    v_pk_fma_f32 v[70:71], v[70:71], v[34:35], v[42:43]
    v_pk_fma_f32 v[72:73], v[72:73], v[32:33], v[40:41]
    v_pk_fma_f32 v[74:75], v[74:75], v[34:35], v[42:43]
    v_pk_fma_f32 v[76:77], v[76:77], v[32:33], v[40:41]
    v_pk_fma_f32 v[78:79], v[78:79], v[34:35], v[42:43]
    v_pk_fma_f32 v[80:81], v[80:81], v[32:33], v[40:41]
    v_pk_fma_f32 v[82:83], v[82:83], v[34:35], v[42:43]
    v_pk_fma_f32 v[84:85], v[84:85], v[32:33], v[40:41]
    v_pk_fma_f32 v[86:87], v[86:87], v[34:35], v[42:43]
    v_cvt_pk_bf16_f32 v52, v60, v61
    v_cvt_pk_bf16_f32 v54, v64, v65
    v_cvt_pk_bf16_f32 v53, v62, v63
    v_cvt_pk_bf16_f32 v55, v66, v67
    v_permlane16_swap_b32 v52, v54
    s_nop 0
    v_permlane16_swap_b32 v53, v55
    v_cvt_pk_bf16_f32 v56, v68, v69
    v_cvt_pk_bf16_f32 v58, v72, v73
    v_cvt_pk_bf16_f32 v57, v70, v71
    v_cvt_pk_bf16_f32 v59, v74, v75
    buffer_store_dwordx4 v[52:55], v5, s[40:43], s10 offen sc1
    v_permlane16_swap_b32 v56, v58
    v_permlane16_swap_b32 v57, v59
    v_cvt_pk_bf16_f32 v52, v76, v77
    v_cvt_pk_bf16_f32 v54, v80, v81
    v_cvt_pk_bf16_f32 v53, v78, v79
    v_cvt_pk_bf16_f32 v55, v82, v83
    buffer_store_dwordx4 v[56:59], v6, s[40:43], s10 offen sc1
    v_permlane16_swap_b32 v52, v54
    v_permlane16_swap_b32 v53, v55
    v_cvt_pk_bf16_f32 v56, v84, v85
    v_cvt_pk_bf16_f32 v58, v84, v85
    v_cvt_pk_bf16_f32 v57, v86, v87
    v_cvt_pk_bf16_f32 v59, v86, v87
    buffer_store_dwordx4 v[52:55], v7, s[40:43], s10 offen sc1
    v_permlane16_swap_b32 v56, v58
    v_permlane16_swap_b32 v57, v59
    buffer_store_dwordx4 v[56:59], v253, s[40:43], s10 offen sc1
    s_mov_b64 exec, s[74:75]
    buffer_store_dwordx4 v[28:31], v252, s[40:43], s9 offen sc1
    buffer_store_dwordx4 v[20:23], v252, s[40:43], s9 offen offset:64 sc1
    s_mov_b64 exec, -1
    s_waitcnt vmcnt(0)
    s_barrier
    s_cmp_lg_u32 s56, 0
    s_cbranch_scc1 L_pub_51
    s_lshl_b32 s7, s71, 7
    s_add_u32 s7, s7, 32768
    s_mov_b64 exec, 1
    buffer_store_dword v254, v255, s[40:43], s7 offen sc1
    s_mov_b64 exec, -1
L_pub_51:
L_bdone:
    s_cmp_lg_u32 s64, -1
    s_cbranch_scc1 L_loc_52
    s_sub_u32 s9, s61, 28
    s_lshl_b32 s9, s9, 1
    s_and_b32 s4, s58, 1
    s_add_u32 s9, s9, s4
    s_mul_i32 s9, s9, 28
    s_add_u32 s9, s9, 224
    s_mul_i32 s7, s56, 448
    s_add_u32 s9, s9, s7
    s_lshl_b32 s9, s9, 12
    s_lshr_b32 s7, s58, 1
    s_lshl_b32 s7, s7, 10
    s_add_u32 s9, s9, s7
    v_lshrrev_b32 v8, 3, v1
    v_lshlrev_b32 v8, 12, v8
    v_and_b32 v9, 7, v1
    v_lshl_add_u32 v8, v9, 7, v8
    buffer_load_dword v10, v8, s[36:39], s9 offen
    s_add_u32 s9, s9, 32768
    buffer_load_dword v10, v8, s[36:39], s9 offen
    s_add_u32 s9, s9, 32768
    buffer_load_dword v10, v8, s[36:39], s9 offen
    s_add_u32 s9, s9, 32768
    s_mov_b32 exec_lo, 0xffffffff
    s_mov_b32 exec_hi, 0x0
    buffer_load_dword v10, v8, s[36:39], s9 offen
    s_add_u32 s9, s9, 32768
    s_mov_b64 exec, -1
L_loc_52:
    s_cmp_lg_u32 s2, 176
    s_cbranch_scc1 L_loc_53
    s_lshl_b32 s7, s56, 13
    s_add_u32 s7, s7, 98304
    s_mov_b32 exec_lo, 0xffffffff
    s_mov_b32 exec_hi, 0xffffffff
L_poll_54:
    buffer_load_dword v8, v255, s[40:43], s7 offen sc1
L_poll_54_chk:
    s_add_u32 s77, s77, 1
    s_waitcnt vmcnt(0)
    v_cmp_ne_u32 vcc, s57, v8
    s_cmp_ge_u32 s77, 50000
    s_cbranch_scc1 L_seen_55
    s_and_b64 exec, exec, vcc
    s_cbranch_scc1 L_poll_54
L_seen_55:
    s_mov_b64 exec, -1
    s_barrier
    s_cmp_lg_u32 s56, 0
    s_cbranch_scc1 L_pub_56
    s_mov_b32 s7, 0
    s_mov_b64 exec, 1
    buffer_store_dword v254, v255, s[40:43], s7 offen sc1
    s_mov_b64 exec, -1
L_pub_56:
L_loc_53:
    s_branch L_g2_only
L_roleC:
    s_waitcnt lgkmcnt(0)
    s_mov_b32 s24, s6
    s_mov_b32 s25, s7
    s_mov_b32 s26, 0x126000
    s_mov_b32 s27, 0x00020000
    s_mov_b32 s20, s4
    s_mov_b32 s21, s5
    s_mov_b32 s22, 0x1c0000
    s_mov_b32 s23, 0x00020000
    s_mov_b32 s40, s74
    s_mov_b32 s41, s75
    s_mov_b32 s42, 0x800000
    s_mov_b32 s43, 0x00020000
    v_mov_b32 v18, 0
    buffer_load_dword v252, v18, s[40:43], 0 offen sc1
    s_mov_b32 s28, s8
    s_mov_b32 s29, s9
    s_mov_b32 s30, 0x62000
    s_mov_b32 s31, 0x00020000
    s_mov_b32 s44, s10
    s_mov_b32 s45, s11
    s_mov_b32 s46, 0x1c0000
    s_mov_b32 s47, 0x00020000
    s_mov_b32 s32, s12
    s_mov_b32 s33, s13
    s_mov_b32 s34, 0x700000
    s_mov_b32 s35, 0x00020000
    s_mov_b32 s48, s14
    s_mov_b32 s49, s15
    s_mov_b32 s50, 0xe00
    s_mov_b32 s51, 0x00020000
    s_mov_b32 s36, s16
    s_mov_b32 s37, s17
    s_mov_b32 s38, 0x700000
    s_mov_b32 s39, 0x00020000
    s_mov_b32 s52, s18
    s_mov_b32 s53, s19
    s_mov_b32 s54, 0x1000
    s_mov_b32 s55, 0x00020000
    s_sub_u32 s17, s61, 16
    s_min_u32 s17, s17, 7
    s_lshl_b32 s17, s17, 2
    s_add_u32 s17, s17, s56
    v_min_u32 v21, 41, v1
    v_lshlrev_b32 v21, 7, v21
    s_mul_i32 s6, s17, 5376
    v_lshrrev_b32 v19, 3, v1
    v_mul_u32_u24 v19, 896, v19
    v_and_b32 v20, 7, v1
    v_min_u32 v20, 4, v20
    v_lshl_add_u32 v19, v20, 7, v19
    s_lshl_b32 s4, s58, 8
    s_lshl_b32 s5, s17, 3
    s_add_u32 s4, s4, s5
    s_mul_i32 s4, s4, 896
    s_add_u32 s4, s4, 256
    v_min_u32 v18, 62, v1
    v_lshlrev_b32 v18, 7, v18
    s_mul_i32 s5, s17, 8064
    s_add_u32 s5, s5, 143360
    s_add_u32 s7, s6, 0
    buffer_load_dword v251, v21, s[24:27], s7 offen
    s_add_u32 s7, s6, 172032
    buffer_load_dword v251, v21, s[24:27], s7 offen
    s_waitcnt vmcnt(2)
    v_readfirstlane_b32 s57, v252
    s_mul_i32 s57, s57, 0x19660d
    s_add_u32 s57, s57, 0x3c6ef35f
    s_cmp_lg_u32 s56, 0
    s_cbranch_scc1 L_pub_57
    s_lshl_b32 s76, s2, 7
    s_add_u32 s76, s76, 98304
    v_mov_b32 v254, s57
    v_mov_b32 v255, 0
    s_mov_b64 exec, 1
    buffer_store_dword v254, v255, s[40:43], s76 offen sc1
    s_mov_b64 exec, -1
L_pub_57:
    s_add_u32 s7, s6, 344064
    buffer_load_dword v251, v21, s[24:27], s7 offen
    buffer_load_dword v251, v18, s[28:31], s5 offen
    buffer_load_dword v251, v19, s[20:23], s4 offen
    s_add_u32 s7, s6, 516096
    buffer_load_dword v251, v21, s[24:27], s7 offen
    s_add_u32 s7, s6, 688128
    buffer_load_dword v251, v21, s[24:27], s7 offen
    s_lshl_b32 s7, s17, 3
    s_add_u32 s7, s7, s58
    s_mul_i32 s7, s7, 1408
    s_add_u32 s7, s7, 860160
    v_min_u32 v22, 10, v1
    v_lshlrev_b32 v22, 7, v22
    buffer_load_dword v251, v22, s[24:27], s7 offen
L_g1:
    v_lshrrev_b32 v18, 3, v1
    v_and_b32 v19, 7, v1
    v_bfe_u32 v20, v1, 4, 1
    v_lshlrev_b32 v20, 2, v20
    v_xor_b32 v19, v19, v20
    v_mul_u32_u24 v18, 3584, v18
    v_lshl_add_u32 v4, v19, 4, v18
    v_and_b32 v18, 15, v1
    v_lshrrev_b32 v19, 2, v18
    v_lshrrev_b32 v20, 5, v1
    v_lshl_add_u32 v19, v20, 3, v19
    v_bfe_u32 v20, v18, 3, 1
    s_and_b32 s4, s56, 1
    v_xor_b32 v20, s4, v20
    v_lshlrev_b32 v20, 6, v20
    v_lshl_add_u32 v20, v19, 7, v20
    v_bfe_u32 v19, v1, 4, 1
    s_lshr_b32 s4, s56, 1
    v_xor_b32 v19, s4, v19
    v_lshl_add_u32 v20, v19, 5, v20
    v_and_b32 v19, 3, v1
    v_lshl_add_u32 v20, v19, 3, v20
    s_mul_i32 s5, s56, 28672
    s_add_u32 s5, s5, 49152
    v_xor_b32 v19, 64, v20
    v_add_u32 v5, s5, v20
    v_add_u32 v6, s5, v19
    s_mul_i32 s6, s56, 1835008
    s_lshl_b32 s7, s62, 7
    s_add_u32 s6, s6, s7
    s_add_u32 s66, s6, 917504
    s_bitcmp0_b32 s58, 0
    s_cselect_b32 s67, s66, s6
    s_cselect_b32 s66, s6, s66
    s_cmp_eq_u32 s3, 0
    s_cbranch_scc1 L_g1_rest
    s_add_u32 m0, s5, 0
    s_add_u32 s7, s66, 0
    buffer_load_dwordx4 v4, s[32:35], s7 offen lds
    s_add_u32 m0, s5, 1024
    s_add_u32 s7, s66, 28672
    buffer_load_dwordx4 v4, s[32:35], s7 offen lds
    s_add_u32 m0, s5, 2048
    s_add_u32 s7, s66, 57344
    buffer_load_dwordx4 v4, s[32:35], s7 offen lds
    s_add_u32 m0, s5, 3072
    s_add_u32 s7, s66, 86016
    buffer_load_dwordx4 v4, s[32:35], s7 offen lds
    s_add_u32 m0, s5, 4096
    s_add_u32 s7, s66, 114688
    buffer_load_dwordx4 v4, s[32:35], s7 offen lds
    s_add_u32 m0, s5, 5120
    s_add_u32 s7, s66, 143360
    buffer_load_dwordx4 v4, s[32:35], s7 offen lds
    s_add_u32 m0, s5, 6144
    s_add_u32 s7, s66, 172032
    buffer_load_dwordx4 v4, s[32:35], s7 offen lds
    s_add_u32 m0, s5, 7168
    s_add_u32 s7, s66, 200704
    buffer_load_dwordx4 v4, s[32:35], s7 offen lds
    s_add_u32 m0, s5, 8192
    s_add_u32 s7, s66, 229376
    buffer_load_dwordx4 v4, s[32:35], s7 offen lds
    s_add_u32 m0, s5, 9216
    s_add_u32 s7, s66, 258048
    buffer_load_dwordx4 v4, s[32:35], s7 offen lds
    s_add_u32 m0, s5, 10240
    s_add_u32 s7, s66, 286720
    buffer_load_dwordx4 v4, s[32:35], s7 offen lds
    s_add_u32 m0, s5, 11264
    s_add_u32 s7, s66, 315392
    buffer_load_dwordx4 v4, s[32:35], s7 offen lds
L_g1_rest:
    s_add_u32 m0, s5, 12288
    s_add_u32 s7, s66, 344064
    buffer_load_dwordx4 v4, s[32:35], s7 offen lds
    s_add_u32 m0, s5, 13312
    s_add_u32 s7, s66, 372736
    buffer_load_dwordx4 v4, s[32:35], s7 offen lds
    s_add_u32 m0, s5, 14336
    s_add_u32 s7, s66, 401408
    buffer_load_dwordx4 v4, s[32:35], s7 offen lds
    s_add_u32 m0, s5, 15360
    s_add_u32 s7, s66, 430080
    buffer_load_dwordx4 v4, s[32:35], s7 offen lds
    s_add_u32 m0, s5, 16384
    s_add_u32 s7, s66, 458752
    buffer_load_dwordx4 v4, s[32:35], s7 offen lds
    s_add_u32 m0, s5, 17408
    s_add_u32 s7, s66, 487424
    buffer_load_dwordx4 v4, s[32:35], s7 offen lds
    s_add_u32 m0, s5, 18432
    s_add_u32 s7, s66, 516096
    buffer_load_dwordx4 v4, s[32:35], s7 offen lds
    s_add_u32 m0, s5, 19456
    s_add_u32 s7, s66, 544768
    buffer_load_dwordx4 v4, s[32:35], s7 offen lds
    s_add_u32 m0, s5, 20480
    s_add_u32 s7, s66, 573440
    buffer_load_dwordx4 v4, s[32:35], s7 offen lds
    s_add_u32 m0, s5, 21504
    s_add_u32 s7, s66, 602112
    buffer_load_dwordx4 v4, s[32:35], s7 offen lds
    s_add_u32 m0, s5, 22528
    s_add_u32 s7, s66, 630784
    buffer_load_dwordx4 v4, s[32:35], s7 offen lds
    s_add_u32 m0, s5, 23552
    s_add_u32 s7, s66, 659456
    buffer_load_dwordx4 v4, s[32:35], s7 offen lds
    s_add_u32 m0, s5, 24576
    s_add_u32 s7, s66, 688128
    buffer_load_dwordx4 v4, s[32:35], s7 offen lds
    s_add_u32 m0, s5, 25600
    s_add_u32 s7, s66, 716800
    buffer_load_dwordx4 v4, s[32:35], s7 offen lds
    s_add_u32 m0, s5, 26624
    s_add_u32 s7, s66, 745472
    buffer_load_dwordx4 v4, s[32:35], s7 offen lds
    s_add_u32 m0, s5, 27648
    s_add_u32 s7, s66, 774144
    buffer_load_dwordx4 v4, s[32:35], s7 offen lds
    s_cmp_lg_u32 s3, 2
    s_cbranch_scc1 L_now_58
    s_sub_u32 s17, s61, 16
    s_min_u32 s17, s17, 7
    s_lshl_b32 s17, s17, 1
    s_and_b32 s4, s58, 1
    s_add_u32 s17, s17, s4
    s_mul_i32 s17, s17, 14
    s_mul_i32 s7, s56, 448
    s_add_u32 s17, s17, s7
    s_lshl_b32 s17, s17, 12
    s_lshr_b32 s7, s58, 1
    s_lshl_b32 s7, s7, 10
    s_add_u32 s17, s17, s7
    v_lshrrev_b32 v18, 3, v1
    v_lshlrev_b32 v18, 12, v18
    v_and_b32 v19, 7, v1
    v_lshl_add_u32 v18, v19, 7, v18
    buffer_load_dword v251, v18, s[36:39], s17 offen
    s_add_u32 s17, s17, 32768
    s_mov_b32 exec_lo, 0xffffffff
    s_mov_b32 exec_hi, 0xffff
    buffer_load_dword v251, v18, s[36:39], s17 offen
    s_add_u32 s17, s17, 32768
    s_mov_b64 exec, -1
L_now_58:
    s_waitcnt vmcnt(26)
    ds_read_b64_tr_b16 a[0:1], v5 offset:0
    ds_read_b64_tr_b16 a[2:3], v5 offset:512
    ds_read_b64_tr_b16 a[4:5], v6 offset:0
    ds_read_b64_tr_b16 a[6:7], v6 offset:512
    s_waitcnt vmcnt(24)
    ds_read_b64_tr_b16 a[8:9], v5 offset:2048
    ds_read_b64_tr_b16 a[10:11], v5 offset:2560
    ds_read_b64_tr_b16 a[12:13], v6 offset:2048
    ds_read_b64_tr_b16 a[14:15], v6 offset:2560
    s_waitcnt lgkmcnt(4)
    s_add_u32 m0, s5, 0
    s_add_u32 s7, s67, 0
    buffer_load_dwordx4 v4, s[32:35], s7 offen lds
    s_add_u32 m0, s5, 1024
    s_add_u32 s7, s67, 28672
    buffer_load_dwordx4 v4, s[32:35], s7 offen lds
    s_waitcnt vmcnt(24)
    ds_read_b64_tr_b16 a[16:17], v5 offset:4096
    ds_read_b64_tr_b16 a[18:19], v5 offset:4608
    ds_read_b64_tr_b16 a[20:21], v6 offset:4096
    ds_read_b64_tr_b16 a[22:23], v6 offset:4608
    s_waitcnt lgkmcnt(4)
    s_add_u32 m0, s5, 2048
    s_add_u32 s7, s67, 57344
    buffer_load_dwordx4 v4, s[32:35], s7 offen lds
    s_add_u32 m0, s5, 3072
    s_add_u32 s7, s67, 86016
    buffer_load_dwordx4 v4, s[32:35], s7 offen lds
    s_waitcnt vmcnt(24)
    ds_read_b64_tr_b16 a[24:25], v5 offset:6144
    ds_read_b64_tr_b16 a[26:27], v5 offset:6656
    ds_read_b64_tr_b16 a[28:29], v6 offset:6144
    ds_read_b64_tr_b16 a[30:31], v6 offset:6656
    s_waitcnt lgkmcnt(4)
    s_add_u32 m0, s5, 4096
    s_add_u32 s7, s67, 114688
    buffer_load_dwordx4 v4, s[32:35], s7 offen lds
    s_add_u32 m0, s5, 5120
    s_add_u32 s7, s67, 143360
    buffer_load_dwordx4 v4, s[32:35], s7 offen lds
    s_waitcnt vmcnt(24)
    ds_read_b64_tr_b16 a[32:33], v5 offset:8192
    ds_read_b64_tr_b16 a[34:35], v5 offset:8704
    ds_read_b64_tr_b16 a[36:37], v6 offset:8192
    ds_read_b64_tr_b16 a[38:39], v6 offset:8704
    s_waitcnt lgkmcnt(4)
    s_add_u32 m0, s5, 6144
    s_add_u32 s7, s67, 172032
    buffer_load_dwordx4 v4, s[32:35], s7 offen lds
    s_add_u32 m0, s5, 7168
    s_add_u32 s7, s67, 200704
    buffer_load_dwordx4 v4, s[32:35], s7 offen lds
    s_waitcnt vmcnt(24)
    ds_read_b64_tr_b16 a[40:41], v5 offset:10240
    ds_read_b64_tr_b16 a[42:43], v5 offset:10752
    ds_read_b64_tr_b16 a[44:45], v6 offset:10240
    ds_read_b64_tr_b16 a[46:47], v6 offset:10752
    s_waitcnt lgkmcnt(4)
    s_add_u32 m0, s5, 8192
    s_add_u32 s7, s67, 229376
    buffer_load_dwordx4 v4, s[32:35], s7 offen lds
    s_add_u32 m0, s5, 9216
    s_add_u32 s7, s67, 258048
    buffer_load_dwordx4 v4, s[32:35], s7 offen lds
    s_waitcnt vmcnt(24)
    ds_read_b64_tr_b16 a[48:49], v5 offset:12288
    ds_read_b64_tr_b16 a[50:51], v5 offset:12800
    ds_read_b64_tr_b16 a[52:53], v6 offset:12288
    ds_read_b64_tr_b16 a[54:55], v6 offset:12800
    s_waitcnt lgkmcnt(4)
    s_add_u32 m0, s5, 10240
    s_add_u32 s7, s67, 286720
    buffer_load_dwordx4 v4, s[32:35], s7 offen lds
    s_add_u32 m0, s5, 11264
    s_add_u32 s7, s67, 315392
    buffer_load_dwordx4 v4, s[32:35], s7 offen lds
    s_waitcnt vmcnt(24)
    ds_read_b64_tr_b16 a[56:57], v5 offset:14336
    ds_read_b64_tr_b16 a[58:59], v5 offset:14848
    ds_read_b64_tr_b16 a[60:61], v6 offset:14336
    ds_read_b64_tr_b16 a[62:63], v6 offset:14848
    s_waitcnt lgkmcnt(4)
    s_add_u32 m0, s5, 12288
    s_add_u32 s7, s67, 344064
    buffer_load_dwordx4 v4, s[32:35], s7 offen lds
    s_add_u32 m0, s5, 13312
    s_add_u32 s7, s67, 372736
    buffer_load_dwordx4 v4, s[32:35], s7 offen lds
    s_waitcnt vmcnt(24)
    ds_read_b64_tr_b16 a[64:65], v5 offset:16384
    ds_read_b64_tr_b16 a[66:67], v5 offset:16896
    ds_read_b64_tr_b16 a[68:69], v6 offset:16384
    ds_read_b64_tr_b16 a[70:71], v6 offset:16896
    s_waitcnt lgkmcnt(4)
    s_add_u32 m0, s5, 14336
    s_add_u32 s7, s67, 401408
    buffer_load_dwordx4 v4, s[32:35], s7 offen lds
    s_add_u32 m0, s5, 15360
    s_add_u32 s7, s67, 430080
    buffer_load_dwordx4 v4, s[32:35], s7 offen lds
    s_waitcnt vmcnt(24)
    ds_read_b64_tr_b16 a[72:73], v5 offset:18432
    ds_read_b64_tr_b16 a[74:75], v5 offset:18944
    ds_read_b64_tr_b16 a[76:77], v6 offset:18432
    ds_read_b64_tr_b16 a[78:79], v6 offset:18944
    s_waitcnt lgkmcnt(4)
    s_add_u32 m0, s5, 16384
    s_add_u32 s7, s67, 458752
    buffer_load_dwordx4 v4, s[32:35], s7 offen lds
    s_add_u32 m0, s5, 17408
    s_add_u32 s7, s67, 487424
    buffer_load_dwordx4 v4, s[32:35], s7 offen lds
    s_waitcnt vmcnt(24)
    ds_read_b64_tr_b16 a[80:81], v5 offset:20480
    ds_read_b64_tr_b16 a[82:83], v5 offset:20992
    ds_read_b64_tr_b16 a[84:85], v6 offset:20480
    ds_read_b64_tr_b16 a[86:87], v6 offset:20992
    s_waitcnt lgkmcnt(4)
    s_add_u32 m0, s5, 18432
    s_add_u32 s7, s67, 516096
    buffer_load_dwordx4 v4, s[32:35], s7 offen lds
    s_add_u32 m0, s5, 19456
    s_add_u32 s7, s67, 544768
    buffer_load_dwordx4 v4, s[32:35], s7 offen lds
    s_waitcnt vmcnt(24)
    ds_read_b64_tr_b16 a[88:89], v5 offset:22528
    ds_read_b64_tr_b16 a[90:91], v5 offset:23040
    ds_read_b64_tr_b16 a[92:93], v6 offset:22528
    ds_read_b64_tr_b16 a[94:95], v6 offset:23040
    s_waitcnt lgkmcnt(4)
    s_add_u32 m0, s5, 20480
    s_add_u32 s7, s67, 573440
    buffer_load_dwordx4 v4, s[32:35], s7 offen lds
    s_add_u32 m0, s5, 21504
    s_add_u32 s7, s67, 602112
    buffer_load_dwordx4 v4, s[32:35], s7 offen lds
    s_waitcnt vmcnt(24)
    ds_read_b64_tr_b16 a[96:97], v5 offset:24576
    ds_read_b64_tr_b16 a[98:99], v5 offset:25088
    ds_read_b64_tr_b16 a[100:101], v6 offset:24576
    ds_read_b64_tr_b16 a[102:103], v6 offset:25088
    s_waitcnt lgkmcnt(4)
    s_add_u32 m0, s5, 22528
    s_add_u32 s7, s67, 630784
    buffer_load_dwordx4 v4, s[32:35], s7 offen lds
    s_add_u32 m0, s5, 23552
    s_add_u32 s7, s67, 659456
    buffer_load_dwordx4 v4, s[32:35], s7 offen lds
    s_waitcnt vmcnt(24)
    ds_read_b64_tr_b16 a[104:105], v5 offset:26624
    ds_read_b64_tr_b16 a[106:107], v5 offset:27136
    ds_read_b64_tr_b16 a[108:109], v6 offset:26624
    ds_read_b64_tr_b16 a[110:111], v6 offset:27136
    s_waitcnt lgkmcnt(4)
    s_add_u32 m0, s5, 24576
    s_add_u32 s7, s67, 688128
    buffer_load_dwordx4 v4, s[32:35], s7 offen lds
    s_add_u32 m0, s5, 25600
    s_add_u32 s7, s67, 716800
    buffer_load_dwordx4 v4, s[32:35], s7 offen lds
    s_waitcnt vmcnt(24)
    ds_read_b64_tr_b16 a[112:113], v5 offset:0
    ds_read_b64_tr_b16 a[114:115], v5 offset:512
    ds_read_b64_tr_b16 a[116:117], v6 offset:0
    ds_read_b64_tr_b16 a[118:119], v6 offset:512
    s_waitcnt lgkmcnt(4)
    s_add_u32 m0, s5, 26624
    s_add_u32 s7, s67, 745472
    buffer_load_dwordx4 v4, s[32:35], s7 offen lds
    s_add_u32 m0, s5, 27648
    s_add_u32 s7, s67, 774144
    buffer_load_dwordx4 v4, s[32:35], s7 offen lds
    s_waitcnt vmcnt(24)
    ds_read_b64_tr_b16 a[120:121], v5 offset:2048
    ds_read_b64_tr_b16 a[122:123], v5 offset:2560
    ds_read_b64_tr_b16 a[124:125], v6 offset:2048
    ds_read_b64_tr_b16 a[126:127], v6 offset:2560
    s_waitcnt lgkmcnt(4)
    s_add_u32 m0, s5, 0
    s_add_u32 s7, s6, 1720320
    buffer_load_dwordx4 v4, s[32:35], s7 offen lds
    s_add_u32 m0, s5, 1024
    s_add_u32 s7, s6, 1748992
    buffer_load_dwordx4 v4, s[32:35], s7 offen lds
    s_waitcnt vmcnt(24)
    ds_read_b64_tr_b16 a[128:129], v5 offset:4096
    ds_read_b64_tr_b16 a[130:131], v5 offset:4608
    ds_read_b64_tr_b16 a[132:133], v6 offset:4096
    ds_read_b64_tr_b16 a[134:135], v6 offset:4608
    s_waitcnt lgkmcnt(4)
    s_add_u32 m0, s5, 2048
    s_add_u32 s7, s6, 1777664
    buffer_load_dwordx4 v4, s[32:35], s7 offen lds
    s_add_u32 m0, s5, 3072
    s_add_u32 s7, s6, 1806336
    buffer_load_dwordx4 v4, s[32:35], s7 offen lds
    s_waitcnt vmcnt(24)
    ds_read_b64_tr_b16 a[136:137], v5 offset:6144
    ds_read_b64_tr_b16 a[138:139], v5 offset:6656
    ds_read_b64_tr_b16 a[140:141], v6 offset:6144
    ds_read_b64_tr_b16 a[142:143], v6 offset:6656
    s_waitcnt lgkmcnt(4)
    s_add_u32 m0, s5, 4096
    s_add_u32 s7, s6, 802816
    buffer_load_dwordx4 v4, s[32:35], s7 offen lds
    s_add_u32 m0, s5, 5120
    s_add_u32 s7, s6, 831488
    buffer_load_dwordx4 v4, s[32:35], s7 offen lds
    s_waitcnt vmcnt(24)
    ds_read_b64_tr_b16 a[144:145], v5 offset:8192
    ds_read_b64_tr_b16 a[146:147], v5 offset:8704
    ds_read_b64_tr_b16 a[148:149], v6 offset:8192
    ds_read_b64_tr_b16 a[150:151], v6 offset:8704
    s_waitcnt lgkmcnt(4)
    s_add_u32 m0, s5, 6144
    s_add_u32 s7, s6, 860160
    buffer_load_dwordx4 v4, s[32:35], s7 offen lds
    s_add_u32 m0, s5, 7168
    s_add_u32 s7, s6, 888832
    buffer_load_dwordx4 v4, s[32:35], s7 offen lds
    s_waitcnt vmcnt(24)
    ds_read_b64_tr_b16 a[152:153], v5 offset:10240
    ds_read_b64_tr_b16 a[154:155], v5 offset:10752
    ds_read_b64_tr_b16 a[156:157], v6 offset:10240
    ds_read_b64_tr_b16 a[158:159], v6 offset:10752
    s_waitcnt vmcnt(22)
    ds_read_b64_tr_b16 a[160:161], v5 offset:12288
    ds_read_b64_tr_b16 a[162:163], v5 offset:12800
    ds_read_b64_tr_b16 a[164:165], v6 offset:12288
    ds_read_b64_tr_b16 a[166:167], v6 offset:12800
    s_waitcnt vmcnt(20)
    ds_read_b64_tr_b16 a[168:169], v5 offset:14336
    ds_read_b64_tr_b16 a[170:171], v5 offset:14848
    ds_read_b64_tr_b16 a[172:173], v6 offset:14336
    ds_read_b64_tr_b16 a[174:175], v6 offset:14848
    s_waitcnt vmcnt(18)
    ds_read_b64_tr_b16 a[176:177], v5 offset:16384
    ds_read_b64_tr_b16 a[178:179], v5 offset:16896
    ds_read_b64_tr_b16 a[180:181], v6 offset:16384
    ds_read_b64_tr_b16 a[182:183], v6 offset:16896
    s_waitcnt vmcnt(16)
    ds_read_b64_tr_b16 a[184:185], v5 offset:18432
    ds_read_b64_tr_b16 a[186:187], v5 offset:18944
    ds_read_b64_tr_b16 a[188:189], v6 offset:18432
    ds_read_b64_tr_b16 a[190:191], v6 offset:18944
    s_waitcnt vmcnt(14)
    ds_read_b64_tr_b16 a[192:193], v5 offset:20480
    ds_read_b64_tr_b16 a[194:195], v5 offset:20992
    ds_read_b64_tr_b16 a[196:197], v6 offset:20480
    ds_read_b64_tr_b16 a[198:199], v6 offset:20992
    s_waitcnt vmcnt(12)
    ds_read_b64_tr_b16 a[200:201], v5 offset:22528
    ds_read_b64_tr_b16 a[202:203], v5 offset:23040
    ds_read_b64_tr_b16 a[204:205], v6 offset:22528
    ds_read_b64_tr_b16 a[206:207], v6 offset:23040
    s_waitcnt vmcnt(10)
    ds_read_b64_tr_b16 a[208:209], v5 offset:24576
    ds_read_b64_tr_b16 a[210:211], v5 offset:25088
    ds_read_b64_tr_b16 a[212:213], v6 offset:24576
    ds_read_b64_tr_b16 a[214:215], v6 offset:25088
    s_waitcnt vmcnt(8)
    ds_read_b64_tr_b16 a[216:217], v5 offset:26624
    ds_read_b64_tr_b16 a[218:219], v5 offset:27136
    ds_read_b64_tr_b16 a[220:221], v6 offset:26624
    ds_read_b64_tr_b16 a[222:223], v6 offset:27136
    s_waitcnt vmcnt(6)
    ds_read_b64_tr_b16 a[224:225], v5 offset:0
    ds_read_b64_tr_b16 a[226:227], v5 offset:512
    ds_read_b64_tr_b16 a[228:229], v6 offset:0
    ds_read_b64_tr_b16 a[230:231], v6 offset:512
    s_waitcnt vmcnt(4)
    ds_read_b64_tr_b16 a[232:233], v5 offset:2048
    ds_read_b64_tr_b16 a[234:235], v5 offset:2560
    ds_read_b64_tr_b16 a[236:237], v6 offset:2048
    ds_read_b64_tr_b16 a[238:239], v6 offset:2560
    s_waitcnt vmcnt(2)
    ds_read_b64_tr_b16 a[240:241], v5 offset:4096
    ds_read_b64_tr_b16 a[242:243], v5 offset:4608
    ds_read_b64_tr_b16 a[244:245], v6 offset:4096
    ds_read_b64_tr_b16 a[246:247], v6 offset:4608
    s_waitcnt vmcnt(0)
    ds_read_b64_tr_b16 a[248:249], v5 offset:6144
    ds_read_b64_tr_b16 a[250:251], v5 offset:6656
    ds_read_b64_tr_b16 a[252:253], v6 offset:6144
    ds_read_b64_tr_b16 a[254:255], v6 offset:6656
    s_waitcnt lgkmcnt(0)
    v_lshrrev_b32 v18, 3, v1
    v_and_b32 v19, 7, v1
    v_bfe_u32 v20, v1, 4, 1
    v_lshlrev_b32 v20, 2, v20
    v_xor_b32 v19, v19, v20
    v_mul_u32_u24 v18, 4096, v18
    v_lshl_add_u32 v4, v19, 4, v18
    v_and_b32 v18, 15, v1
    v_lshrrev_b32 v19, 2, v18
    v_lshrrev_b32 v20, 5, v1
    v_lshl_add_u32 v19, v20, 2, v19
    v_bfe_u32 v20, v18, 3, 1
    s_and_b32 s4, s56, 1
    v_xor_b32 v20, s4, v20
    v_lshlrev_b32 v20, 6, v20
    v_lshl_add_u32 v20, v19, 7, v20
    v_bfe_u32 v19, v1, 4, 1
    v_lshl_add_u32 v20, v19, 5, v20
    v_and_b32 v19, 3, v1
    v_lshl_add_u32 v20, v19, 3, v20
    s_mul_i32 s5, s56, 28672
    s_add_u32 s5, s5, 49152
    v_xor_b32 v19, 64, v20
    v_add_u32 v5, s5, v20
    v_add_u32 v6, s5, v19
    s_mul_i32 s6, s56, 1835008
    s_lshl_b32 s7, s64, 7
    s_add_u32 s6, s6, s7
    s_mov_b32 s66, s6
    s_add_u32 s67, s6, 917504
    s_add_u32 m0, s5, 26624
    s_add_u32 s7, s66, 851968
    buffer_load_dwordx4 v4, s[36:39], s7 offen lds
    s_add_u32 m0, s5, 27648
    s_add_u32 s7, s66, 884736
    buffer_load_dwordx4 v4, s[36:39], s7 offen lds
    s_add_u32 m0, s5, 24576
    s_add_u32 s7, s66, 786432
    buffer_load_dwordx4 v4, s[36:39], s7 offen lds
    s_add_u32 m0, s5, 25600
    s_add_u32 s7, s66, 819200
    buffer_load_dwordx4 v4, s[36:39], s7 offen lds
    s_add_u32 m0, s5, 22528
    s_add_u32 s7, s66, 720896
    buffer_load_dwordx4 v4, s[36:39], s7 offen lds
    s_add_u32 m0, s5, 23552
    s_add_u32 s7, s66, 753664
    buffer_load_dwordx4 v4, s[36:39], s7 offen lds
    s_add_u32 m0, s5, 20480
    s_add_u32 s7, s66, 655360
    buffer_load_dwordx4 v4, s[36:39], s7 offen lds
    s_add_u32 m0, s5, 21504
    s_add_u32 s7, s66, 688128
    buffer_load_dwordx4 v4, s[36:39], s7 offen lds
    s_add_u32 m0, s5, 18432
    s_add_u32 s7, s66, 589824
    buffer_load_dwordx4 v4, s[36:39], s7 offen lds
    s_add_u32 m0, s5, 19456
    s_add_u32 s7, s66, 622592
    buffer_load_dwordx4 v4, s[36:39], s7 offen lds
    s_add_u32 m0, s5, 16384
    s_add_u32 s7, s66, 524288
    buffer_load_dwordx4 v4, s[36:39], s7 offen lds
    s_add_u32 m0, s5, 17408
    s_add_u32 s7, s66, 557056
    buffer_load_dwordx4 v4, s[36:39], s7 offen lds
    s_add_u32 m0, s5, 14336
    s_add_u32 s7, s66, 458752
    buffer_load_dwordx4 v4, s[36:39], s7 offen lds
    s_add_u32 m0, s5, 15360
    s_add_u32 s7, s66, 491520
    buffer_load_dwordx4 v4, s[36:39], s7 offen lds
    s_add_u32 m0, s5, 12288
    s_add_u32 s7, s66, 393216
    buffer_load_dwordx4 v4, s[36:39], s7 offen lds
    s_add_u32 m0, s5, 13312
    s_add_u32 s7, s66, 425984
    buffer_load_dwordx4 v4, s[36:39], s7 offen lds
    s_add_u32 m0, s5, 10240
    s_add_u32 s7, s66, 327680
    buffer_load_dwordx4 v4, s[36:39], s7 offen lds
    s_add_u32 m0, s5, 11264
    s_add_u32 s7, s66, 360448
    buffer_load_dwordx4 v4, s[36:39], s7 offen lds
    s_add_u32 m0, s5, 8192
    s_add_u32 s7, s66, 262144
    buffer_load_dwordx4 v4, s[36:39], s7 offen lds
    s_add_u32 m0, s5, 9216
    s_add_u32 s7, s66, 294912
    buffer_load_dwordx4 v4, s[36:39], s7 offen lds
    s_add_u32 m0, s5, 6144
    s_add_u32 s7, s66, 196608
    buffer_load_dwordx4 v4, s[36:39], s7 offen lds
    s_add_u32 m0, s5, 7168
    s_add_u32 s7, s66, 229376
    buffer_load_dwordx4 v4, s[36:39], s7 offen lds
    s_add_u32 m0, s5, 4096
    s_add_u32 s7, s66, 131072
    buffer_load_dwordx4 v4, s[36:39], s7 offen lds
    s_add_u32 m0, s5, 5120
    s_add_u32 s7, s66, 163840
    buffer_load_dwordx4 v4, s[36:39], s7 offen lds
    s_add_u32 m0, s5, 2048
    s_add_u32 s7, s66, 65536
    buffer_load_dwordx4 v4, s[36:39], s7 offen lds
    s_add_u32 m0, s5, 3072
    s_add_u32 s7, s66, 98304
    buffer_load_dwordx4 v4, s[36:39], s7 offen lds
    s_add_u32 m0, s5, 0
    s_add_u32 s7, s66, 0
    buffer_load_dwordx4 v4, s[36:39], s7 offen lds
    s_add_u32 m0, s5, 1024
    s_add_u32 s7, s66, 32768
    buffer_load_dwordx4 v4, s[36:39], s7 offen lds
    v_lshlrev_b32 v252, 4, v1
    s_xor_b32 s9, s56, 1
    s_mul_i32 s9, s9, 12288
    s_add_u32 s9, s9, 0
    v_add_u32 v9, s9, v252
    s_xor_b32 s9, s56, 3
    s_mul_i32 s9, s9, 12288
    s_add_u32 s9, s9, 2048
    v_add_u32 v10, s9, v252
    s_xor_b32 s9, s56, 2
    s_mul_i32 s9, s9, 12288
    s_add_u32 s9, s9, 4096
    v_add_u32 v11, s9, v252
    s_mul_i32 s9, s56, 12288
    v_add_u32 v12, s9, v252
    v_mov_b32 v7, v252
    v_add_u32 v8, 0x400, v252
    s_lshl_b32 s8, s56, 16
    s_lshl_b32 s9, s63, 18
    s_add_u32 s8, s8, s9
    s_add_u32 s8, s8, 2883584
    s_add_u32 s68, s8, 32768
    s_bitcmp0_b32 s58, 0
    s_cselect_b32 s69, s68, s8
    s_cselect_b32 s68, s8, s68
    s_lshl_b32 s10, s64, 2
    s_and_b32 s11, s56, 1
    s_lshl_b32 s11, s11, 1
    s_add_u32 s10, s10, s11
    v_lshlrev_b32 v22, 7, v1
    s_mov_b32 s9, 4096
    buffer_load_dword v21, v22, s[40:43], s9 offen sc1
    s_and_b32 s9, s56, 1
    s_lshl_b32 s9, s9, 1
    s_lshr_b32 s11, s56, 1
    s_add_u32 s9, s9, s11
    s_lshl_b32 s70, s62, 2
    s_add_u32 s70, s70, s9
    v_lshrrev_b32 v19, 5, v1
    v_lshlrev_b32 v19, 3, v19
    s_lshl_b32 s9, s70, 5
    buffer_load_dwordx2 v[24:25], v19, s[48:51], s9 offen offset:0
    buffer_load_dwordx2 v[26:27], v19, s[48:51], s9 offen offset:16
    s_lshl_b32 s70, s70, 11
    s_mul_i32 s9, s63, 229376
    s_add_u32 s70, s70, s9
    s_add_u32 s70, s70, 4718592
    v_cmp_le_u32 vcc, 7, v1
    s_nop 1
    v_cndmask_b32 v23, 1, 3, vcc
    v_lshl_add_u32 v23, v1, 1, v23
    v_lshlrev_b32 v23, 11, v23
    s_mov_b64 exec, 129
    buffer_load_dword v20, v23, s[40:43], s8 offen sc1
    s_mov_b64 exec, -1
    v_mov_b32 v40, 0
    v_mov_b32 v41, 0
    v_mov_b32 v42, 0
    v_mov_b32 v43, 0
    v_mov_b32 v44, 0
    v_mov_b32 v45, 0
    v_mov_b32 v46, 0
    v_mov_b32 v47, 0
    v_mov_b32 v72, 0
    v_mov_b32 v73, 0
    v_mov_b32 v74, 0
    v_mov_b32 v75, 0
    v_mov_b32 v76, 0
    v_mov_b32 v77, 0
    v_mov_b32 v78, 0
    v_mov_b32 v79, 0
    s_waitcnt vmcnt(0)
    v_lshlrev_b32 v32, 16, v24
    v_and_b32 v33, 0xffff0000, v24
    v_lshlrev_b32 v34, 16, v25
    v_and_b32 v35, 0xffff0000, v25
    v_lshlrev_b32 v36, 16, v26
    v_and_b32 v37, 0xffff0000, v26
    v_lshlrev_b32 v38, 16, v27
    v_and_b32 v39, 0xffff0000, v27
    v_lshlrev_b32 v64, 16, v24
    v_and_b32 v65, 0xffff0000, v24
    v_lshlrev_b32 v66, 16, v25
    v_and_b32 v67, 0xffff0000, v25
    v_lshlrev_b32 v68, 16, v26
    v_and_b32 v69, 0xffff0000, v26
    v_lshlrev_b32 v70, 16, v27
    v_and_b32 v71, 0xffff0000, v27
    v_cmp_ne_u32 vcc, s57, v21
    s_and_b32 s16, vcc_lo, 0xff7fff7f
    s_and_b32 s17, vcc_hi, 0xff7fff7f
    s_or_b32 s16, s16, s17
    s_cbranch_scc0 L_ok_59
    v_lshlrev_b32 v19, 7, v1
    s_mov_b32 s9, 4096
    s_mov_b32 exec_lo, 0xff7fff7f
    s_mov_b32 exec_hi, 0xff7fff7f
L_poll_60:
    buffer_load_dword v21, v19, s[40:43], s9 offen sc1
L_poll_60_chk:
    s_add_u32 s77, s77, 1
    s_waitcnt vmcnt(0)
    v_cmp_ne_u32 vcc, s57, v21
    s_cmp_ge_u32 s77, 50000
    s_cbranch_scc1 L_seen_61
    s_and_b64 exec, exec, vcc
    s_cbranch_scc1 L_poll_60
L_seen_61:
    s_mov_b64 exec, -1
    v_mov_b32 v20, -1
L_ok_59:
    s_lshl_b32 s9, s10, 7
    s_add_u32 s9, s9, 32768
    v_bfe_u32 v19, v1, 4, 1
    v_lshl_add_u32 v19, v19, 7, s9
    s_mul_i32 s12, s56, 12288
    s_lshr_b32 s11, s56, 1
    s_lshl_b32 s11, s11, 8
    s_add_u32 s12, s12, s11
    s_add_u32 s12, s12, 6144
    v_bfe_u32 v17, v1, 4, 1
    v_lshlrev_b32 v17, 10, v17
    v_bfe_u32 v24, v1, 1, 1
    v_lshl_add_u32 v17, v24, 9, v17
    v_lshrrev_b32 v24, 5, v1
    v_bfe_u32 v25, v1, 2, 2
    v_lshl_add_u32 v24, v24, 2, v25
    v_lshl_add_u32 v17, v24, 4, v17
    v_and_b32 v24, 1, v1
    v_lshl_add_u32 v17, v24, 3, v17
    v_add_u32 v17, s12, v17
    v_and_b32 v18, 31, v1
    v_mul_u32_u24 v18, 896, v18
    v_lshrrev_b32 v24, 5, v1
    v_lshl_add_u32 v18, v24, 4, v18
    s_mul_i32 s15, s10, 14336
    s_lshl_b32 s11, s65, 7
    s_add_u32 s15, s15, s11
    s_lshr_b32 s11, s56, 1
    s_lshl_b32 s11, s11, 5
    s_add_u32 s15, s15, s11
    s_barrier
    v_cmp_eq_u32 vcc, -1, v20
    s_and_b32 s16, vcc_lo, 129
    s_cbranch_scc0 L_ok_62
    s_mov_b32 exec_lo, 0x81
    s_mov_b32 exec_hi, 0x0
L_poll_63:
    buffer_load_dword v21, v23, s[40:43], s8 offen sc1
L_poll_63_chk:
    s_add_u32 s77, s77, 1
    s_waitcnt vmcnt(0)
    v_cmp_eq_u32 vcc, -1, v21
    s_cmp_ge_u32 s77, 50000
    s_cbranch_scc1 L_seen_64
    s_and_b64 exec, exec, vcc
    s_cbranch_scc1 L_poll_63
L_seen_64:
    s_mov_b64 exec, -1
L_ok_62:
    s_mov_b32 s18, 0xbdd2d3e8
    s_mov_b32 s19, s18
    v_mov_b32 v22, 0xc0135761
    v_mov_b32 v23, v22
    s_add_u32 s11, s68, 0
    buffer_load_dwordx4 v[96:99], v7, s[40:43], s11 offen sc1
    buffer_load_dwordx4 v[100:103], v8, s[40:43], s11 offen sc1
    s_add_u32 s11, s68, 2048
    buffer_load_dwordx4 v[104:107], v7, s[40:43], s11 offen sc1
    buffer_load_dwordx4 v[108:111], v8, s[40:43], s11 offen sc1
    s_add_u32 s11, s68, 4096
    buffer_load_dwordx4 v[112:115], v7, s[40:43], s11 offen sc1
    buffer_load_dwordx4 v[116:119], v8, s[40:43], s11 offen sc1
    s_add_u32 s11, s68, 6144
    buffer_load_dwordx4 v[120:123], v7, s[40:43], s11 offen sc1
    buffer_load_dwordx4 v[124:127], v8, s[40:43], s11 offen sc1
    s_add_u32 s11, s68, 8192
    buffer_load_dwordx4 v[128:131], v7, s[40:43], s11 offen sc1
    buffer_load_dwordx4 v[132:135], v8, s[40:43], s11 offen sc1
    s_add_u32 s11, s68, 10240
    buffer_load_dwordx4 v[136:139], v7, s[40:43], s11 offen sc1
    buffer_load_dwordx4 v[140:143], v8, s[40:43], s11 offen sc1
    s_add_u32 s11, s68, 12288
    buffer_load_dwordx4 v[144:147], v7, s[40:43], s11 offen sc1
    buffer_load_dwordx4 v[148:151], v8, s[40:43], s11 offen sc1
    s_waitcnt vmcnt(12)
    v_max_u32 v20, v96, v100
    v_cmp_eq_u32 vcc, -1, v20
    s_cbranch_vccnz L_retry_g1_0_0
L_back_g1_0_0:
    v_mfma_f32_32x32x16_bf16 v[80:95], a[4:7], v[100:103], 0
    s_add_u32 s11, s68, 14336
    buffer_load_dwordx4 v[152:155], v7, s[40:43], s11 offen sc1
    v_mfma_f32_32x32x16_bf16 v[64:79], a[0:3], v[100:103], v[64:79]
    buffer_load_dwordx4 v[156:159], v8, s[40:43], s11 offen sc1
    v_mfma_f32_32x32x16_bf16 v[48:63], a[4:7], v[96:99], 0
    s_waitcnt vmcnt(12)
    v_max_u32 v20, v104, v108
    v_cmp_eq_u32 vcc, -1, v20
    v_mfma_f32_32x32x16_bf16 v[32:47], a[0:3], v[96:99], v[32:47]
    s_cbranch_vccnz L_retry_g1_1_0
L_back_g1_1_0:
    v_mfma_f32_32x32x16_bf16 v[80:95], a[12:15], v[108:111], v[80:95]
    s_add_u32 s11, s68, 16384
    buffer_load_dwordx4 v[160:163], v7, s[40:43], s11 offen sc1
    ds_read_b64_tr_b16 a[0:1], v5 offset:0
    v_mfma_f32_32x32x16_bf16 v[64:79], a[8:11], v[108:111], v[64:79]
    buffer_load_dwordx4 v[164:167], v8, s[40:43], s11 offen sc1
    ds_read_b64_tr_b16 a[2:3], v5 offset:1024
    v_mfma_f32_32x32x16_bf16 v[48:63], a[12:15], v[104:107], v[48:63]
    ds_read_b64_tr_b16 a[4:5], v6 offset:0
    s_waitcnt vmcnt(12)
    v_max_u32 v20, v112, v116
    v_cmp_eq_u32 vcc, -1, v20
    v_mfma_f32_32x32x16_bf16 v[32:47], a[8:11], v[104:107], v[32:47]
    ds_read_b64_tr_b16 a[6:7], v6 offset:1024
    s_cbranch_vccnz L_retry_g1_2_0
L_back_g1_2_0:
    v_mfma_f32_32x32x16_bf16 v[80:95], a[20:23], v[116:119], v[80:95]
    s_add_u32 s11, s68, 18432
    buffer_load_dwordx4 v[168:171], v7, s[40:43], s11 offen sc1
    ds_read_b64_tr_b16 a[8:9], v5 offset:2048
    v_mfma_f32_32x32x16_bf16 v[64:79], a[16:19], v[116:119], v[64:79]
    buffer_load_dwordx4 v[172:175], v8, s[40:43], s11 offen sc1
    ds_read_b64_tr_b16 a[10:11], v5 offset:3072
    v_mfma_f32_32x32x16_bf16 v[48:63], a[20:23], v[112:115], v[48:63]
    ds_read_b64_tr_b16 a[12:13], v6 offset:2048
    s_waitcnt vmcnt(12)
    v_max_u32 v20, v120, v124
    v_cmp_eq_u32 vcc, -1, v20
    v_mfma_f32_32x32x16_bf16 v[32:47], a[16:19], v[112:115], v[32:47]
    ds_read_b64_tr_b16 a[14:15], v6 offset:3072
    s_cbranch_vccnz L_retry_g1_3_0
L_back_g1_3_0:
    v_mfma_f32_32x32x16_bf16 v[80:95], a[28:31], v[124:127], v[80:95]
    s_add_u32 s11, s68, 20480
    buffer_load_dwordx4 v[176:179], v7, s[40:43], s11 offen sc1
    ds_read_b64_tr_b16 a[16:17], v5 offset:4096
    v_mfma_f32_32x32x16_bf16 v[64:79], a[24:27], v[124:127], v[64:79]
    buffer_load_dwordx4 v[180:183], v8, s[40:43], s11 offen sc1
    ds_read_b64_tr_b16 a[18:19], v5 offset:5120
    v_mfma_f32_32x32x16_bf16 v[48:63], a[28:31], v[120:123], v[48:63]
    ds_read_b64_tr_b16 a[20:21], v6 offset:4096
    s_waitcnt vmcnt(12)
    v_max_u32 v20, v128, v132
    v_cmp_eq_u32 vcc, -1, v20
    v_mfma_f32_32x32x16_bf16 v[32:47], a[24:27], v[120:123], v[32:47]
    ds_read_b64_tr_b16 a[22:23], v6 offset:5120
    s_cbranch_vccnz L_retry_g1_4_0
L_back_g1_4_0:
    v_mfma_f32_32x32x16_bf16 v[80:95], a[36:39], v[132:135], v[80:95]
    s_add_u32 s11, s68, 22528
    buffer_load_dwordx4 v[184:187], v7, s[40:43], s11 offen sc1
    ds_read_b64_tr_b16 a[24:25], v5 offset:6144
    v_mfma_f32_32x32x16_bf16 v[64:79], a[32:35], v[132:135], v[64:79]
    buffer_load_dwordx4 v[188:191], v8, s[40:43], s11 offen sc1
    ds_read_b64_tr_b16 a[26:27], v5 offset:7168
    v_mfma_f32_32x32x16_bf16 v[48:63], a[36:39], v[128:131], v[48:63]
    ds_read_b64_tr_b16 a[28:29], v6 offset:6144
    s_waitcnt vmcnt(12)
    v_max_u32 v20, v136, v140
    v_cmp_eq_u32 vcc, -1, v20
    v_mfma_f32_32x32x16_bf16 v[32:47], a[32:35], v[128:131], v[32:47]
    ds_read_b64_tr_b16 a[30:31], v6 offset:7168
    s_cbranch_vccnz L_retry_g1_5_0
L_back_g1_5_0:
    v_mfma_f32_32x32x16_bf16 v[80:95], a[44:47], v[140:143], v[80:95]
    s_add_u32 s11, s68, 24576
    buffer_load_dwordx4 v[192:195], v7, s[40:43], s11 offen sc1
    ds_read_b64_tr_b16 a[32:33], v5 offset:8192
    v_mfma_f32_32x32x16_bf16 v[64:79], a[40:43], v[140:143], v[64:79]
    buffer_load_dwordx4 v[196:199], v8, s[40:43], s11 offen sc1
    ds_read_b64_tr_b16 a[34:35], v5 offset:9216
    v_mfma_f32_32x32x16_bf16 v[48:63], a[44:47], v[136:139], v[48:63]
    ds_read_b64_tr_b16 a[36:37], v6 offset:8192
    s_waitcnt vmcnt(12)
    v_max_u32 v20, v144, v148
    v_cmp_eq_u32 vcc, -1, v20
    v_mfma_f32_32x32x16_bf16 v[32:47], a[40:43], v[136:139], v[32:47]
    ds_read_b64_tr_b16 a[38:39], v6 offset:9216
    s_cbranch_vccnz L_retry_g1_6_0
L_back_g1_6_0:
    v_mfma_f32_32x32x16_bf16 v[80:95], a[52:55], v[148:151], v[80:95]
    s_add_u32 s11, s68, 26624
    buffer_load_dwordx4 v[200:203], v7, s[40:43], s11 offen sc1
    ds_read_b64_tr_b16 a[40:41], v5 offset:10240
    v_mfma_f32_32x32x16_bf16 v[64:79], a[48:51], v[148:151], v[64:79]
    buffer_load_dwordx4 v[204:207], v8, s[40:43], s11 offen sc1
    ds_read_b64_tr_b16 a[42:43], v5 offset:11264
    v_mfma_f32_32x32x16_bf16 v[48:63], a[52:55], v[144:147], v[48:63]
    ds_read_b64_tr_b16 a[44:45], v6 offset:10240
    s_waitcnt vmcnt(12)
    v_max_u32 v20, v152, v156
    v_cmp_eq_u32 vcc, -1, v20
    v_mfma_f32_32x32x16_bf16 v[32:47], a[48:51], v[144:147], v[32:47]
    ds_read_b64_tr_b16 a[46:47], v6 offset:11264
    s_cbranch_vccnz L_retry_g1_7_0
L_back_g1_7_0:
    v_mfma_f32_32x32x16_bf16 v[80:95], a[60:63], v[156:159], v[80:95]
    s_add_u32 s11, s69, 0
    buffer_load_dwordx4 v[96:99], v7, s[40:43], s11 offen sc1
    ds_read_b64_tr_b16 a[48:49], v5 offset:12288
    v_mfma_f32_32x32x16_bf16 v[64:79], a[56:59], v[156:159], v[64:79]
    buffer_load_dwordx4 v[100:103], v8, s[40:43], s11 offen sc1
    ds_read_b64_tr_b16 a[50:51], v5 offset:13312
    v_mfma_f32_32x32x16_bf16 v[48:63], a[60:63], v[152:155], v[48:63]
    ds_read_b64_tr_b16 a[52:53], v6 offset:12288
    s_waitcnt vmcnt(12)
    v_max_u32 v20, v160, v164
    v_cmp_eq_u32 vcc, -1, v20
    v_mfma_f32_32x32x16_bf16 v[32:47], a[56:59], v[152:155], v[32:47]
    ds_read_b64_tr_b16 a[54:55], v6 offset:13312
    s_cbranch_vccnz L_retry_g1_8_0
L_back_g1_8_0:
    v_mfma_f32_32x32x16_bf16 v[80:95], a[68:71], v[164:167], v[80:95]
    s_add_u32 s11, s69, 2048
    buffer_load_dwordx4 v[104:107], v7, s[40:43], s11 offen sc1
    ds_read_b64_tr_b16 a[56:57], v5 offset:14336
    v_mfma_f32_32x32x16_bf16 v[64:79], a[64:67], v[164:167], v[64:79]
    buffer_load_dwordx4 v[108:111], v8, s[40:43], s11 offen sc1
    ds_read_b64_tr_b16 a[58:59], v5 offset:15360
    v_mfma_f32_32x32x16_bf16 v[48:63], a[68:71], v[160:163], v[48:63]
    ds_read_b64_tr_b16 a[60:61], v6 offset:14336
    s_waitcnt vmcnt(12)
    v_max_u32 v20, v168, v172
    v_cmp_eq_u32 vcc, -1, v20
    v_mfma_f32_32x32x16_bf16 v[32:47], a[64:67], v[160:163], v[32:47]
    ds_read_b64_tr_b16 a[62:63], v6 offset:15360
    s_cbranch_vccnz L_retry_g1_9_0
L_back_g1_9_0:
    v_mfma_f32_32x32x16_bf16 v[80:95], a[76:79], v[172:175], v[80:95]
    s_add_u32 s11, s69, 4096
    buffer_load_dwordx4 v[112:115], v7, s[40:43], s11 offen sc1
    ds_read_b64_tr_b16 a[64:65], v5 offset:16384
    v_mfma_f32_32x32x16_bf16 v[64:79], a[72:75], v[172:175], v[64:79]
    buffer_load_dwordx4 v[116:119], v8, s[40:43], s11 offen sc1
    ds_read_b64_tr_b16 a[66:67], v5 offset:17408
    v_mfma_f32_32x32x16_bf16 v[48:63], a[76:79], v[168:171], v[48:63]
    ds_read_b64_tr_b16 a[68:69], v6 offset:16384
    s_waitcnt vmcnt(12)
    v_max_u32 v20, v176, v180
    v_cmp_eq_u32 vcc, -1, v20
    v_mfma_f32_32x32x16_bf16 v[32:47], a[72:75], v[168:171], v[32:47]
    ds_read_b64_tr_b16 a[70:71], v6 offset:17408
    s_cbranch_vccnz L_retry_g1_10_0
L_back_g1_10_0:
    v_mfma_f32_32x32x16_bf16 v[80:95], a[84:87], v[180:183], v[80:95]
    s_add_u32 s11, s69, 6144
    buffer_load_dwordx4 v[120:123], v7, s[40:43], s11 offen sc1
    ds_read_b64_tr_b16 a[72:73], v5 offset:18432
    v_mfma_f32_32x32x16_bf16 v[64:79], a[80:83], v[180:183], v[64:79]
    buffer_load_dwordx4 v[124:127], v8, s[40:43], s11 offen sc1
    ds_read_b64_tr_b16 a[74:75], v5 offset:19456
    v_mfma_f32_32x32x16_bf16 v[48:63], a[84:87], v[176:179], v[48:63]
    ds_read_b64_tr_b16 a[76:77], v6 offset:18432
    s_waitcnt vmcnt(12)
    v_max_u32 v20, v184, v188
    v_cmp_eq_u32 vcc, -1, v20
    v_mfma_f32_32x32x16_bf16 v[32:47], a[80:83], v[176:179], v[32:47]
    ds_read_b64_tr_b16 a[78:79], v6 offset:19456
    s_cbranch_vccnz L_retry_g1_11_0
L_back_g1_11_0:
    v_mfma_f32_32x32x16_bf16 v[80:95], a[92:95], v[188:191], v[80:95]
    s_add_u32 s11, s69, 8192
    buffer_load_dwordx4 v[128:131], v7, s[40:43], s11 offen sc1
    ds_read_b64_tr_b16 a[80:81], v5 offset:20480
    v_mfma_f32_32x32x16_bf16 v[64:79], a[88:91], v[188:191], v[64:79]
    buffer_load_dwordx4 v[132:135], v8, s[40:43], s11 offen sc1
    ds_read_b64_tr_b16 a[82:83], v5 offset:21504
    v_mfma_f32_32x32x16_bf16 v[48:63], a[92:95], v[184:187], v[48:63]
    ds_read_b64_tr_b16 a[84:85], v6 offset:20480
    s_waitcnt vmcnt(12)
    v_max_u32 v20, v192, v196
    v_cmp_eq_u32 vcc, -1, v20
    v_mfma_f32_32x32x16_bf16 v[32:47], a[88:91], v[184:187], v[32:47]
    ds_read_b64_tr_b16 a[86:87], v6 offset:21504
    s_cbranch_vccnz L_retry_g1_12_0
L_back_g1_12_0:
    v_mfma_f32_32x32x16_bf16 v[80:95], a[100:103], v[196:199], v[80:95]
    s_add_u32 s11, s69, 10240
    buffer_load_dwordx4 v[136:139], v7, s[40:43], s11 offen sc1
    ds_read_b64_tr_b16 a[88:89], v5 offset:22528
    v_mfma_f32_32x32x16_bf16 v[64:79], a[96:99], v[196:199], v[64:79]
    buffer_load_dwordx4 v[140:143], v8, s[40:43], s11 offen sc1
    ds_read_b64_tr_b16 a[90:91], v5 offset:23552
    v_mfma_f32_32x32x16_bf16 v[48:63], a[100:103], v[192:195], v[48:63]
    ds_read_b64_tr_b16 a[92:93], v6 offset:22528
    s_waitcnt vmcnt(12)
    v_max_u32 v20, v200, v204
    v_cmp_eq_u32 vcc, -1, v20
    v_mfma_f32_32x32x16_bf16 v[32:47], a[96:99], v[192:195], v[32:47]
    ds_read_b64_tr_b16 a[94:95], v6 offset:23552
    s_cbranch_vccnz L_retry_g1_13_0
L_back_g1_13_0:
    v_mfma_f32_32x32x16_bf16 v[80:95], a[108:111], v[204:207], v[80:95]
    s_add_u32 s11, s69, 12288
    buffer_load_dwordx4 v[144:147], v7, s[40:43], s11 offen sc1
    ds_read_b64_tr_b16 a[96:97], v5 offset:24576
    v_mfma_f32_32x32x16_bf16 v[64:79], a[104:107], v[204:207], v[64:79]
    buffer_load_dwordx4 v[148:151], v8, s[40:43], s11 offen sc1
    ds_read_b64_tr_b16 a[98:99], v5 offset:25600
    v_mfma_f32_32x32x16_bf16 v[48:63], a[108:111], v[200:203], v[48:63]
    ds_read_b64_tr_b16 a[100:101], v6 offset:24576
    s_waitcnt vmcnt(12)
    v_max_u32 v20, v96, v100
    v_cmp_eq_u32 vcc, -1, v20
    v_mfma_f32_32x32x16_bf16 v[32:47], a[104:107], v[200:203], v[32:47]
    ds_read_b64_tr_b16 a[102:103], v6 offset:25600
    s_cbranch_vccnz L_retry_g1_14_0
L_back_g1_14_0:
    v_mfma_f32_32x32x16_bf16 v[80:95], a[116:119], v[100:103], v[80:95]
    s_add_u32 s11, s69, 14336
    buffer_load_dwordx4 v[152:155], v7, s[40:43], s11 offen sc1
    ds_read_b64_tr_b16 a[104:105], v5 offset:26624
    v_mfma_f32_32x32x16_bf16 v[64:79], a[112:115], v[100:103], v[64:79]
    buffer_load_dwordx4 v[156:159], v8, s[40:43], s11 offen sc1
    ds_read_b64_tr_b16 a[106:107], v5 offset:27648
    v_mfma_f32_32x32x16_bf16 v[48:63], a[116:119], v[96:99], v[48:63]
    ds_read_b64_tr_b16 a[108:109], v6 offset:26624
    s_waitcnt vmcnt(12)
    v_max_u32 v20, v104, v108
    v_cmp_eq_u32 vcc, -1, v20
    v_mfma_f32_32x32x16_bf16 v[32:47], a[112:115], v[96:99], v[32:47]
    ds_read_b64_tr_b16 a[110:111], v6 offset:27648
    s_cbranch_vccnz L_retry_g1_15_0
L_back_g1_15_0:
    v_mfma_f32_32x32x16_bf16 v[80:95], a[124:127], v[108:111], v[80:95]
    s_add_u32 s11, s69, 16384
    buffer_load_dwordx4 v[160:163], v7, s[40:43], s11 offen sc1
    v_mfma_f32_32x32x16_bf16 v[64:79], a[120:123], v[108:111], v[64:79]
    buffer_load_dwordx4 v[164:167], v8, s[40:43], s11 offen sc1
    v_mfma_f32_32x32x16_bf16 v[48:63], a[124:127], v[104:107], v[48:63]
    s_waitcnt vmcnt(12)
    v_max_u32 v20, v112, v116
    v_cmp_eq_u32 vcc, -1, v20
    v_mfma_f32_32x32x16_bf16 v[32:47], a[120:123], v[104:107], v[32:47]
    s_cbranch_vccnz L_retry_g1_16_0
L_back_g1_16_0:
    v_mfma_f32_32x32x16_bf16 v[80:95], a[132:135], v[116:119], v[80:95]
    s_add_u32 s11, s69, 18432
    buffer_load_dwordx4 v[168:171], v7, s[40:43], s11 offen sc1
    v_mfma_f32_32x32x16_bf16 v[64:79], a[128:131], v[116:119], v[64:79]
    buffer_load_dwordx4 v[172:175], v8, s[40:43], s11 offen sc1
    v_mfma_f32_32x32x16_bf16 v[48:63], a[132:135], v[112:115], v[48:63]
    s_waitcnt vmcnt(12)
    v_max_u32 v20, v120, v124
    v_cmp_eq_u32 vcc, -1, v20
    v_mfma_f32_32x32x16_bf16 v[32:47], a[128:131], v[112:115], v[32:47]
    s_cbranch_vccnz L_retry_g1_17_0
L_back_g1_17_0:
    v_mfma_f32_32x32x16_bf16 v[80:95], a[140:143], v[124:127], v[80:95]
    s_add_u32 s11, s69, 20480
    buffer_load_dwordx4 v[176:179], v7, s[40:43], s11 offen sc1
    v_mfma_f32_32x32x16_bf16 v[64:79], a[136:139], v[124:127], v[64:79]
    buffer_load_dwordx4 v[180:183], v8, s[40:43], s11 offen sc1
    v_mfma_f32_32x32x16_bf16 v[48:63], a[140:143], v[120:123], v[48:63]
    s_waitcnt vmcnt(12)
    v_max_u32 v20, v128, v132
    v_cmp_eq_u32 vcc, -1, v20
    v_mfma_f32_32x32x16_bf16 v[32:47], a[136:139], v[120:123], v[32:47]
    s_cbranch_vccnz L_retry_g1_18_0
L_back_g1_18_0:
    buffer_load_dword v21, v19, s[40:43], 0 offen sc1
    v_mfma_f32_32x32x16_bf16 v[80:95], a[148:151], v[132:135], v[80:95]
    s_add_u32 s11, s69, 22528
    buffer_load_dwordx4 v[184:187], v7, s[40:43], s11 offen sc1
    v_mfma_f32_32x32x16_bf16 v[64:79], a[144:147], v[132:135], v[64:79]
    buffer_load_dwordx4 v[188:191], v8, s[40:43], s11 offen sc1
    v_mfma_f32_32x32x16_bf16 v[48:63], a[148:151], v[128:131], v[48:63]
    s_waitcnt vmcnt(13)
    v_max_u32 v20, v136, v140
    v_cmp_eq_u32 vcc, -1, v20
    v_mfma_f32_32x32x16_bf16 v[32:47], a[144:147], v[128:131], v[32:47]
    s_cbranch_vccnz L_retry_g1_19_0
L_back_g1_19_0:
    v_mfma_f32_32x32x16_bf16 v[80:95], a[156:159], v[140:143], v[80:95]
    s_add_u32 s11, s69, 24576
    buffer_load_dwordx4 v[196:199], v8, s[40:43], s11 offen sc1
    v_mfma_f32_32x32x16_bf16 v[64:79], a[152:155], v[140:143], v[64:79]
    s_add_u32 s11, s69, 26624
    buffer_load_dwordx4 v[204:207], v8, s[40:43], s11 offen sc1
    v_mfma_f32_32x32x16_bf16 v[48:63], a[156:159], v[136:139], v[48:63]
    s_waitcnt vmcnt(13)
    v_max_u32 v20, v144, v148
    v_cmp_eq_u32 vcc, -1, v20
    v_mfma_f32_32x32x16_bf16 v[32:47], a[152:155], v[136:139], v[32:47]
    s_cbranch_vccnz L_retry_g1_20_0
L_back_g1_20_0:
    v_mfma_f32_32x32x16_bf16 v[80:95], a[164:167], v[148:151], v[80:95]
    s_add_u32 s11, s8, 61440
    buffer_load_dwordx4 v[100:103], v8, s[40:43], s11 offen sc1
    v_mfma_f32_32x32x16_bf16 v[64:79], a[160:163], v[148:151], v[64:79]
    s_add_u32 s11, s8, 63488
    buffer_load_dwordx4 v[108:111], v8, s[40:43], s11 offen sc1
    v_mfma_f32_32x32x16_bf16 v[48:63], a[164:167], v[144:147], v[48:63]
    s_waitcnt vmcnt(13)
    v_max_u32 v20, v152, v156
    v_cmp_eq_u32 vcc, -1, v20
    v_mfma_f32_32x32x16_bf16 v[32:47], a[160:163], v[144:147], v[32:47]
    s_cbranch_vccnz L_retry_g1_21_0
L_back_g1_21_0:
    v_mfma_f32_32x32x16_bf16 v[80:95], a[172:175], v[156:159], v[80:95]
    s_add_u32 s11, s8, 28672
    buffer_load_dwordx4 v[116:119], v8, s[40:43], s11 offen sc1
    v_mfma_f32_32x32x16_bf16 v[64:79], a[168:171], v[156:159], v[64:79]
    s_add_u32 s11, s8, 30720
    buffer_load_dwordx4 v[124:127], v8, s[40:43], s11 offen sc1
    v_mfma_f32_32x32x16_bf16 v[48:63], a[172:175], v[152:155], v[48:63]
    s_waitcnt vmcnt(13)
    v_max_u32 v20, v160, v164
    v_cmp_eq_u32 vcc, -1, v20
    v_mfma_f32_32x32x16_bf16 v[32:47], a[168:171], v[152:155], v[32:47]
    s_cbranch_vccnz L_retry_g1_22_0
L_back_g1_22_0:
    v_mfma_f32_32x32x16_bf16 v[80:95], a[180:183], v[164:167], v[80:95]
    s_add_u32 s11, s69, 24576
    buffer_load_dwordx4 v[192:195], v7, s[40:43], s11 offen sc1
    v_mfma_f32_32x32x16_bf16 v[64:79], a[176:179], v[164:167], v[64:79]
    s_add_u32 s11, s69, 26624
    buffer_load_dwordx4 v[200:203], v7, s[40:43], s11 offen sc1
    v_mfma_f32_32x32x16_bf16 v[48:63], a[180:183], v[160:163], v[48:63]
    s_waitcnt vmcnt(13)
    v_max_u32 v20, v168, v172
    v_cmp_eq_u32 vcc, -1, v20
    v_mfma_f32_32x32x16_bf16 v[32:47], a[176:179], v[160:163], v[32:47]
    s_cbranch_vccnz L_retry_g1_23_0
L_back_g1_23_0:
    v_mfma_f32_32x32x16_bf16 v[80:95], a[188:191], v[172:175], v[80:95]
    s_add_u32 s11, s8, 61440
    buffer_load_dwordx4 v[96:99], v7, s[40:43], s11 offen sc1
    v_mfma_f32_32x32x16_bf16 v[64:79], a[184:187], v[172:175], v[64:79]
    s_add_u32 s11, s8, 63488
    buffer_load_dwordx4 v[104:107], v7, s[40:43], s11 offen sc1
    v_mfma_f32_32x32x16_bf16 v[48:63], a[188:191], v[168:171], v[48:63]
    s_waitcnt vmcnt(13)
    v_max_u32 v20, v176, v180
    v_cmp_eq_u32 vcc, -1, v20
    v_mfma_f32_32x32x16_bf16 v[32:47], a[184:187], v[168:171], v[32:47]
    s_cbranch_vccnz L_retry_g1_24_0
L_back_g1_24_0:
    v_mfma_f32_32x32x16_bf16 v[80:95], a[196:199], v[180:183], v[80:95]
    s_add_u32 s11, s8, 28672
    buffer_load_dwordx4 v[112:115], v7, s[40:43], s11 offen sc1
    v_mfma_f32_32x32x16_bf16 v[64:79], a[192:195], v[180:183], v[64:79]
    s_add_u32 s11, s8, 30720
    buffer_load_dwordx4 v[120:123], v7, s[40:43], s11 offen sc1
    v_mfma_f32_32x32x16_bf16 v[48:63], a[196:199], v[176:179], v[48:63]
    s_waitcnt vmcnt(12)
    v_max_u32 v20, v184, v188
    v_cmp_eq_u32 vcc, -1, v20
    v_mfma_f32_32x32x16_bf16 v[32:47], a[192:195], v[176:179], v[32:47]
    s_cbranch_vccnz L_retry_g1_25_0
L_back_g1_25_0:
    v_mfma_f32_32x32x16_bf16 v[80:95], a[204:207], v[188:191], v[80:95]
    s_waitcnt lgkmcnt(0)
    s_add_u32 m0, s5, 0
    s_add_u32 s7, s67, 0
    buffer_load_dwordx4 v4, s[36:39], s7 offen lds
    v_mfma_f32_32x32x16_bf16 v[64:79], a[200:203], v[188:191], v[64:79]
    v_mfma_f32_32x32x16_bf16 v[48:63], a[204:207], v[184:187], v[48:63]
    s_waitcnt vmcnt(12)
    v_cmp_eq_u32 vcc, -1, v196
    v_mfma_f32_32x32x16_bf16 v[32:47], a[200:203], v[184:187], v[32:47]
    s_cbranch_vccnz L_retry_g1_26_1
L_back_g1_26_1:
    s_waitcnt vmcnt(15)
    v_cmp_ne_u32 vcc, s57, v21
    s_cbranch_vccz L_ok_65
    s_mov_b32 s4, 0
    s_mov_b32 exec_lo, 0xffffffff
    s_mov_b32 exec_hi, 0xffffffff
L_poll_66:
    buffer_load_dword v21, v19, s[40:43], s4 offen sc1
L_poll_66_chk:
    s_add_u32 s77, s77, 1
    s_waitcnt vmcnt(0)
    v_cmp_ne_u32 vcc, s57, v21
    s_cmp_ge_u32 s77, 50000
    s_cbranch_scc1 L_seen_67
    s_and_b64 exec, exec, vcc
    s_cbranch_scc1 L_poll_66
L_seen_67:
    s_mov_b64 exec, -1
L_ok_65:
    v_mfma_f32_32x32x16_bf16 v[80:95], a[212:215], v[196:199], v[80:95]
    s_add_u32 m0, s5, 1024
    s_add_u32 s7, s67, 32768
    buffer_load_dwordx4 v4, s[36:39], s7 offen lds
    s_waitcnt vmcnt(12)
    v_cmp_eq_u32 vcc, -1, v204
    v_mfma_f32_32x32x16_bf16 v[64:79], a[208:211], v[196:199], v[64:79]
    s_cbranch_vccnz L_retry_g1_27_1
L_back_g1_27_1:
    v_mfma_f32_32x32x16_bf16 v[80:95], a[220:223], v[204:207], v[80:95]
    s_add_u32 m0, s5, 2048
    s_add_u32 s7, s67, 65536
    buffer_load_dwordx4 v4, s[36:39], s7 offen lds
    s_waitcnt vmcnt(12)
    v_cmp_eq_u32 vcc, -1, v100
    v_mfma_f32_32x32x16_bf16 v[64:79], a[216:219], v[204:207], v[64:79]
    s_cbranch_vccnz L_retry_g1_28_1
L_back_g1_28_1:
    v_mfma_f32_32x32x16_bf16 v[80:95], a[228:231], v[100:103], v[80:95]
    s_add_u32 m0, s5, 3072
    s_add_u32 s7, s67, 98304
    buffer_load_dwordx4 v4, s[36:39], s7 offen lds
    s_waitcnt vmcnt(12)
    v_cmp_eq_u32 vcc, -1, v108
    v_mfma_f32_32x32x16_bf16 v[64:79], a[224:227], v[100:103], v[64:79]
    s_cbranch_vccnz L_retry_g1_29_1
L_back_g1_29_1:
    v_mfma_f32_32x32x16_bf16 v[80:95], a[236:239], v[108:111], v[80:95]
    s_add_u32 m0, s5, 4096
    s_add_u32 s7, s67, 131072
    buffer_load_dwordx4 v4, s[36:39], s7 offen lds
    s_waitcnt vmcnt(12)
    v_cmp_eq_u32 vcc, -1, v116
    v_mfma_f32_32x32x16_bf16 v[64:79], a[232:235], v[108:111], v[64:79]
    s_cbranch_vccnz L_retry_g1_30_1
L_back_g1_30_1:
    v_mfma_f32_32x32x16_bf16 v[80:95], a[244:247], v[116:119], v[80:95]
    s_add_u32 m0, s5, 5120
    s_add_u32 s7, s67, 163840
    buffer_load_dwordx4 v4, s[36:39], s7 offen lds
    s_waitcnt vmcnt(12)
    v_cmp_eq_u32 vcc, -1, v124
    v_mfma_f32_32x32x16_bf16 v[64:79], a[240:243], v[116:119], v[64:79]
    s_cbranch_vccnz L_retry_g1_31_1
L_back_g1_31_1:
    v_mfma_f32_32x32x16_bf16 v[80:95], a[252:255], v[124:127], v[80:95]
    s_add_u32 m0, s5, 6144
    s_add_u32 s7, s67, 196608
    buffer_load_dwordx4 v4, s[36:39], s7 offen lds
    s_waitcnt vmcnt(12)
    v_cmp_eq_u32 vcc, -1, v192
    v_mfma_f32_32x32x16_bf16 v[64:79], a[248:251], v[124:127], v[64:79]
    s_cbranch_vccnz L_retry_g1_26_0
L_back_g1_26_0:
    v_mfma_f32_32x32x16_bf16 v[48:63], a[212:215], v[192:195], v[48:63]
    s_nop 3
    ds_write_b128 v12, v[80:83] offset:6144
    ds_write_b128 v12, v[84:87] offset:7168
    ds_write_b128 v12, v[88:91] offset:8192
    ds_write_b128 v12, v[92:95] offset:9216
    s_waitcnt vmcnt(11)
    v_cmp_eq_u32 vcc, -1, v200
    v_mfma_f32_32x32x16_bf16 v[32:47], a[208:211], v[192:195], v[32:47]
    ds_write_b128 v12, v[72:75] offset:10240
    ds_write_b128 v12, v[76:79] offset:11264
    s_add_u32 m0, s5, 7168
    s_add_u32 s7, s67, 229376
    buffer_load_dwordx4 v4, s[36:39], s7 offen lds
    s_cbranch_vccnz L_retry_g1_27_0
L_back_g1_27_0:
    v_mfma_f32_32x32x16_bf16 v[48:63], a[220:223], v[200:203], v[48:63]
    s_waitcnt lgkmcnt(0)
    s_barrier
    s_waitcnt vmcnt(11)
    v_cmp_eq_u32 vcc, -1, v96
    v_mfma_f32_32x32x16_bf16 v[32:47], a[216:219], v[200:203], v[32:47]
    ds_read_b128 v[216:219], v9 offset:6144
    ds_read_b128 v[220:223], v9 offset:7168
    ds_read_b128 v[224:227], v10 offset:6144
    s_add_u32 m0, s5, 8192
    s_add_u32 s7, s67, 262144
    buffer_load_dwordx4 v4, s[36:39], s7 offen lds
    s_cbranch_vccnz L_retry_g1_28_0
L_back_g1_28_0:
    v_mfma_f32_32x32x16_bf16 v[48:63], a[228:231], v[96:99], v[48:63]
    ds_read_b128 v[228:231], v10 offset:7168
    ds_read_b128 v[232:235], v11 offset:6144
    ds_read_b128 v[236:239], v11 offset:7168
    s_waitcnt lgkmcnt(4)
    v_add_f32 v64, v64, v216
    s_waitcnt vmcnt(11)
    v_cmp_eq_u32 vcc, -1, v104
    v_mfma_f32_32x32x16_bf16 v[32:47], a[224:227], v[96:99], v[32:47]
    v_add_f32 v65, v65, v217
    v_add_f32 v66, v66, v218
    v_add_f32 v67, v67, v219
    s_add_u32 m0, s5, 9216
    s_add_u32 s7, s67, 294912
    buffer_load_dwordx4 v4, s[36:39], s7 offen lds
    s_cbranch_vccnz L_retry_g1_29_0
L_back_g1_29_0:
    v_mfma_f32_32x32x16_bf16 v[48:63], a[236:239], v[104:107], v[48:63]
    v_add_f32 v68, v68, v220
    v_add_f32 v69, v69, v221
    v_add_f32 v70, v70, v222
    v_add_f32 v71, v71, v223
    s_waitcnt vmcnt(11)
    v_cmp_eq_u32 vcc, -1, v112
    v_mfma_f32_32x32x16_bf16 v[32:47], a[232:235], v[104:107], v[32:47]
    s_waitcnt lgkmcnt(2)
    v_add_f32 v64, v64, v224
    v_add_f32 v65, v65, v225
    v_add_f32 v66, v66, v226
    s_cbranch_vccnz L_retry_g1_30_0
L_back_g1_30_0:
    v_mfma_f32_32x32x16_bf16 v[48:63], a[244:247], v[112:115], v[48:63]
    v_add_f32 v67, v67, v227
    v_add_f32 v68, v68, v228
    v_add_f32 v69, v69, v229
    v_add_f32 v70, v70, v230
    s_waitcnt vmcnt(10)
    v_cmp_eq_u32 vcc, -1, v120
    v_mfma_f32_32x32x16_bf16 v[32:47], a[240:243], v[112:115], v[32:47]
    v_add_f32 v71, v71, v231
    s_waitcnt lgkmcnt(0)
    v_add_f32 v64, v64, v232
    v_add_f32 v65, v65, v233
    s_cbranch_vccnz L_retry_g1_31_0
L_back_g1_31_0:
    v_mfma_f32_32x32x16_bf16 v[48:63], a[252:255], v[120:123], v[48:63]
    v_add_f32 v66, v66, v234
    v_add_f32 v67, v67, v235
    v_add_f32 v68, v68, v236
    v_mfma_f32_32x32x16_bf16 v[32:47], a[248:251], v[120:123], v[32:47]
    v_add_f32 v69, v69, v237
    v_add_f32 v70, v70, v238
    v_add_f32 v71, v71, v239
    s_nop 4
    ds_write_b128 v12, v[48:51] offset:0
    ds_write_b128 v12, v[52:55] offset:1024
    ds_write_b128 v12, v[56:59] offset:2048
    ds_write_b128 v12, v[60:63] offset:3072
    ds_write_b128 v12, v[40:43] offset:4096
    ds_write_b128 v12, v[44:47] offset:5120
    v_pk_mul_f32 v[240:241], v[64:65], v[64:65]
    s_add_u32 m0, s5, 10240
    s_add_u32 s7, s67, 327680
    buffer_load_dwordx4 v4, s[36:39], s7 offen lds
    v_pk_mul_f32 v[242:243], v[66:67], v[66:67]
    v_pk_mul_f32 v[244:245], v[68:69], v[68:69]
    v_pk_mul_f32 v[246:247], v[70:71], v[70:71]
    v_pk_fma_f32 v[240:241], v[240:241], s[18:19], v[22:23]
    v_pk_fma_f32 v[242:243], v[242:243], s[18:19], v[22:23]
    v_pk_fma_f32 v[244:245], v[244:245], s[18:19], v[22:23]
    v_pk_fma_f32 v[246:247], v[246:247], s[18:19], v[22:23]
    v_pk_mul_f32 v[240:241], v[240:241], v[64:65]
    v_pk_mul_f32 v[242:243], v[242:243], v[66:67]
    v_pk_mul_f32 v[244:245], v[244:245], v[68:69]
    v_pk_mul_f32 v[246:247], v[246:247], v[70:71]
    v_exp_f32 v240, v240
    v_exp_f32 v241, v241
    s_add_u32 m0, s5, 11264
    s_add_u32 s7, s67, 360448
    buffer_load_dwordx4 v4, s[36:39], s7 offen lds
    v_exp_f32 v242, v242
    v_exp_f32 v243, v243
    v_exp_f32 v244, v244
    v_exp_f32 v245, v245
    v_exp_f32 v246, v246
    v_exp_f32 v247, v247
    v_pk_add_f32 v[240:241], v[240:241], 1.0 op_sel_hi:[1,0]
    v_pk_add_f32 v[242:243], v[242:243], 1.0 op_sel_hi:[1,0]
    v_pk_add_f32 v[244:245], v[244:245], 1.0 op_sel_hi:[1,0]
    v_pk_add_f32 v[246:247], v[246:247], 1.0 op_sel_hi:[1,0]
    v_rcp_f32 v240, v240
    v_rcp_f32 v241, v241
    v_rcp_f32 v242, v242
    s_add_u32 m0, s5, 12288
    s_add_u32 s7, s67, 393216
    buffer_load_dwordx4 v4, s[36:39], s7 offen lds
    v_rcp_f32 v243, v243
    v_rcp_f32 v244, v244
    v_rcp_f32 v245, v245
    v_rcp_f32 v246, v246
    v_rcp_f32 v247, v247
    v_pk_mul_f32 v[240:241], v[240:241], v[64:65]
    v_pk_mul_f32 v[242:243], v[242:243], v[66:67]
    v_pk_mul_f32 v[244:245], v[244:245], v[68:69]
    v_pk_mul_f32 v[246:247], v[246:247], v[70:71]
    v_cvt_pk_bf16_f32 v248, v240, v241
    v_cvt_pk_bf16_f32 v249, v242, v243
    v_cvt_pk_bf16_f32 v250, v244, v245
    v_cvt_pk_bf16_f32 v251, v246, v247
    buffer_store_dwordx4 v[248:251], v252, s[40:43], s70 offen offset:1024 sc1
    s_waitcnt lgkmcnt(0)
    s_barrier
    ds_read_b128 v[216:219], v9 offset:0
    s_add_u32 m0, s5, 13312
    s_add_u32 s7, s67, 425984
    buffer_load_dwordx4 v4, s[36:39], s7 offen lds
    ds_read_b128 v[220:223], v9 offset:1024
    ds_read_b128 v[224:227], v10 offset:0
    s_add_u32 m0, s5, 14336
    s_add_u32 s7, s67, 458752
    buffer_load_dwordx4 v4, s[36:39], s7 offen lds
    ds_read_b128 v[228:231], v10 offset:1024
    ds_read_b128 v[232:235], v11 offset:0
    s_add_u32 m0, s5, 15360
    s_add_u32 s7, s67, 491520
    buffer_load_dwordx4 v4, s[36:39], s7 offen lds
    ds_read_b128 v[236:239], v11 offset:1024
    s_waitcnt lgkmcnt(4)
    v_pk_add_f32 v[32:33], v[32:33], v[216:217]
    v_pk_add_f32 v[34:35], v[34:35], v[218:219]
    v_pk_add_f32 v[36:37], v[36:37], v[220:221]
    v_pk_add_f32 v[38:39], v[38:39], v[222:223]
    s_waitcnt lgkmcnt(2)
    v_pk_add_f32 v[32:33], v[32:33], v[224:225]
    v_pk_add_f32 v[34:35], v[34:35], v[226:227]
    v_pk_add_f32 v[36:37], v[36:37], v[228:229]
    v_pk_add_f32 v[38:39], v[38:39], v[230:231]
    s_waitcnt lgkmcnt(0)
    v_pk_add_f32 v[32:33], v[32:33], v[232:233]
    v_pk_add_f32 v[34:35], v[34:35], v[234:235]
    v_pk_add_f32 v[36:37], v[36:37], v[236:237]
    v_pk_add_f32 v[38:39], v[38:39], v[238:239]
    v_pk_mul_f32 v[240:241], v[32:33], v[32:33]
    v_pk_mul_f32 v[242:243], v[34:35], v[34:35]
    v_pk_mul_f32 v[244:245], v[36:37], v[36:37]
    v_pk_mul_f32 v[246:247], v[38:39], v[38:39]
    v_pk_fma_f32 v[240:241], v[240:241], s[18:19], v[22:23]
    v_pk_fma_f32 v[242:243], v[242:243], s[18:19], v[22:23]
    v_pk_fma_f32 v[244:245], v[244:245], s[18:19], v[22:23]
    v_pk_fma_f32 v[246:247], v[246:247], s[18:19], v[22:23]
    v_pk_mul_f32 v[240:241], v[240:241], v[32:33]
    v_pk_mul_f32 v[242:243], v[242:243], v[34:35]
    v_pk_mul_f32 v[244:245], v[244:245], v[36:37]
    v_pk_mul_f32 v[246:247], v[246:247], v[38:39]
    v_exp_f32 v240, v240
    v_exp_f32 v241, v241
    v_exp_f32 v242, v242
    v_exp_f32 v243, v243
    v_exp_f32 v244, v244
    v_exp_f32 v245, v245
    v_exp_f32 v246, v246
    v_exp_f32 v247, v247
    v_pk_add_f32 v[240:241], v[240:241], 1.0 op_sel_hi:[1,0]
    v_pk_add_f32 v[242:243], v[242:243], 1.0 op_sel_hi:[1,0]
    v_pk_add_f32 v[244:245], v[244:245], 1.0 op_sel_hi:[1,0]
    v_pk_add_f32 v[246:247], v[246:247], 1.0 op_sel_hi:[1,0]
    v_rcp_f32 v240, v240
    v_rcp_f32 v241, v241
    v_rcp_f32 v242, v242
    v_rcp_f32 v243, v243
    v_rcp_f32 v244, v244
    v_rcp_f32 v245, v245
    v_rcp_f32 v246, v246
    v_rcp_f32 v247, v247
    v_pk_mul_f32 v[240:241], v[240:241], v[32:33]
    v_pk_mul_f32 v[242:243], v[242:243], v[34:35]
    v_pk_mul_f32 v[244:245], v[244:245], v[36:37]
    v_pk_mul_f32 v[246:247], v[246:247], v[38:39]
    v_cvt_pk_bf16_f32 v248, v240, v241
    v_cvt_pk_bf16_f32 v249, v242, v243
    v_cvt_pk_bf16_f32 v250, v244, v245
    v_cvt_pk_bf16_f32 v251, v246, v247
    buffer_store_dwordx4 v[248:251], v252, s[40:43], s70 offen offset:0 sc1
    s_lshl_b32 s14, s10, 11
    s_mul_i32 s11, s65, 262144
    s_add_u32 s14, s14, s11
    s_add_u32 s14, s14, 2883584
    s_mul_i32 s12, s56, 12288
    s_add_u32 s12, s12, 6144
    s_add_u32 m0, s12, 0
    s_add_u32 s11, s14, 0
    buffer_load_dwordx4 v252, s[40:43], s11 offen sc1 lds
    s_add_u32 m0, s12, 1024
    s_add_u32 s11, s14, 2048
    buffer_load_dwordx4 v252, s[40:43], s11 offen sc1 lds
    s_add_u32 m0, s12, 2048
    s_add_u32 s11, s14, 1024
    buffer_load_dwordx4 v252, s[40:43], s11 offen sc1 lds
    s_add_u32 m0, s12, 3072
    s_add_u32 s11, s14, 3072
    buffer_load_dwordx4 v252, s[40:43], s11 offen sc1 lds
    v_and_b32 v13, 31, v1
    v_lshlrev_b32 v24, 1, v13
    s_lshl_b32 s11, s10, 5
    buffer_load_ushort v16, v24, s[52:55], s11 offen
    v_lshrrev_b32 v25, 4, v13
    v_and_b32 v13, 15, v1
    v_lshlrev_b32 v13, 2, v13
    v_lshl_add_u32 v13, v25, 7, v13
    s_lshl_b32 s11, s10, 7
    s_add_u32 s11, s11, 131072
    buffer_load_dword v14, v13, s[40:43], s11 offen sc1
    buffer_load_dword v15, v13, s[40:43], s11 offen offset:64 sc1
    s_add_u32 m0, s5, 16384
    s_add_u32 s7, s67, 524288
    buffer_load_dwordx4 v4, s[36:39], s7 offen lds
    s_add_u32 m0, s5, 17408
    s_add_u32 s7, s67, 557056
    buffer_load_dwordx4 v4, s[36:39], s7 offen lds
    s_add_u32 m0, s5, 18432
    s_add_u32 s7, s67, 589824
    buffer_load_dwordx4 v4, s[36:39], s7 offen lds
    s_add_u32 m0, s5, 19456
    s_add_u32 s7, s67, 622592
    buffer_load_dwordx4 v4, s[36:39], s7 offen lds
    s_add_u32 m0, s5, 20480
    s_add_u32 s7, s67, 655360
    buffer_load_dwordx4 v4, s[36:39], s7 offen lds
    s_add_u32 m0, s5, 21504
    s_add_u32 s7, s67, 688128
    buffer_load_dwordx4 v4, s[36:39], s7 offen lds
    s_add_u32 m0, s5, 22528
    s_add_u32 s7, s67, 720896
    buffer_load_dwordx4 v4, s[36:39], s7 offen lds
    s_add_u32 m0, s5, 23552
    s_add_u32 s7, s67, 753664
    buffer_load_dwordx4 v4, s[36:39], s7 offen lds
    s_add_u32 m0, s5, 24576
    s_add_u32 s7, s67, 786432
    buffer_load_dwordx4 v4, s[36:39], s7 offen lds
    s_add_u32 m0, s5, 25600
    s_add_u32 s7, s67, 819200
    buffer_load_dwordx4 v4, s[36:39], s7 offen lds
    s_add_u32 m0, s5, 26624
    s_add_u32 s7, s67, 851968
    buffer_load_dwordx4 v4, s[36:39], s7 offen lds
    s_add_u32 m0, s5, 27648
    s_add_u32 s7, s67, 884736
    buffer_load_dwordx4 v4, s[36:39], s7 offen lds
    s_branch L_g2
L_g2_only:
    s_cmp_eq_u32 s64, -1
    s_cbranch_scc1 L_done
    v_lshrrev_b32 v18, 3, v1
    v_and_b32 v19, 7, v1
    v_bfe_u32 v20, v1, 4, 1
    v_lshlrev_b32 v20, 2, v20
    v_xor_b32 v19, v19, v20
    v_mul_u32_u24 v18, 4096, v18
    v_lshl_add_u32 v4, v19, 4, v18
    v_and_b32 v18, 15, v1
    v_lshrrev_b32 v19, 2, v18
    v_lshrrev_b32 v20, 5, v1
    v_lshl_add_u32 v19, v20, 2, v19
    v_bfe_u32 v20, v18, 3, 1
    s_and_b32 s4, s56, 1
    v_xor_b32 v20, s4, v20
    v_lshlrev_b32 v20, 6, v20
    v_lshl_add_u32 v20, v19, 7, v20
    v_bfe_u32 v19, v1, 4, 1
    v_lshl_add_u32 v20, v19, 5, v20
    v_and_b32 v19, 3, v1
    v_lshl_add_u32 v20, v19, 3, v20
    s_mul_i32 s5, s56, 28672
    s_add_u32 s5, s5, 49152
    v_xor_b32 v19, 64, v20
    v_add_u32 v5, s5, v20
    v_add_u32 v6, s5, v19
    s_mul_i32 s6, s56, 1835008
    s_lshl_b32 s7, s64, 7
    s_add_u32 s6, s6, s7
    s_mov_b32 s66, s6
    s_add_u32 s67, s6, 917504
    s_add_u32 m0, s5, 0
    s_add_u32 s7, s66, 0
    buffer_load_dwordx4 v4, s[36:39], s7 offen lds
    s_add_u32 m0, s5, 1024
    s_add_u32 s7, s66, 32768
    buffer_load_dwordx4 v4, s[36:39], s7 offen lds
    s_add_u32 m0, s5, 2048
    s_add_u32 s7, s66, 65536
    buffer_load_dwordx4 v4, s[36:39], s7 offen lds
    s_add_u32 m0, s5, 3072
    s_add_u32 s7, s66, 98304
    buffer_load_dwordx4 v4, s[36:39], s7 offen lds
    s_add_u32 m0, s5, 4096
    s_add_u32 s7, s66, 131072
    buffer_load_dwordx4 v4, s[36:39], s7 offen lds
    s_add_u32 m0, s5, 5120
    s_add_u32 s7, s66, 163840
    buffer_load_dwordx4 v4, s[36:39], s7 offen lds
    s_add_u32 m0, s5, 6144
    s_add_u32 s7, s66, 196608
    buffer_load_dwordx4 v4, s[36:39], s7 offen lds
    s_add_u32 m0, s5, 7168
    s_add_u32 s7, s66, 229376
    buffer_load_dwordx4 v4, s[36:39], s7 offen lds
    s_add_u32 m0, s5, 8192
    s_add_u32 s7, s66, 262144
    buffer_load_dwordx4 v4, s[36:39], s7 offen lds
    s_add_u32 m0, s5, 9216
    s_add_u32 s7, s66, 294912
    buffer_load_dwordx4 v4, s[36:39], s7 offen lds
    s_add_u32 m0, s5, 10240
    s_add_u32 s7, s66, 327680
    buffer_load_dwordx4 v4, s[36:39], s7 offen lds
    s_add_u32 m0, s5, 11264
    s_add_u32 s7, s66, 360448
    buffer_load_dwordx4 v4, s[36:39], s7 offen lds
    s_add_u32 m0, s5, 12288
    s_add_u32 s7, s66, 393216
    buffer_load_dwordx4 v4, s[36:39], s7 offen lds
    s_add_u32 m0, s5, 13312
    s_add_u32 s7, s66, 425984
    buffer_load_dwordx4 v4, s[36:39], s7 offen lds
    s_add_u32 m0, s5, 14336
    s_add_u32 s7, s66, 458752
    buffer_load_dwordx4 v4, s[36:39], s7 offen lds
    s_add_u32 m0, s5, 15360
    s_add_u32 s7, s66, 491520
    buffer_load_dwordx4 v4, s[36:39], s7 offen lds
    s_add_u32 m0, s5, 16384
    s_add_u32 s7, s66, 524288
    buffer_load_dwordx4 v4, s[36:39], s7 offen lds
    s_add_u32 m0, s5, 17408
    s_add_u32 s7, s66, 557056
    buffer_load_dwordx4 v4, s[36:39], s7 offen lds
    s_add_u32 m0, s5, 18432
    s_add_u32 s7, s66, 589824
    buffer_load_dwordx4 v4, s[36:39], s7 offen lds
    s_add_u32 m0, s5, 19456
    s_add_u32 s7, s66, 622592
    buffer_load_dwordx4 v4, s[36:39], s7 offen lds
    s_add_u32 m0, s5, 20480
    s_add_u32 s7, s66, 655360
    buffer_load_dwordx4 v4, s[36:39], s7 offen lds
    s_add_u32 m0, s5, 21504
    s_add_u32 s7, s66, 688128
    buffer_load_dwordx4 v4, s[36:39], s7 offen lds
    s_add_u32 m0, s5, 22528
    s_add_u32 s7, s66, 720896
    buffer_load_dwordx4 v4, s[36:39], s7 offen lds
    s_add_u32 m0, s5, 23552
    s_add_u32 s7, s66, 753664
    buffer_load_dwordx4 v4, s[36:39], s7 offen lds
    s_add_u32 m0, s5, 24576
    s_add_u32 s7, s66, 786432
    buffer_load_dwordx4 v4, s[36:39], s7 offen lds
    s_add_u32 m0, s5, 25600
    s_add_u32 s7, s66, 819200
    buffer_load_dwordx4 v4, s[36:39], s7 offen lds
    s_add_u32 m0, s5, 26624
    s_add_u32 s7, s66, 851968
    buffer_load_dwordx4 v4, s[36:39], s7 offen lds
    s_add_u32 m0, s5, 27648
    s_add_u32 s7, s66, 884736
    buffer_load_dwordx4 v4, s[36:39], s7 offen lds
    s_waitcnt vmcnt(26)
    ds_read_b64_tr_b16 a[0:1], v5 offset:0
    ds_read_b64_tr_b16 a[2:3], v5 offset:1024
    ds_read_b64_tr_b16 a[4:5], v6 offset:0
    ds_read_b64_tr_b16 a[6:7], v6 offset:1024
    s_waitcnt vmcnt(24)
    ds_read_b64_tr_b16 a[8:9], v5 offset:2048
    ds_read_b64_tr_b16 a[10:11], v5 offset:3072
    ds_read_b64_tr_b16 a[12:13], v6 offset:2048
    ds_read_b64_tr_b16 a[14:15], v6 offset:3072
    s_waitcnt lgkmcnt(4)
    s_add_u32 m0, s5, 0
    s_add_u32 s7, s67, 0
    buffer_load_dwordx4 v4, s[36:39], s7 offen lds
    s_add_u32 m0, s5, 1024
    s_add_u32 s7, s67, 32768
    buffer_load_dwordx4 v4, s[36:39], s7 offen lds
    s_waitcnt vmcnt(24)
    ds_read_b64_tr_b16 a[16:17], v5 offset:4096
    ds_read_b64_tr_b16 a[18:19], v5 offset:5120
    ds_read_b64_tr_b16 a[20:21], v6 offset:4096
    ds_read_b64_tr_b16 a[22:23], v6 offset:5120
    s_waitcnt lgkmcnt(4)
    s_add_u32 m0, s5, 2048
    s_add_u32 s7, s67, 65536
    buffer_load_dwordx4 v4, s[36:39], s7 offen lds
    s_add_u32 m0, s5, 3072
    s_add_u32 s7, s67, 98304
    buffer_load_dwordx4 v4, s[36:39], s7 offen lds
    s_waitcnt vmcnt(24)
    ds_read_b64_tr_b16 a[24:25], v5 offset:6144
    ds_read_b64_tr_b16 a[26:27], v5 offset:7168
    ds_read_b64_tr_b16 a[28:29], v6 offset:6144
    ds_read_b64_tr_b16 a[30:31], v6 offset:7168
    s_waitcnt lgkmcnt(4)
    s_add_u32 m0, s5, 4096
    s_add_u32 s7, s67, 131072
    buffer_load_dwordx4 v4, s[36:39], s7 offen lds
    s_add_u32 m0, s5, 5120
    s_add_u32 s7, s67, 163840
    buffer_load_dwordx4 v4, s[36:39], s7 offen lds
    s_waitcnt vmcnt(24)
    ds_read_b64_tr_b16 a[32:33], v5 offset:8192
    ds_read_b64_tr_b16 a[34:35], v5 offset:9216
    ds_read_b64_tr_b16 a[36:37], v6 offset:8192
    ds_read_b64_tr_b16 a[38:39], v6 offset:9216
    s_waitcnt lgkmcnt(4)
    s_add_u32 m0, s5, 6144
    s_add_u32 s7, s67, 196608
    buffer_load_dwordx4 v4, s[36:39], s7 offen lds
    s_add_u32 m0, s5, 7168
    s_add_u32 s7, s67, 229376
    buffer_load_dwordx4 v4, s[36:39], s7 offen lds
    s_waitcnt vmcnt(24)
    ds_read_b64_tr_b16 a[40:41], v5 offset:10240
    ds_read_b64_tr_b16 a[42:43], v5 offset:11264
    ds_read_b64_tr_b16 a[44:45], v6 offset:10240
    ds_read_b64_tr_b16 a[46:47], v6 offset:11264
    s_waitcnt lgkmcnt(4)
    s_add_u32 m0, s5, 8192
    s_add_u32 s7, s67, 262144
    buffer_load_dwordx4 v4, s[36:39], s7 offen lds
    s_add_u32 m0, s5, 9216
    s_add_u32 s7, s67, 294912
    buffer_load_dwordx4 v4, s[36:39], s7 offen lds
    s_waitcnt vmcnt(24)
    ds_read_b64_tr_b16 a[48:49], v5 offset:12288
    ds_read_b64_tr_b16 a[50:51], v5 offset:13312
    ds_read_b64_tr_b16 a[52:53], v6 offset:12288
    ds_read_b64_tr_b16 a[54:55], v6 offset:13312
    s_waitcnt lgkmcnt(4)
    s_add_u32 m0, s5, 10240
    s_add_u32 s7, s67, 327680
    buffer_load_dwordx4 v4, s[36:39], s7 offen lds
    s_add_u32 m0, s5, 11264
    s_add_u32 s7, s67, 360448
    buffer_load_dwordx4 v4, s[36:39], s7 offen lds
    s_waitcnt vmcnt(24)
    ds_read_b64_tr_b16 a[56:57], v5 offset:14336
    ds_read_b64_tr_b16 a[58:59], v5 offset:15360
    ds_read_b64_tr_b16 a[60:61], v6 offset:14336
    ds_read_b64_tr_b16 a[62:63], v6 offset:15360
    s_waitcnt lgkmcnt(4)
    s_add_u32 m0, s5, 12288
    s_add_u32 s7, s67, 393216
    buffer_load_dwordx4 v4, s[36:39], s7 offen lds
    s_add_u32 m0, s5, 13312
    s_add_u32 s7, s67, 425984
    buffer_load_dwordx4 v4, s[36:39], s7 offen lds
    s_waitcnt vmcnt(24)
    ds_read_b64_tr_b16 a[64:65], v5 offset:16384
    ds_read_b64_tr_b16 a[66:67], v5 offset:17408
    ds_read_b64_tr_b16 a[68:69], v6 offset:16384
    ds_read_b64_tr_b16 a[70:71], v6 offset:17408
    s_waitcnt lgkmcnt(4)
    s_add_u32 m0, s5, 14336
    s_add_u32 s7, s67, 458752
    buffer_load_dwordx4 v4, s[36:39], s7 offen lds
    s_add_u32 m0, s5, 15360
    s_add_u32 s7, s67, 491520
    buffer_load_dwordx4 v4, s[36:39], s7 offen lds
    s_waitcnt vmcnt(24)
    ds_read_b64_tr_b16 a[72:73], v5 offset:18432
    ds_read_b64_tr_b16 a[74:75], v5 offset:19456
    ds_read_b64_tr_b16 a[76:77], v6 offset:18432
    ds_read_b64_tr_b16 a[78:79], v6 offset:19456
    s_waitcnt lgkmcnt(4)
    s_add_u32 m0, s5, 16384
    s_add_u32 s7, s67, 524288
    buffer_load_dwordx4 v4, s[36:39], s7 offen lds
    s_add_u32 m0, s5, 17408
    s_add_u32 s7, s67, 557056
    buffer_load_dwordx4 v4, s[36:39], s7 offen lds
    s_waitcnt vmcnt(24)
    ds_read_b64_tr_b16 a[80:81], v5 offset:20480
    ds_read_b64_tr_b16 a[82:83], v5 offset:21504
    ds_read_b64_tr_b16 a[84:85], v6 offset:20480
    ds_read_b64_tr_b16 a[86:87], v6 offset:21504
    s_waitcnt lgkmcnt(4)
    s_add_u32 m0, s5, 18432
    s_add_u32 s7, s67, 589824
    buffer_load_dwordx4 v4, s[36:39], s7 offen lds
    s_add_u32 m0, s5, 19456
    s_add_u32 s7, s67, 622592
    buffer_load_dwordx4 v4, s[36:39], s7 offen lds
    s_waitcnt vmcnt(24)
    ds_read_b64_tr_b16 a[88:89], v5 offset:22528
    ds_read_b64_tr_b16 a[90:91], v5 offset:23552
    ds_read_b64_tr_b16 a[92:93], v6 offset:22528
    ds_read_b64_tr_b16 a[94:95], v6 offset:23552
    s_waitcnt lgkmcnt(4)
    s_add_u32 m0, s5, 20480
    s_add_u32 s7, s67, 655360
    buffer_load_dwordx4 v4, s[36:39], s7 offen lds
    s_add_u32 m0, s5, 21504
    s_add_u32 s7, s67, 688128
    buffer_load_dwordx4 v4, s[36:39], s7 offen lds
    s_waitcnt vmcnt(24)
    ds_read_b64_tr_b16 a[96:97], v5 offset:24576
    ds_read_b64_tr_b16 a[98:99], v5 offset:25600
    ds_read_b64_tr_b16 a[100:101], v6 offset:24576
    ds_read_b64_tr_b16 a[102:103], v6 offset:25600
    s_waitcnt lgkmcnt(4)
    s_add_u32 m0, s5, 22528
    s_add_u32 s7, s67, 720896
    buffer_load_dwordx4 v4, s[36:39], s7 offen lds
    s_add_u32 m0, s5, 23552
    s_add_u32 s7, s67, 753664
    buffer_load_dwordx4 v4, s[36:39], s7 offen lds
    s_waitcnt vmcnt(24)
    ds_read_b64_tr_b16 a[104:105], v5 offset:26624
    ds_read_b64_tr_b16 a[106:107], v5 offset:27648
    ds_read_b64_tr_b16 a[108:109], v6 offset:26624
    ds_read_b64_tr_b16 a[110:111], v6 offset:27648
    s_waitcnt lgkmcnt(4)
    s_add_u32 m0, s5, 24576
    s_add_u32 s7, s67, 786432
    buffer_load_dwordx4 v4, s[36:39], s7 offen lds
    s_add_u32 m0, s5, 25600
    s_add_u32 s7, s67, 819200
    buffer_load_dwordx4 v4, s[36:39], s7 offen lds
    s_waitcnt lgkmcnt(0)
    s_lshl_b32 s10, s64, 2
    s_and_b32 s11, s56, 1
    s_lshl_b32 s11, s11, 1
    s_add_u32 s10, s10, s11
    v_lshlrev_b32 v19, 7, v1
    s_lshl_b32 s9, s10, 7
    s_add_u32 s9, s9, 32768
    s_mov_b32 exec_lo, 0x3
    s_mov_b32 exec_hi, 0x0
L_poll_68:
    buffer_load_dword v20, v19, s[40:43], s9 offen sc1
L_poll_68_chk:
    s_add_u32 s77, s77, 1
    s_waitcnt vmcnt(0)
    v_cmp_ne_u32 vcc, s57, v20
    s_cmp_ge_u32 s77, 50000
    s_cbranch_scc1 L_seen_69
    s_and_b64 exec, exec, vcc
    s_cbranch_scc1 L_poll_68
L_seen_69:
    s_mov_b64 exec, -1
    s_mov_b32 s9, 4096
    s_mov_b32 exec_lo, 0xff7fff7f
    s_mov_b32 exec_hi, 0xff7fff7f
L_poll_70:
    buffer_load_dword v20, v19, s[40:43], s9 offen sc1
L_poll_70_chk:
    s_add_u32 s77, s77, 1
    s_waitcnt vmcnt(0)
    v_cmp_ne_u32 vcc, s57, v20
    s_cmp_ge_u32 s77, 50000
    s_cbranch_scc1 L_seen_71
    s_and_b64 exec, exec, vcc
    s_cbranch_scc1 L_poll_70
L_seen_71:
    s_mov_b64 exec, -1
    v_lshlrev_b32 v252, 4, v1
    s_xor_b32 s9, s56, 1
    s_mul_i32 s9, s9, 12288
    s_add_u32 s9, s9, 0
    v_add_u32 v9, s9, v252
    s_xor_b32 s9, s56, 3
    s_mul_i32 s9, s9, 12288
    s_add_u32 s9, s9, 2048
    v_add_u32 v10, s9, v252
    s_xor_b32 s9, s56, 2
    s_mul_i32 s9, s9, 12288
    s_add_u32 s9, s9, 4096
    v_add_u32 v11, s9, v252
    s_mul_i32 s9, s56, 12288
    v_add_u32 v12, s9, v252
    s_lshl_b32 s14, s10, 11
    s_mul_i32 s11, s65, 262144
    s_add_u32 s14, s14, s11
    s_add_u32 s14, s14, 2883584
    s_mul_i32 s12, s56, 12288
    s_add_u32 s12, s12, 6144
    s_add_u32 m0, s12, 0
    s_add_u32 s11, s14, 0
    buffer_load_dwordx4 v252, s[40:43], s11 offen sc1 lds
    s_add_u32 m0, s12, 1024
    s_add_u32 s11, s14, 2048
    buffer_load_dwordx4 v252, s[40:43], s11 offen sc1 lds
    s_add_u32 m0, s12, 2048
    s_add_u32 s11, s14, 1024
    buffer_load_dwordx4 v252, s[40:43], s11 offen sc1 lds
    s_add_u32 m0, s12, 3072
    s_add_u32 s11, s14, 3072
    buffer_load_dwordx4 v252, s[40:43], s11 offen sc1 lds
    v_and_b32 v13, 31, v1
    v_lshlrev_b32 v24, 1, v13
    s_lshl_b32 s11, s10, 5
    buffer_load_ushort v16, v24, s[52:55], s11 offen
    v_lshrrev_b32 v25, 4, v13
    v_and_b32 v13, 15, v1
    v_lshlrev_b32 v13, 2, v13
    v_lshl_add_u32 v13, v25, 7, v13
    s_lshl_b32 s11, s10, 7
    s_add_u32 s11, s11, 131072
    buffer_load_dword v14, v13, s[40:43], s11 offen sc1
    buffer_load_dword v15, v13, s[40:43], s11 offen offset:64 sc1
    s_add_u32 m0, s5, 26624
    s_add_u32 s7, s67, 851968
    buffer_load_dwordx4 v4, s[36:39], s7 offen lds
    s_add_u32 m0, s5, 27648
    s_add_u32 s7, s67, 884736
    buffer_load_dwordx4 v4, s[36:39], s7 offen lds
    s_mul_i32 s12, s56, 12288
    s_lshr_b32 s11, s56, 1
    s_lshl_b32 s11, s11, 8
    s_add_u32 s12, s12, s11
    s_add_u32 s12, s12, 6144
    v_bfe_u32 v17, v1, 4, 1
    v_lshlrev_b32 v17, 10, v17
    v_bfe_u32 v24, v1, 1, 1
    v_lshl_add_u32 v17, v24, 9, v17
    v_lshrrev_b32 v24, 5, v1
    v_bfe_u32 v25, v1, 2, 2
    v_lshl_add_u32 v24, v24, 2, v25
    v_lshl_add_u32 v17, v24, 4, v17
    v_and_b32 v24, 1, v1
    v_lshl_add_u32 v17, v24, 3, v17
    v_add_u32 v17, s12, v17
    v_and_b32 v18, 31, v1
    v_mul_u32_u24 v18, 896, v18
    v_lshrrev_b32 v24, 5, v1
    v_lshl_add_u32 v18, v24, 4, v18
    s_mul_i32 s15, s10, 14336
    s_lshl_b32 s11, s65, 7
    s_add_u32 s15, s15, s11
    s_lshr_b32 s11, s56, 1
    s_lshl_b32 s11, s11, 5
    s_add_u32 s15, s15, s11
L_g2:
    s_mul_i32 s8, s56, 57344
    s_mul_i32 s9, s65, 229376
    s_add_u32 s8, s8, s9
    s_add_u32 s8, s8, 4718592
    s_mov_b32 s68, s8
    s_add_u32 s69, s8, 28672
    v_lshlrev_b32 v19, 13, v1
    v_add_u32 v19, 0x1800, v19
    s_lshr_b32 s9, s56, 1
    s_lshl_b32 s9, s9, 8
    v_xor_b32 v7, s9, v252
    v_add_u32 v8, 0x400, v7
    s_mov_b64 exec, 9
    buffer_load_dword v20, v19, s[40:43], s8 offen sc1
    s_mov_b64 exec, -1
    s_waitcnt vmcnt(27)
    ds_read_b64_tr_b16 a[112:113], v5 offset:0
    ds_read_b64_tr_b16 a[114:115], v5 offset:1024
    ds_read_b64_tr_b16 a[116:117], v6 offset:0
    ds_read_b64_tr_b16 a[118:119], v6 offset:1024
    s_waitcnt vmcnt(25)
    ds_read_b64_tr_b16 a[120:121], v5 offset:2048
    ds_read_b64_tr_b16 a[122:123], v5 offset:3072
    ds_read_b64_tr_b16 a[124:125], v6 offset:2048
    ds_read_b64_tr_b16 a[126:127], v6 offset:3072
    s_waitcnt vmcnt(23)
    ds_read_b64_tr_b16 a[128:129], v5 offset:4096
    ds_read_b64_tr_b16 a[130:131], v5 offset:5120
    ds_read_b64_tr_b16 a[132:133], v6 offset:4096
    ds_read_b64_tr_b16 a[134:135], v6 offset:5120
    s_waitcnt vmcnt(21)
    ds_read_b64_tr_b16 a[136:137], v5 offset:6144
    ds_read_b64_tr_b16 a[138:139], v5 offset:7168
    ds_read_b64_tr_b16 a[140:141], v6 offset:6144
    ds_read_b64_tr_b16 a[142:143], v6 offset:7168
    s_waitcnt vmcnt(19)
    ds_read_b64_tr_b16 a[144:145], v5 offset:8192
    ds_read_b64_tr_b16 a[146:147], v5 offset:9216
    ds_read_b64_tr_b16 a[148:149], v6 offset:8192
    ds_read_b64_tr_b16 a[150:151], v6 offset:9216
    s_waitcnt vmcnt(17)
    ds_read_b64_tr_b16 a[152:153], v5 offset:10240
    ds_read_b64_tr_b16 a[154:155], v5 offset:11264
    ds_read_b64_tr_b16 a[156:157], v6 offset:10240
    ds_read_b64_tr_b16 a[158:159], v6 offset:11264
    s_waitcnt vmcnt(15)
    ds_read_b64_tr_b16 a[160:161], v5 offset:12288
    ds_read_b64_tr_b16 a[162:163], v5 offset:13312
    ds_read_b64_tr_b16 a[164:165], v6 offset:12288
    ds_read_b64_tr_b16 a[166:167], v6 offset:13312
    s_waitcnt vmcnt(13)
    ds_read_b64_tr_b16 a[168:169], v5 offset:14336
    ds_read_b64_tr_b16 a[170:171], v5 offset:15360
    ds_read_b64_tr_b16 a[172:173], v6 offset:14336
    ds_read_b64_tr_b16 a[174:175], v6 offset:15360
    s_waitcnt vmcnt(11)
    ds_read_b64_tr_b16 a[176:177], v5 offset:16384
    ds_read_b64_tr_b16 a[178:179], v5 offset:17408
    ds_read_b64_tr_b16 a[180:181], v6 offset:16384
    ds_read_b64_tr_b16 a[182:183], v6 offset:17408
    s_waitcnt vmcnt(9)
    ds_read_b64_tr_b16 a[184:185], v5 offset:18432
    ds_read_b64_tr_b16 a[186:187], v5 offset:19456
    ds_read_b64_tr_b16 a[188:189], v6 offset:18432
    ds_read_b64_tr_b16 a[190:191], v6 offset:19456
    s_waitcnt vmcnt(7)
    ds_read_b64_tr_b16 a[192:193], v5 offset:20480
    ds_read_b64_tr_b16 a[194:195], v5 offset:21504
    ds_read_b64_tr_b16 a[196:197], v6 offset:20480
    ds_read_b64_tr_b16 a[198:199], v6 offset:21504
    s_waitcnt vmcnt(5)
    ds_read_b64_tr_b16 a[200:201], v5 offset:22528
    ds_read_b64_tr_b16 a[202:203], v5 offset:23552
    ds_read_b64_tr_b16 a[204:205], v6 offset:22528
    ds_read_b64_tr_b16 a[206:207], v6 offset:23552
    s_waitcnt vmcnt(3)
    ds_read_b64_tr_b16 a[208:209], v5 offset:24576
    ds_read_b64_tr_b16 a[210:211], v5 offset:25600
    ds_read_b64_tr_b16 a[212:213], v6 offset:24576
    ds_read_b64_tr_b16 a[214:215], v6 offset:25600
    s_waitcnt vmcnt(1)
    ds_read_b64_tr_b16 a[216:217], v5 offset:26624
    ds_read_b64_tr_b16 a[218:219], v5 offset:27648
    ds_read_b64_tr_b16 a[220:221], v6 offset:26624
    ds_read_b64_tr_b16 a[222:223], v6 offset:27648
    s_waitcnt vmcnt(0)
    v_cmp_eq_u32 vcc, -1, v20
    s_and_b32 s16, vcc_lo, 9
    s_cbranch_scc0 L_ok_72
    s_mov_b32 exec_lo, 0x9
    s_mov_b32 exec_hi, 0x0
L_poll_73:
    buffer_load_dword v20, v19, s[40:43], s8 offen sc1
L_poll_73_chk:
    s_add_u32 s77, s77, 1
    s_waitcnt vmcnt(0)
    v_cmp_eq_u32 vcc, -1, v20
    s_cmp_ge_u32 s77, 50000
    s_cbranch_scc1 L_seen_74
    s_and_b64 exec, exec, vcc
    s_cbranch_scc1 L_poll_73
L_seen_74:
    s_mov_b64 exec, -1
L_ok_72:
    s_add_u32 s11, s68, 0
    buffer_load_dwordx4 v[96:99], v7, s[40:43], s11 offen sc1
    buffer_load_dwordx4 v[100:103], v8, s[40:43], s11 offen sc1
    ds_read_b64_tr_b16 v[24:25], v17 offset:0
    ds_read_b64_tr_b16 v[26:27], v17 offset:128
    ds_read_b64_tr_b16 v[28:29], v17 offset:2048
    ds_read_b64_tr_b16 v[30:31], v17 offset:2176
    s_add_u32 s11, s68, 2048
    buffer_load_dwordx4 v[104:107], v7, s[40:43], s11 offen sc1
    v_lshlrev_b32 v16, 16, v16
    v_add_f32 v14, v14, v16
    v_mov_b32 v40, 0
    v_mov_b32 v41, 0
    v_mov_b32 v42, 0
    buffer_load_dwordx4 v[108:111], v8, s[40:43], s11 offen sc1
    v_mov_b32 v43, 0
    v_mov_b32 v44, 0
    v_mov_b32 v45, 0
    v_mov_b32 v46, 0
    v_mov_b32 v47, 0
    s_add_u32 s11, s68, 4096
    buffer_load_dwordx4 v[112:115], v7, s[40:43], s11 offen sc1
    v_mov_b32 v72, 0
    v_mov_b32 v73, 0
    v_mov_b32 v74, 0
    v_mov_b32 v75, 0
    v_mov_b32 v76, 0
    buffer_load_dwordx4 v[116:119], v8, s[40:43], s11 offen sc1
    v_mov_b32 v77, 0
    v_mov_b32 v78, 0
    v_mov_b32 v79, 0
    s_waitcnt lgkmcnt(0)
    s_barrier
    s_add_u32 s11, s68, 6144
    buffer_load_dwordx4 v[120:123], v7, s[40:43], s11 offen sc1
    v_lshlrev_b32 v32, 16, v24
    v_and_b32 v33, 0xffff0000, v24
    v_lshlrev_b32 v34, 16, v25
    v_and_b32 v35, 0xffff0000, v25
    v_lshlrev_b32 v36, 16, v26
    buffer_load_dwordx4 v[124:127], v8, s[40:43], s11 offen sc1
    v_and_b32 v37, 0xffff0000, v26
    v_lshlrev_b32 v38, 16, v27
    v_and_b32 v39, 0xffff0000, v27
    v_lshlrev_b32 v64, 16, v28
    v_and_b32 v65, 0xffff0000, v28
    s_add_u32 s11, s68, 8192
    buffer_load_dwordx4 v[128:131], v7, s[40:43], s11 offen sc1
    v_lshlrev_b32 v66, 16, v29
    v_and_b32 v67, 0xffff0000, v29
    v_lshlrev_b32 v68, 16, v30
    v_and_b32 v69, 0xffff0000, v30
    v_lshlrev_b32 v70, 16, v31
    buffer_load_dwordx4 v[132:135], v8, s[40:43], s11 offen sc1
    v_and_b32 v71, 0xffff0000, v31
    v_pk_fma_f32 v[32:33], v[32:33], v[14:15], v[14:15] op_sel:[0,1,0] op_sel_hi:[1,1,0]
    v_pk_fma_f32 v[34:35], v[34:35], v[14:15], v[14:15] op_sel:[0,1,0] op_sel_hi:[1,1,0]
    v_pk_fma_f32 v[36:37], v[36:37], v[14:15], v[14:15] op_sel:[0,1,0] op_sel_hi:[1,1,0]
    v_pk_fma_f32 v[38:39], v[38:39], v[14:15], v[14:15] op_sel:[0,1,0] op_sel_hi:[1,1,0]
    s_add_u32 s11, s68, 10240
    buffer_load_dwordx4 v[136:139], v7, s[40:43], s11 offen sc1
    v_pk_fma_f32 v[64:65], v[64:65], v[14:15], v[14:15] op_sel:[0,1,0] op_sel_hi:[1,1,0]
    v_pk_fma_f32 v[66:67], v[66:67], v[14:15], v[14:15] op_sel:[0,1,0] op_sel_hi:[1,1,0]
    v_pk_fma_f32 v[68:69], v[68:69], v[14:15], v[14:15] op_sel:[0,1,0] op_sel_hi:[1,1,0]
    v_pk_fma_f32 v[70:71], v[70:71], v[14:15], v[14:15] op_sel:[0,1,0] op_sel_hi:[1,1,0]
    buffer_load_dwordx4 v[140:143], v8, s[40:43], s11 offen sc1
    s_waitcnt vmcnt(10)
    v_max_u32 v20, v96, v100
    v_cmp_eq_u32 vcc, -1, v20
    s_cbranch_vccnz L_retry_g2_0_0
L_back_g2_0_0:
    v_mfma_f32_32x32x16_bf16 v[80:95], v[100:103], a[4:7], 0
    s_add_u32 s11, s68, 12288
    buffer_load_dwordx4 v[144:147], v7, s[40:43], s11 offen sc1
    v_mfma_f32_32x32x16_bf16 v[64:79], v[100:103], a[0:3], v[64:79]
    buffer_load_dwordx4 v[148:151], v8, s[40:43], s11 offen sc1
    v_mfma_f32_32x32x16_bf16 v[48:63], v[96:99], a[4:7], 0
    s_waitcnt vmcnt(10)
    v_max_u32 v20, v104, v108
    v_cmp_eq_u32 vcc, -1, v20
    v_mfma_f32_32x32x16_bf16 v[32:47], v[96:99], a[0:3], v[32:47]
    s_cbranch_vccnz L_retry_g2_1_0
L_back_g2_1_0:
    v_mfma_f32_32x32x16_bf16 v[80:95], v[108:111], a[12:15], v[80:95]
    s_add_u32 s11, s68, 14336
    buffer_load_dwordx4 v[152:155], v7, s[40:43], s11 offen sc1
    v_mfma_f32_32x32x16_bf16 v[64:79], v[108:111], a[8:11], v[64:79]
    buffer_load_dwordx4 v[156:159], v8, s[40:43], s11 offen sc1
    v_mfma_f32_32x32x16_bf16 v[48:63], v[104:107], a[12:15], v[48:63]
    s_waitcnt vmcnt(10)
    v_max_u32 v20, v112, v116
    v_cmp_eq_u32 vcc, -1, v20
    v_mfma_f32_32x32x16_bf16 v[32:47], v[104:107], a[8:11], v[32:47]
    s_cbranch_vccnz L_retry_g2_2_0
L_back_g2_2_0:
    v_mfma_f32_32x32x16_bf16 v[80:95], v[116:119], a[20:23], v[80:95]
    s_add_u32 s11, s68, 16384
    buffer_load_dwordx4 v[160:163], v7, s[40:43], s11 offen sc1
    v_mfma_f32_32x32x16_bf16 v[64:79], v[116:119], a[16:19], v[64:79]
    buffer_load_dwordx4 v[164:167], v8, s[40:43], s11 offen sc1
    v_mfma_f32_32x32x16_bf16 v[48:63], v[112:115], a[20:23], v[48:63]
    s_waitcnt vmcnt(10)
    v_max_u32 v20, v120, v124
    v_cmp_eq_u32 vcc, -1, v20
    v_mfma_f32_32x32x16_bf16 v[32:47], v[112:115], a[16:19], v[32:47]
    s_cbranch_vccnz L_retry_g2_3_0
L_back_g2_3_0:
    v_mfma_f32_32x32x16_bf16 v[80:95], v[124:127], a[28:31], v[80:95]
    s_add_u32 s11, s68, 18432
    buffer_load_dwordx4 v[168:171], v7, s[40:43], s11 offen sc1
    v_mfma_f32_32x32x16_bf16 v[64:79], v[124:127], a[24:27], v[64:79]
    buffer_load_dwordx4 v[172:175], v8, s[40:43], s11 offen sc1
    v_mfma_f32_32x32x16_bf16 v[48:63], v[120:123], a[28:31], v[48:63]
    s_waitcnt vmcnt(10)
    v_max_u32 v20, v128, v132
    v_cmp_eq_u32 vcc, -1, v20
    v_mfma_f32_32x32x16_bf16 v[32:47], v[120:123], a[24:27], v[32:47]
    s_cbranch_vccnz L_retry_g2_4_0
L_back_g2_4_0:
    v_mfma_f32_32x32x16_bf16 v[80:95], v[132:135], a[36:39], v[80:95]
    s_add_u32 s11, s68, 20480
    buffer_load_dwordx4 v[176:179], v7, s[40:43], s11 offen sc1
    v_mfma_f32_32x32x16_bf16 v[64:79], v[132:135], a[32:35], v[64:79]
    buffer_load_dwordx4 v[180:183], v8, s[40:43], s11 offen sc1
    v_mfma_f32_32x32x16_bf16 v[48:63], v[128:131], a[36:39], v[48:63]
    s_waitcnt vmcnt(10)
    v_max_u32 v20, v136, v140
    v_cmp_eq_u32 vcc, -1, v20
    v_mfma_f32_32x32x16_bf16 v[32:47], v[128:131], a[32:35], v[32:47]
    s_cbranch_vccnz L_retry_g2_5_0
L_back_g2_5_0:
    v_mfma_f32_32x32x16_bf16 v[80:95], v[140:143], a[44:47], v[80:95]
    s_add_u32 s11, s68, 22528
    buffer_load_dwordx4 v[184:187], v7, s[40:43], s11 offen sc1
    v_mfma_f32_32x32x16_bf16 v[64:79], v[140:143], a[40:43], v[64:79]
    buffer_load_dwordx4 v[188:191], v8, s[40:43], s11 offen sc1
    v_mfma_f32_32x32x16_bf16 v[48:63], v[136:139], a[44:47], v[48:63]
    s_waitcnt vmcnt(10)
    v_max_u32 v20, v144, v148
    v_cmp_eq_u32 vcc, -1, v20
    v_mfma_f32_32x32x16_bf16 v[32:47], v[136:139], a[40:43], v[32:47]
    s_cbranch_vccnz L_retry_g2_6_0
L_back_g2_6_0:
    v_mfma_f32_32x32x16_bf16 v[80:95], v[148:151], a[52:55], v[80:95]
    s_add_u32 s11, s68, 24576
    buffer_load_dwordx4 v[192:195], v7, s[40:43], s11 offen sc1
    v_mfma_f32_32x32x16_bf16 v[64:79], v[148:151], a[48:51], v[64:79]
    buffer_load_dwordx4 v[196:199], v8, s[40:43], s11 offen sc1
    v_mfma_f32_32x32x16_bf16 v[48:63], v[144:147], a[52:55], v[48:63]
    s_waitcnt vmcnt(10)
    v_max_u32 v20, v152, v156
    v_cmp_eq_u32 vcc, -1, v20
    v_mfma_f32_32x32x16_bf16 v[32:47], v[144:147], a[48:51], v[32:47]
    s_cbranch_vccnz L_retry_g2_7_0
L_back_g2_7_0:
    v_mfma_f32_32x32x16_bf16 v[80:95], v[156:159], a[60:63], v[80:95]
    s_add_u32 s11, s68, 26624
    buffer_load_dwordx4 v[96:99], v7, s[40:43], s11 offen sc1
    v_mfma_f32_32x32x16_bf16 v[64:79], v[156:159], a[56:59], v[64:79]
    buffer_load_dwordx4 v[100:103], v8, s[40:43], s11 offen sc1
    v_mfma_f32_32x32x16_bf16 v[48:63], v[152:155], a[60:63], v[48:63]
    s_waitcnt vmcnt(10)
    v_max_u32 v20, v160, v164
    v_cmp_eq_u32 vcc, -1, v20
    v_mfma_f32_32x32x16_bf16 v[32:47], v[152:155], a[56:59], v[32:47]
    s_cbranch_vccnz L_retry_g2_8_0
L_back_g2_8_0:
    v_mfma_f32_32x32x16_bf16 v[80:95], v[164:167], a[68:71], v[80:95]
    s_add_u32 s11, s69, 0
    buffer_load_dwordx4 v[104:107], v7, s[40:43], s11 offen sc1
    v_mfma_f32_32x32x16_bf16 v[64:79], v[164:167], a[64:67], v[64:79]
    buffer_load_dwordx4 v[108:111], v8, s[40:43], s11 offen sc1
    v_mfma_f32_32x32x16_bf16 v[48:63], v[160:163], a[68:71], v[48:63]
    s_waitcnt vmcnt(10)
    v_max_u32 v20, v168, v172
    v_cmp_eq_u32 vcc, -1, v20
    v_mfma_f32_32x32x16_bf16 v[32:47], v[160:163], a[64:67], v[32:47]
    s_cbranch_vccnz L_retry_g2_9_0
L_back_g2_9_0:
    v_mfma_f32_32x32x16_bf16 v[80:95], v[172:175], a[76:79], v[80:95]
    s_add_u32 s11, s69, 2048
    buffer_load_dwordx4 v[112:115], v7, s[40:43], s11 offen sc1
    v_mfma_f32_32x32x16_bf16 v[64:79], v[172:175], a[72:75], v[64:79]
    buffer_load_dwordx4 v[116:119], v8, s[40:43], s11 offen sc1
    v_mfma_f32_32x32x16_bf16 v[48:63], v[168:171], a[76:79], v[48:63]
    s_waitcnt vmcnt(10)
    v_max_u32 v20, v176, v180
    v_cmp_eq_u32 vcc, -1, v20
    v_mfma_f32_32x32x16_bf16 v[32:47], v[168:171], a[72:75], v[32:47]
    s_cbranch_vccnz L_retry_g2_10_0
L_back_g2_10_0:
    v_mfma_f32_32x32x16_bf16 v[80:95], v[180:183], a[84:87], v[80:95]
    s_add_u32 s11, s69, 4096
    buffer_load_dwordx4 v[120:123], v7, s[40:43], s11 offen sc1
    v_mfma_f32_32x32x16_bf16 v[64:79], v[180:183], a[80:83], v[64:79]
    buffer_load_dwordx4 v[124:127], v8, s[40:43], s11 offen sc1
    v_mfma_f32_32x32x16_bf16 v[48:63], v[176:179], a[84:87], v[48:63]
    s_waitcnt vmcnt(10)
    v_max_u32 v20, v184, v188
    v_cmp_eq_u32 vcc, -1, v20
    v_mfma_f32_32x32x16_bf16 v[32:47], v[176:179], a[80:83], v[32:47]
    s_cbranch_vccnz L_retry_g2_11_0
L_back_g2_11_0:
    v_mfma_f32_32x32x16_bf16 v[80:95], v[188:191], a[92:95], v[80:95]
    s_add_u32 s11, s69, 6144
    buffer_load_dwordx4 v[128:131], v7, s[40:43], s11 offen sc1
    v_mfma_f32_32x32x16_bf16 v[64:79], v[188:191], a[88:91], v[64:79]
    buffer_load_dwordx4 v[132:135], v8, s[40:43], s11 offen sc1
    v_mfma_f32_32x32x16_bf16 v[48:63], v[184:187], a[92:95], v[48:63]
    s_waitcnt vmcnt(10)
    v_max_u32 v20, v192, v196
    v_cmp_eq_u32 vcc, -1, v20
    v_mfma_f32_32x32x16_bf16 v[32:47], v[184:187], a[88:91], v[32:47]
    s_cbranch_vccnz L_retry_g2_12_0
L_back_g2_12_0:
    v_mfma_f32_32x32x16_bf16 v[80:95], v[196:199], a[100:103], v[80:95]
    s_add_u32 s11, s69, 8192
    buffer_load_dwordx4 v[136:139], v7, s[40:43], s11 offen sc1
    v_mfma_f32_32x32x16_bf16 v[64:79], v[196:199], a[96:99], v[64:79]
    buffer_load_dwordx4 v[140:143], v8, s[40:43], s11 offen sc1
    v_mfma_f32_32x32x16_bf16 v[48:63], v[192:195], a[100:103], v[48:63]
    s_waitcnt vmcnt(10)
    v_max_u32 v20, v96, v100
    v_cmp_eq_u32 vcc, -1, v20
    v_mfma_f32_32x32x16_bf16 v[32:47], v[192:195], a[96:99], v[32:47]
    s_cbranch_vccnz L_retry_g2_13_0
L_back_g2_13_0:
    v_mfma_f32_32x32x16_bf16 v[80:95], v[100:103], a[108:111], v[80:95]
    s_add_u32 s11, s69, 10240
    buffer_load_dwordx4 v[144:147], v7, s[40:43], s11 offen sc1
    v_mfma_f32_32x32x16_bf16 v[64:79], v[100:103], a[104:107], v[64:79]
    buffer_load_dwordx4 v[148:151], v8, s[40:43], s11 offen sc1
    v_mfma_f32_32x32x16_bf16 v[48:63], v[96:99], a[108:111], v[48:63]
    s_waitcnt vmcnt(10)
    v_max_u32 v20, v104, v108
    v_cmp_eq_u32 vcc, -1, v20
    v_mfma_f32_32x32x16_bf16 v[32:47], v[96:99], a[104:107], v[32:47]
    s_cbranch_vccnz L_retry_g2_14_0
L_back_g2_14_0:
    v_mfma_f32_32x32x16_bf16 v[80:95], v[108:111], a[116:119], v[80:95]
    s_add_u32 s11, s69, 12288
    buffer_load_dwordx4 v[152:155], v7, s[40:43], s11 offen sc1
    v_mfma_f32_32x32x16_bf16 v[64:79], v[108:111], a[112:115], v[64:79]
    buffer_load_dwordx4 v[156:159], v8, s[40:43], s11 offen sc1
    v_mfma_f32_32x32x16_bf16 v[48:63], v[104:107], a[116:119], v[48:63]
    s_waitcnt vmcnt(10)
    v_max_u32 v20, v112, v116
    v_cmp_eq_u32 vcc, -1, v20
    v_mfma_f32_32x32x16_bf16 v[32:47], v[104:107], a[112:115], v[32:47]
    s_cbranch_vccnz L_retry_g2_15_0
L_back_g2_15_0:
    v_mfma_f32_32x32x16_bf16 v[80:95], v[116:119], a[124:127], v[80:95]
    s_add_u32 s11, s69, 14336
    buffer_load_dwordx4 v[160:163], v7, s[40:43], s11 offen sc1
    v_mfma_f32_32x32x16_bf16 v[64:79], v[116:119], a[120:123], v[64:79]
    buffer_load_dwordx4 v[164:167], v8, s[40:43], s11 offen sc1
    v_mfma_f32_32x32x16_bf16 v[48:63], v[112:115], a[124:127], v[48:63]
    s_waitcnt vmcnt(10)
    v_max_u32 v20, v120, v124
    v_cmp_eq_u32 vcc, -1, v20
    v_mfma_f32_32x32x16_bf16 v[32:47], v[112:115], a[120:123], v[32:47]
    s_cbranch_vccnz L_retry_g2_16_0
L_back_g2_16_0:
    v_mfma_f32_32x32x16_bf16 v[80:95], v[124:127], a[132:135], v[80:95]
    s_add_u32 s11, s69, 16384
    buffer_load_dwordx4 v[172:175], v8, s[40:43], s11 offen sc1
    v_mfma_f32_32x32x16_bf16 v[64:79], v[124:127], a[128:131], v[64:79]
    s_add_u32 s11, s69, 18432
    buffer_load_dwordx4 v[180:183], v8, s[40:43], s11 offen sc1
    v_mfma_f32_32x32x16_bf16 v[48:63], v[120:123], a[132:135], v[48:63]
    s_waitcnt vmcnt(10)
    v_max_u32 v20, v128, v132
    v_cmp_eq_u32 vcc, -1, v20
    v_mfma_f32_32x32x16_bf16 v[32:47], v[120:123], a[128:131], v[32:47]
    s_cbranch_vccnz L_retry_g2_17_0
L_back_g2_17_0:
    v_mfma_f32_32x32x16_bf16 v[80:95], v[132:135], a[140:143], v[80:95]
    s_add_u32 s11, s69, 20480
    buffer_load_dwordx4 v[188:191], v8, s[40:43], s11 offen sc1
    v_mfma_f32_32x32x16_bf16 v[64:79], v[132:135], a[136:139], v[64:79]
    s_add_u32 s11, s69, 22528
    buffer_load_dwordx4 v[196:199], v8, s[40:43], s11 offen sc1
    v_mfma_f32_32x32x16_bf16 v[48:63], v[128:131], a[140:143], v[48:63]
    s_waitcnt vmcnt(10)
    v_max_u32 v20, v136, v140
    v_cmp_eq_u32 vcc, -1, v20
    v_mfma_f32_32x32x16_bf16 v[32:47], v[128:131], a[136:139], v[32:47]
    s_cbranch_vccnz L_retry_g2_18_0
L_back_g2_18_0:
    v_mfma_f32_32x32x16_bf16 v[80:95], v[140:143], a[148:151], v[80:95]
    s_add_u32 s11, s69, 24576
    buffer_load_dwordx4 v[100:103], v8, s[40:43], s11 offen sc1
    v_mfma_f32_32x32x16_bf16 v[64:79], v[140:143], a[144:147], v[64:79]
    s_add_u32 s11, s69, 26624
    buffer_load_dwordx4 v[108:111], v8, s[40:43], s11 offen sc1
    v_mfma_f32_32x32x16_bf16 v[48:63], v[136:139], a[148:151], v[48:63]
    s_waitcnt vmcnt(10)
    v_max_u32 v20, v144, v148
    v_cmp_eq_u32 vcc, -1, v20
    v_mfma_f32_32x32x16_bf16 v[32:47], v[136:139], a[144:147], v[32:47]
    s_cbranch_vccnz L_retry_g2_19_0
L_back_g2_19_0:
    v_mfma_f32_32x32x16_bf16 v[80:95], v[148:151], a[156:159], v[80:95]
    s_add_u32 s11, s69, 16384
    buffer_load_dwordx4 v[168:171], v7, s[40:43], s11 offen sc1
    v_mfma_f32_32x32x16_bf16 v[64:79], v[148:151], a[152:155], v[64:79]
    s_add_u32 s11, s69, 18432
    buffer_load_dwordx4 v[176:179], v7, s[40:43], s11 offen sc1
    v_mfma_f32_32x32x16_bf16 v[48:63], v[144:147], a[156:159], v[48:63]
    s_waitcnt vmcnt(10)
    v_max_u32 v20, v152, v156
    v_cmp_eq_u32 vcc, -1, v20
    v_mfma_f32_32x32x16_bf16 v[32:47], v[144:147], a[152:155], v[32:47]
    s_cbranch_vccnz L_retry_g2_20_0
L_back_g2_20_0:
    v_mfma_f32_32x32x16_bf16 v[80:95], v[156:159], a[164:167], v[80:95]
    s_add_u32 s11, s69, 20480
    buffer_load_dwordx4 v[184:187], v7, s[40:43], s11 offen sc1
    v_mfma_f32_32x32x16_bf16 v[64:79], v[156:159], a[160:163], v[64:79]
    s_add_u32 s11, s69, 22528
    buffer_load_dwordx4 v[192:195], v7, s[40:43], s11 offen sc1
    v_mfma_f32_32x32x16_bf16 v[48:63], v[152:155], a[164:167], v[48:63]
    s_waitcnt vmcnt(10)
    v_max_u32 v20, v160, v164
    v_cmp_eq_u32 vcc, -1, v20
    v_mfma_f32_32x32x16_bf16 v[32:47], v[152:155], a[160:163], v[32:47]
    s_cbranch_vccnz L_retry_g2_21_0
L_back_g2_21_0:
    v_mfma_f32_32x32x16_bf16 v[80:95], v[164:167], a[172:175], v[80:95]
    s_add_u32 s11, s69, 24576
    buffer_load_dwordx4 v[96:99], v7, s[40:43], s11 offen sc1
    v_mfma_f32_32x32x16_bf16 v[64:79], v[164:167], a[168:171], v[64:79]
    s_add_u32 s11, s69, 26624
    buffer_load_dwordx4 v[104:107], v7, s[40:43], s11 offen sc1
    v_mfma_f32_32x32x16_bf16 v[48:63], v[160:163], a[172:175], v[48:63]
    s_waitcnt vmcnt(11)
    v_cmp_eq_u32 vcc, -1, v172
    v_mfma_f32_32x32x16_bf16 v[32:47], v[160:163], a[168:171], v[32:47]
    s_cbranch_vccnz L_retry_g2_22_1
L_back_g2_22_1:
    v_mfma_f32_32x32x16_bf16 v[80:95], v[172:175], a[180:183], v[80:95]
    s_waitcnt vmcnt(10)
    v_cmp_eq_u32 vcc, -1, v180
    v_mfma_f32_32x32x16_bf16 v[64:79], v[172:175], a[176:179], v[64:79]
    s_cbranch_vccnz L_retry_g2_23_1
L_back_g2_23_1:
    v_mfma_f32_32x32x16_bf16 v[80:95], v[180:183], a[188:191], v[80:95]
    s_waitcnt vmcnt(9)
    v_cmp_eq_u32 vcc, -1, v188
    v_mfma_f32_32x32x16_bf16 v[64:79], v[180:183], a[184:187], v[64:79]
    s_cbranch_vccnz L_retry_g2_24_1
L_back_g2_24_1:
    v_mfma_f32_32x32x16_bf16 v[80:95], v[188:191], a[196:199], v[80:95]
    s_waitcnt vmcnt(8)
    v_cmp_eq_u32 vcc, -1, v196
    v_mfma_f32_32x32x16_bf16 v[64:79], v[188:191], a[192:195], v[64:79]
    s_cbranch_vccnz L_retry_g2_25_1
L_back_g2_25_1:
    v_mfma_f32_32x32x16_bf16 v[80:95], v[196:199], a[204:207], v[80:95]
    s_waitcnt vmcnt(7)
    v_cmp_eq_u32 vcc, -1, v100
    v_mfma_f32_32x32x16_bf16 v[64:79], v[196:199], a[200:203], v[64:79]
    s_cbranch_vccnz L_retry_g2_26_1
L_back_g2_26_1:
    v_mfma_f32_32x32x16_bf16 v[80:95], v[100:103], a[212:215], v[80:95]
    s_waitcnt vmcnt(6)
    v_cmp_eq_u32 vcc, -1, v108
    v_mfma_f32_32x32x16_bf16 v[64:79], v[100:103], a[208:211], v[64:79]
    s_cbranch_vccnz L_retry_g2_27_1
L_back_g2_27_1:
    v_mfma_f32_32x32x16_bf16 v[80:95], v[108:111], a[220:223], v[80:95]
    s_waitcnt vmcnt(5)
    v_cmp_eq_u32 vcc, -1, v168
    v_mfma_f32_32x32x16_bf16 v[64:79], v[108:111], a[216:219], v[64:79]
    s_cbranch_vccnz L_retry_g2_22_0
L_back_g2_22_0:
    v_mfma_f32_32x32x16_bf16 v[48:63], v[168:171], a[180:183], v[48:63]
    s_nop 6
    ds_write_b128 v12, v[80:83] offset:6144
    ds_write_b128 v12, v[84:87] offset:7168
    ds_write_b128 v12, v[88:91] offset:8192
    ds_write_b128 v12, v[92:95] offset:9216
    s_waitcnt vmcnt(4)
    v_cmp_eq_u32 vcc, -1, v176
    v_mfma_f32_32x32x16_bf16 v[32:47], v[168:171], a[176:179], v[32:47]
    ds_write_b128 v12, v[72:75] offset:10240
    ds_write_b128 v12, v[76:79] offset:11264
    s_cbranch_vccnz L_retry_g2_23_0
L_back_g2_23_0:
    v_mfma_f32_32x32x16_bf16 v[48:63], v[176:179], a[188:191], v[48:63]
    s_waitcnt lgkmcnt(0)
    s_barrier
    s_waitcnt vmcnt(3)
    v_cmp_eq_u32 vcc, -1, v184
    v_mfma_f32_32x32x16_bf16 v[32:47], v[176:179], a[184:187], v[32:47]
    ds_read_b128 v[216:219], v9 offset:6144
    ds_read_b128 v[220:223], v9 offset:7168
    ds_read_b128 v[224:227], v10 offset:6144
    s_cbranch_vccnz L_retry_g2_24_0
L_back_g2_24_0:
    v_mfma_f32_32x32x16_bf16 v[48:63], v[184:187], a[196:199], v[48:63]
    ds_read_b128 v[228:231], v10 offset:7168
    ds_read_b128 v[232:235], v11 offset:6144
    ds_read_b128 v[236:239], v11 offset:7168
    s_waitcnt lgkmcnt(4)
    v_add_f32 v64, v64, v216
    s_waitcnt vmcnt(2)
    v_cmp_eq_u32 vcc, -1, v192
    v_mfma_f32_32x32x16_bf16 v[32:47], v[184:187], a[192:195], v[32:47]
    v_add_f32 v65, v65, v217
    v_add_f32 v66, v66, v218
    v_add_f32 v67, v67, v219
    s_cbranch_vccnz L_retry_g2_25_0
L_back_g2_25_0:
    v_mfma_f32_32x32x16_bf16 v[48:63], v[192:195], a[204:207], v[48:63]
    v_add_f32 v68, v68, v220
    v_add_f32 v69, v69, v221
    v_add_f32 v70, v70, v222
    v_add_f32 v71, v71, v223
    s_waitcnt vmcnt(1)
    v_cmp_eq_u32 vcc, -1, v96
    v_mfma_f32_32x32x16_bf16 v[32:47], v[192:195], a[200:203], v[32:47]
    s_waitcnt lgkmcnt(2)
    v_add_f32 v64, v64, v224
    v_add_f32 v65, v65, v225
    v_add_f32 v66, v66, v226
    s_cbranch_vccnz L_retry_g2_26_0
L_back_g2_26_0:
    v_mfma_f32_32x32x16_bf16 v[48:63], v[96:99], a[212:215], v[48:63]
    v_add_f32 v67, v67, v227
    v_add_f32 v68, v68, v228
    v_add_f32 v69, v69, v229
    v_add_f32 v70, v70, v230
    s_waitcnt vmcnt(0)
    v_cmp_eq_u32 vcc, -1, v104
    v_mfma_f32_32x32x16_bf16 v[32:47], v[96:99], a[208:211], v[32:47]
    v_add_f32 v71, v71, v231
    s_waitcnt lgkmcnt(0)
    v_add_f32 v64, v64, v232
    v_add_f32 v65, v65, v233
    s_cbranch_vccnz L_retry_g2_27_0
L_back_g2_27_0:
    v_mfma_f32_32x32x16_bf16 v[48:63], v[104:107], a[220:223], v[48:63]
    v_add_f32 v66, v66, v234
    v_add_f32 v67, v67, v235
    v_add_f32 v68, v68, v236
    v_mfma_f32_32x32x16_bf16 v[32:47], v[104:107], a[216:219], v[32:47]
    v_add_f32 v69, v69, v237
    v_add_f32 v70, v70, v238
    v_add_f32 v71, v71, v239
    s_nop 4
    ds_write_b128 v12, v[48:51] offset:0
    ds_write_b128 v12, v[52:55] offset:1024
    ds_write_b128 v12, v[56:59] offset:2048
    ds_write_b128 v12, v[60:63] offset:3072
    ds_write_b128 v12, v[40:43] offset:4096
    ds_write_b128 v12, v[44:47] offset:5120
    v_cvt_pk_bf16_f32 v244, v64, v65
    v_cvt_pk_bf16_f32 v245, v66, v67
    v_cvt_pk_bf16_f32 v246, v68, v69
    v_cvt_pk_bf16_f32 v247, v70, v71
    s_nop 0
    v_permlane32_swap_b32 v244, v246
    v_permlane32_swap_b32 v245, v247
    buffer_store_dwordx4 v[244:247], v18, s[44:47], s15 offen offset:64
    s_waitcnt lgkmcnt(0)
    s_barrier
    ds_read_b128 v[216:219], v9 offset:0
    ds_read_b128 v[220:223], v9 offset:1024
    ds_read_b128 v[224:227], v10 offset:0
    ds_read_b128 v[228:231], v10 offset:1024
    ds_read_b128 v[232:235], v11 offset:0
    ds_read_b128 v[236:239], v11 offset:1024
    s_waitcnt lgkmcnt(4)
    v_pk_add_f32 v[32:33], v[32:33], v[216:217]
    v_pk_add_f32 v[34:35], v[34:35], v[218:219]
    v_pk_add_f32 v[36:37], v[36:37], v[220:221]
    v_pk_add_f32 v[38:39], v[38:39], v[222:223]
    s_waitcnt lgkmcnt(2)
    v_pk_add_f32 v[32:33], v[32:33], v[224:225]
    v_pk_add_f32 v[34:35], v[34:35], v[226:227]
    v_pk_add_f32 v[36:37], v[36:37], v[228:229]
    v_pk_add_f32 v[38:39], v[38:39], v[230:231]
    s_waitcnt lgkmcnt(0)
    v_pk_add_f32 v[32:33], v[32:33], v[232:233]
    v_pk_add_f32 v[34:35], v[34:35], v[234:235]
    v_pk_add_f32 v[36:37], v[36:37], v[236:237]
    v_pk_add_f32 v[38:39], v[38:39], v[238:239]
    v_cvt_pk_bf16_f32 v240, v32, v33
    v_cvt_pk_bf16_f32 v241, v34, v35
    v_cvt_pk_bf16_f32 v242, v36, v37
    v_cvt_pk_bf16_f32 v243, v38, v39
    s_nop 0
    v_permlane32_swap_b32 v240, v242
    v_permlane32_swap_b32 v241, v243
    buffer_store_dwordx4 v[240:243], v18, s[44:47], s15 offen offset:0
L_done:
    s_endpgm
L_o_redo:
    s_add_u32 s73, s73, 1
    s_cmp_ge_u32 s73, 2000
    s_cbranch_scc1 L_o_done
    s_mul_i32 s69, s56, 7168
    s_mul_i32 s7, s66, 14336
    s_add_u32 s7, s7, s69
    s_add_u32 m0, s69, 63488
    s_nop 0
    buffer_load_dwordx4 v44, s[20:23], s7 offen lds
    s_add_u32 m0, s69, 64512
    s_nop 0
    buffer_load_dwordx4 v45, s[20:23], s7 offen lds
    s_add_u32 m0, s69, 65536
    s_nop 0
    buffer_load_dwordx4 v46, s[20:23], s7 offen lds
    s_add_u32 m0, s69, 66560
    s_nop 0
    buffer_load_dwordx4 v47, s[20:23], s7 offen lds
    s_add_u32 m0, s69, 67584
    s_nop 0
    buffer_load_dwordx4 v48, s[20:23], s7 offen lds
    s_add_u32 m0, s69, 68608
    s_nop 0
    buffer_load_dwordx4 v49, s[20:23], s7 offen lds
    s_add_u32 m0, s69, 69632
    s_nop 0
    buffer_load_dwordx4 v50, s[20:23], s7 offen lds
    s_waitcnt vmcnt(0)
    s_barrier
    v_add_u32 v8, 63488, v3
    ds_read_b64_tr_b16 v[28:29], v8 offset:0
    ds_read_b64_tr_b16 v[30:31], v8 offset:1024
    ds_read_b64_tr_b16 v[32:33], v8 offset:2048
    ds_read_b64_tr_b16 v[34:35], v8 offset:3072
    ds_read_b64_tr_b16 v[36:37], v8 offset:4096
    ds_read_b64_tr_b16 v[38:39], v8 offset:5120
    ds_read_b64_tr_b16 v[40:41], v8 offset:6144
    s_waitcnt lgkmcnt(0)
    v_lshlrev_b32 v60, 16, v28
    v_and_b32 v61, 0xffff0000, v28
    v_lshlrev_b32 v62, 16, v29
    v_and_b32 v63, 0xffff0000, v29
    v_lshlrev_b32 v64, 16, v30
    v_and_b32 v65, 0xffff0000, v30
    v_lshlrev_b32 v66, 16, v31
    v_and_b32 v67, 0xffff0000, v31
    v_lshlrev_b32 v68, 16, v32
    v_and_b32 v69, 0xffff0000, v32
    v_lshlrev_b32 v70, 16, v33
    v_and_b32 v71, 0xffff0000, v33
    v_lshlrev_b32 v72, 16, v34
    v_and_b32 v73, 0xffff0000, v34
    v_lshlrev_b32 v74, 16, v35
    v_and_b32 v75, 0xffff0000, v35
    v_lshlrev_b32 v76, 16, v36
    v_and_b32 v77, 0xffff0000, v36
    v_lshlrev_b32 v78, 16, v37
    v_and_b32 v79, 0xffff0000, v37
    v_lshlrev_b32 v80, 16, v38
    v_and_b32 v81, 0xffff0000, v38
    v_lshlrev_b32 v82, 16, v39
    v_and_b32 v83, 0xffff0000, v39
    v_lshlrev_b32 v84, 16, v40
    v_and_b32 v85, 0xffff0000, v40
    v_lshlrev_b32 v86, 16, v41
    v_and_b32 v87, 0xffff0000, v41
    ds_read_b64_tr_b16 v[28:29], v8 offset:14336
    ds_read_b64_tr_b16 v[30:31], v8 offset:15360
    ds_read_b64_tr_b16 v[32:33], v8 offset:16384
    ds_read_b64_tr_b16 v[34:35], v8 offset:17408
    ds_read_b64_tr_b16 v[36:37], v8 offset:18432
    ds_read_b64_tr_b16 v[38:39], v8 offset:19456
    ds_read_b64_tr_b16 v[40:41], v8 offset:20480
    s_waitcnt lgkmcnt(0)
    v_lshlrev_b32 v88, 16, v28
    v_and_b32 v89, 0xffff0000, v28
    v_lshlrev_b32 v90, 16, v29
    v_and_b32 v91, 0xffff0000, v29
    v_lshlrev_b32 v92, 16, v30
    v_and_b32 v93, 0xffff0000, v30
    v_lshlrev_b32 v94, 16, v31
    v_and_b32 v95, 0xffff0000, v31
    v_lshlrev_b32 v96, 16, v32
    v_and_b32 v97, 0xffff0000, v32
    v_lshlrev_b32 v98, 16, v33
    v_and_b32 v99, 0xffff0000, v33
    v_lshlrev_b32 v100, 16, v34
    v_and_b32 v101, 0xffff0000, v34
    v_lshlrev_b32 v102, 16, v35
    v_and_b32 v103, 0xffff0000, v35
    v_lshlrev_b32 v104, 16, v36
    v_and_b32 v105, 0xffff0000, v36
    v_lshlrev_b32 v106, 16, v37
    v_and_b32 v107, 0xffff0000, v37
    v_lshlrev_b32 v108, 16, v38
    v_and_b32 v109, 0xffff0000, v38
    v_lshlrev_b32 v110, 16, v39
    v_and_b32 v111, 0xffff0000, v39
    v_lshlrev_b32 v112, 16, v40
    v_and_b32 v113, 0xffff0000, v40
    v_lshlrev_b32 v114, 16, v41
    v_and_b32 v115, 0xffff0000, v41
    s_branch L_o_fetch
L_retry_g1_0_0:
    s_add_u32 s4, s68, 0
    buffer_load_dwordx4 v[96:99], v7, s[40:43], s4 offen sc1
    buffer_load_dwordx4 v[100:103], v8, s[40:43], s4 offen sc1
    s_add_u32 s77, s77, 1
    s_cmp_ge_u32 s77, 50000
    s_waitcnt vmcnt(0)
    s_cbranch_scc1 L_back_g1_0_0
    v_max_u32 v20, v96, v100
    v_cmp_eq_u32 vcc, -1, v20
    s_cbranch_vccnz L_retry_g1_0_0
    s_branch L_back_g1_0_0
L_retry_g1_1_0:
    s_add_u32 s4, s68, 2048
    buffer_load_dwordx4 v[104:107], v7, s[40:43], s4 offen sc1
    buffer_load_dwordx4 v[108:111], v8, s[40:43], s4 offen sc1
    s_add_u32 s77, s77, 1
    s_cmp_ge_u32 s77, 50000
    s_waitcnt vmcnt(0)
    s_cbranch_scc1 L_back_g1_1_0
    v_max_u32 v20, v104, v108
    v_cmp_eq_u32 vcc, -1, v20
    s_cbranch_vccnz L_retry_g1_1_0
    s_branch L_back_g1_1_0
L_retry_g1_2_0:
    s_add_u32 s4, s68, 4096
    buffer_load_dwordx4 v[112:115], v7, s[40:43], s4 offen sc1
    buffer_load_dwordx4 v[116:119], v8, s[40:43], s4 offen sc1
    s_add_u32 s77, s77, 1
    s_cmp_ge_u32 s77, 50000
    s_waitcnt vmcnt(0)
    s_cbranch_scc1 L_back_g1_2_0
    v_max_u32 v20, v112, v116
    v_cmp_eq_u32 vcc, -1, v20
    s_cbranch_vccnz L_retry_g1_2_0
    s_branch L_back_g1_2_0
L_retry_g1_3_0:
    s_add_u32 s4, s68, 6144
    buffer_load_dwordx4 v[120:123], v7, s[40:43], s4 offen sc1
    buffer_load_dwordx4 v[124:127], v8, s[40:43], s4 offen sc1
    s_add_u32 s77, s77, 1
    s_cmp_ge_u32 s77, 50000
    s_waitcnt vmcnt(0)
    s_cbranch_scc1 L_back_g1_3_0
    v_max_u32 v20, v120, v124
    v_cmp_eq_u32 vcc, -1, v20
    s_cbranch_vccnz L_retry_g1_3_0
    s_branch L_back_g1_3_0
L_retry_g1_4_0:
    s_add_u32 s4, s68, 8192
    buffer_load_dwordx4 v[128:131], v7, s[40:43], s4 offen sc1
    buffer_load_dwordx4 v[132:135], v8, s[40:43], s4 offen sc1
    s_add_u32 s77, s77, 1
    s_cmp_ge_u32 s77, 50000
    s_waitcnt vmcnt(0)
    s_cbranch_scc1 L_back_g1_4_0
    v_max_u32 v20, v128, v132
    v_cmp_eq_u32 vcc, -1, v20
    s_cbranch_vccnz L_retry_g1_4_0
    s_branch L_back_g1_4_0
L_retry_g1_5_0:
    s_add_u32 s4, s68, 10240
    buffer_load_dwordx4 v[136:139], v7, s[40:43], s4 offen sc1
    buffer_load_dwordx4 v[140:143], v8, s[40:43], s4 offen sc1
    s_add_u32 s77, s77, 1
    s_cmp_ge_u32 s77, 50000
    s_waitcnt vmcnt(0)
    s_cbranch_scc1 L_back_g1_5_0
    v_max_u32 v20, v136, v140
    v_cmp_eq_u32 vcc, -1, v20
    s_cbranch_vccnz L_retry_g1_5_0
    s_branch L_back_g1_5_0
L_retry_g1_6_0:
    s_add_u32 s4, s68, 12288
    buffer_load_dwordx4 v[144:147], v7, s[40:43], s4 offen sc1
    buffer_load_dwordx4 v[148:151], v8, s[40:43], s4 offen sc1
    s_add_u32 s77, s77, 1
    s_cmp_ge_u32 s77, 50000
    s_waitcnt vmcnt(0)
    s_cbranch_scc1 L_back_g1_6_0
    v_max_u32 v20, v144, v148
    v_cmp_eq_u32 vcc, -1, v20
    s_cbranch_vccnz L_retry_g1_6_0
    s_branch L_back_g1_6_0
L_retry_g1_7_0:
    s_add_u32 s4, s68, 14336
    buffer_load_dwordx4 v[152:155], v7, s[40:43], s4 offen sc1
    buffer_load_dwordx4 v[156:159], v8, s[40:43], s4 offen sc1
    s_add_u32 s77, s77, 1
    s_cmp_ge_u32 s77, 50000
    s_waitcnt vmcnt(0)
    s_cbranch_scc1 L_back_g1_7_0
    v_max_u32 v20, v152, v156
    v_cmp_eq_u32 vcc, -1, v20
    s_cbranch_vccnz L_retry_g1_7_0
    s_branch L_back_g1_7_0
L_retry_g1_8_0:
    s_add_u32 s4, s68, 16384
    buffer_load_dwordx4 v[160:163], v7, s[40:43], s4 offen sc1
    buffer_load_dwordx4 v[164:167], v8, s[40:43], s4 offen sc1
    s_add_u32 s77, s77, 1
    s_cmp_ge_u32 s77, 50000
    s_waitcnt vmcnt(0)
    s_cbranch_scc1 L_back_g1_8_0
    v_max_u32 v20, v160, v164
    v_cmp_eq_u32 vcc, -1, v20
    s_cbranch_vccnz L_retry_g1_8_0
    s_branch L_back_g1_8_0
L_retry_g1_9_0:
    s_add_u32 s4, s68, 18432
    buffer_load_dwordx4 v[168:171], v7, s[40:43], s4 offen sc1
    buffer_load_dwordx4 v[172:175], v8, s[40:43], s4 offen sc1
    s_add_u32 s77, s77, 1
    s_cmp_ge_u32 s77, 50000
    s_waitcnt vmcnt(0)
    s_cbranch_scc1 L_back_g1_9_0
    v_max_u32 v20, v168, v172
    v_cmp_eq_u32 vcc, -1, v20
    s_cbranch_vccnz L_retry_g1_9_0
    s_branch L_back_g1_9_0
L_retry_g1_10_0:
    s_add_u32 s4, s68, 20480
    buffer_load_dwordx4 v[176:179], v7, s[40:43], s4 offen sc1
    buffer_load_dwordx4 v[180:183], v8, s[40:43], s4 offen sc1
    s_add_u32 s77, s77, 1
    s_cmp_ge_u32 s77, 50000
    s_waitcnt vmcnt(0)
    s_cbranch_scc1 L_back_g1_10_0
    v_max_u32 v20, v176, v180
    v_cmp_eq_u32 vcc, -1, v20
    s_cbranch_vccnz L_retry_g1_10_0
    s_branch L_back_g1_10_0
L_retry_g1_11_0:
    s_add_u32 s4, s68, 22528
    buffer_load_dwordx4 v[184:187], v7, s[40:43], s4 offen sc1
    buffer_load_dwordx4 v[188:191], v8, s[40:43], s4 offen sc1
    s_add_u32 s77, s77, 1
    s_cmp_ge_u32 s77, 50000
    s_waitcnt vmcnt(0)
    s_cbranch_scc1 L_back_g1_11_0
    v_max_u32 v20, v184, v188
    v_cmp_eq_u32 vcc, -1, v20
    s_cbranch_vccnz L_retry_g1_11_0
    s_branch L_back_g1_11_0
L_retry_g1_12_0:
    s_add_u32 s4, s68, 24576
    buffer_load_dwordx4 v[192:195], v7, s[40:43], s4 offen sc1
    buffer_load_dwordx4 v[196:199], v8, s[40:43], s4 offen sc1
    s_add_u32 s77, s77, 1
    s_cmp_ge_u32 s77, 50000
    s_waitcnt vmcnt(0)
    s_cbranch_scc1 L_back_g1_12_0
    v_max_u32 v20, v192, v196
    v_cmp_eq_u32 vcc, -1, v20
    s_cbranch_vccnz L_retry_g1_12_0
    s_branch L_back_g1_12_0
L_retry_g1_13_0:
    s_add_u32 s4, s68, 26624
    buffer_load_dwordx4 v[200:203], v7, s[40:43], s4 offen sc1
    buffer_load_dwordx4 v[204:207], v8, s[40:43], s4 offen sc1
    s_add_u32 s77, s77, 1
    s_cmp_ge_u32 s77, 50000
    s_waitcnt vmcnt(0)
    s_cbranch_scc1 L_back_g1_13_0
    v_max_u32 v20, v200, v204
    v_cmp_eq_u32 vcc, -1, v20
    s_cbranch_vccnz L_retry_g1_13_0
    s_branch L_back_g1_13_0
L_retry_g1_14_0:
    s_add_u32 s4, s69, 0
    buffer_load_dwordx4 v[96:99], v7, s[40:43], s4 offen sc1
    buffer_load_dwordx4 v[100:103], v8, s[40:43], s4 offen sc1
    s_add_u32 s77, s77, 1
    s_cmp_ge_u32 s77, 50000
    s_waitcnt vmcnt(0)
    s_cbranch_scc1 L_back_g1_14_0
    v_max_u32 v20, v96, v100
    v_cmp_eq_u32 vcc, -1, v20
    s_cbranch_vccnz L_retry_g1_14_0
    s_branch L_back_g1_14_0
L_retry_g1_15_0:
    s_add_u32 s4, s69, 2048
    buffer_load_dwordx4 v[104:107], v7, s[40:43], s4 offen sc1
    buffer_load_dwordx4 v[108:111], v8, s[40:43], s4 offen sc1
    s_add_u32 s77, s77, 1
    s_cmp_ge_u32 s77, 50000
    s_waitcnt vmcnt(0)
    s_cbranch_scc1 L_back_g1_15_0
    v_max_u32 v20, v104, v108
    v_cmp_eq_u32 vcc, -1, v20
    s_cbranch_vccnz L_retry_g1_15_0
    s_branch L_back_g1_15_0
L_retry_g1_16_0:
    s_add_u32 s4, s69, 4096
    buffer_load_dwordx4 v[112:115], v7, s[40:43], s4 offen sc1
    buffer_load_dwordx4 v[116:119], v8, s[40:43], s4 offen sc1
    s_add_u32 s77, s77, 1
    s_cmp_ge_u32 s77, 50000
    s_waitcnt vmcnt(0)
    s_cbranch_scc1 L_back_g1_16_0
    v_max_u32 v20, v112, v116
    v_cmp_eq_u32 vcc, -1, v20
    s_cbranch_vccnz L_retry_g1_16_0
    s_branch L_back_g1_16_0
L_retry_g1_17_0:
    s_add_u32 s4, s69, 6144
    buffer_load_dwordx4 v[120:123], v7, s[40:43], s4 offen sc1
    buffer_load_dwordx4 v[124:127], v8, s[40:43], s4 offen sc1
    s_add_u32 s77, s77, 1
    s_cmp_ge_u32 s77, 50000
    s_waitcnt vmcnt(0)
    s_cbranch_scc1 L_back_g1_17_0
    v_max_u32 v20, v120, v124
    v_cmp_eq_u32 vcc, -1, v20
    s_cbranch_vccnz L_retry_g1_17_0
    s_branch L_back_g1_17_0
L_retry_g1_18_0:
    s_add_u32 s4, s69, 8192
    buffer_load_dwordx4 v[128:131], v7, s[40:43], s4 offen sc1
    buffer_load_dwordx4 v[132:135], v8, s[40:43], s4 offen sc1
    s_add_u32 s77, s77, 1
    s_cmp_ge_u32 s77, 50000
    s_waitcnt vmcnt(0)
    s_cbranch_scc1 L_back_g1_18_0
    v_max_u32 v20, v128, v132
    v_cmp_eq_u32 vcc, -1, v20
    s_cbranch_vccnz L_retry_g1_18_0
    s_branch L_back_g1_18_0
L_retry_g1_19_0:
    s_add_u32 s4, s69, 10240
    buffer_load_dwordx4 v[136:139], v7, s[40:43], s4 offen sc1
    buffer_load_dwordx4 v[140:143], v8, s[40:43], s4 offen sc1
    s_add_u32 s77, s77, 1
    s_cmp_ge_u32 s77, 50000
    s_waitcnt vmcnt(0)
    s_cbranch_scc1 L_back_g1_19_0
    v_max_u32 v20, v136, v140
    v_cmp_eq_u32 vcc, -1, v20
    s_cbranch_vccnz L_retry_g1_19_0
    s_branch L_back_g1_19_0
L_retry_g1_20_0:
    s_add_u32 s4, s69, 12288
    buffer_load_dwordx4 v[144:147], v7, s[40:43], s4 offen sc1
    buffer_load_dwordx4 v[148:151], v8, s[40:43], s4 offen sc1
    s_add_u32 s77, s77, 1
    s_cmp_ge_u32 s77, 50000
    s_waitcnt vmcnt(0)
    s_cbranch_scc1 L_back_g1_20_0
    v_max_u32 v20, v144, v148
    v_cmp_eq_u32 vcc, -1, v20
    s_cbranch_vccnz L_retry_g1_20_0
    s_branch L_back_g1_20_0
L_retry_g1_21_0:
    s_add_u32 s4, s69, 14336
    buffer_load_dwordx4 v[152:155], v7, s[40:43], s4 offen sc1
    buffer_load_dwordx4 v[156:159], v8, s[40:43], s4 offen sc1
    s_add_u32 s77, s77, 1
    s_cmp_ge_u32 s77, 50000
    s_waitcnt vmcnt(0)
    s_cbranch_scc1 L_back_g1_21_0
    v_max_u32 v20, v152, v156
    v_cmp_eq_u32 vcc, -1, v20
    s_cbranch_vccnz L_retry_g1_21_0
    s_branch L_back_g1_21_0
L_retry_g1_22_0:
    s_add_u32 s4, s69, 16384
    buffer_load_dwordx4 v[160:163], v7, s[40:43], s4 offen sc1
    buffer_load_dwordx4 v[164:167], v8, s[40:43], s4 offen sc1
    s_add_u32 s77, s77, 1
    s_cmp_ge_u32 s77, 50000
    s_waitcnt vmcnt(0)
    s_cbranch_scc1 L_back_g1_22_0
    v_max_u32 v20, v160, v164
    v_cmp_eq_u32 vcc, -1, v20
    s_cbranch_vccnz L_retry_g1_22_0
    s_branch L_back_g1_22_0
L_retry_g1_23_0:
    s_add_u32 s4, s69, 18432
    buffer_load_dwordx4 v[168:171], v7, s[40:43], s4 offen sc1
    buffer_load_dwordx4 v[172:175], v8, s[40:43], s4 offen sc1
    s_add_u32 s77, s77, 1
    s_cmp_ge_u32 s77, 50000
    s_waitcnt vmcnt(0)
    s_cbranch_scc1 L_back_g1_23_0
    v_max_u32 v20, v168, v172
    v_cmp_eq_u32 vcc, -1, v20
    s_cbranch_vccnz L_retry_g1_23_0
    s_branch L_back_g1_23_0
L_retry_g1_24_0:
    s_add_u32 s4, s69, 20480
    buffer_load_dwordx4 v[176:179], v7, s[40:43], s4 offen sc1
    buffer_load_dwordx4 v[180:183], v8, s[40:43], s4 offen sc1
    s_add_u32 s77, s77, 1
    s_cmp_ge_u32 s77, 50000
    s_waitcnt vmcnt(0)
    s_cbranch_scc1 L_back_g1_24_0
    v_max_u32 v20, v176, v180
    v_cmp_eq_u32 vcc, -1, v20
    s_cbranch_vccnz L_retry_g1_24_0
    s_branch L_back_g1_24_0
L_retry_g1_25_0:
    s_add_u32 s4, s69, 22528
    buffer_load_dwordx4 v[184:187], v7, s[40:43], s4 offen sc1
    buffer_load_dwordx4 v[188:191], v8, s[40:43], s4 offen sc1
    s_add_u32 s77, s77, 1
    s_cmp_ge_u32 s77, 50000
    s_waitcnt vmcnt(0)
    s_cbranch_scc1 L_back_g1_25_0
    v_max_u32 v20, v184, v188
    v_cmp_eq_u32 vcc, -1, v20
    s_cbranch_vccnz L_retry_g1_25_0
    s_branch L_back_g1_25_0
L_retry_g1_26_1:
    s_add_u32 s4, s69, 24576
    buffer_load_dwordx4 v[196:199], v8, s[40:43], s4 offen sc1
    s_add_u32 s77, s77, 1
    s_cmp_ge_u32 s77, 50000
    s_waitcnt vmcnt(0)
    s_cbranch_scc1 L_back_g1_26_1
    v_cmp_eq_u32 vcc, -1, v196
    s_cbranch_vccnz L_retry_g1_26_1
    s_branch L_back_g1_26_1
L_retry_g1_27_1:
    s_add_u32 s4, s69, 26624
    buffer_load_dwordx4 v[204:207], v8, s[40:43], s4 offen sc1
    s_add_u32 s77, s77, 1
    s_cmp_ge_u32 s77, 50000
    s_waitcnt vmcnt(0)
    s_cbranch_scc1 L_back_g1_27_1
    v_cmp_eq_u32 vcc, -1, v204
    s_cbranch_vccnz L_retry_g1_27_1
    s_branch L_back_g1_27_1
L_retry_g1_28_1:
    s_add_u32 s4, s8, 61440
    buffer_load_dwordx4 v[100:103], v8, s[40:43], s4 offen sc1
    s_add_u32 s77, s77, 1
    s_cmp_ge_u32 s77, 50000
    s_waitcnt vmcnt(0)
    s_cbranch_scc1 L_back_g1_28_1
    v_cmp_eq_u32 vcc, -1, v100
    s_cbranch_vccnz L_retry_g1_28_1
    s_branch L_back_g1_28_1
L_retry_g1_29_1:
    s_add_u32 s4, s8, 63488
    buffer_load_dwordx4 v[108:111], v8, s[40:43], s4 offen sc1
    s_add_u32 s77, s77, 1
    s_cmp_ge_u32 s77, 50000
    s_waitcnt vmcnt(0)
    s_cbranch_scc1 L_back_g1_29_1
    v_cmp_eq_u32 vcc, -1, v108
    s_cbranch_vccnz L_retry_g1_29_1
    s_branch L_back_g1_29_1
L_retry_g1_30_1:
    s_add_u32 s4, s8, 28672
    buffer_load_dwordx4 v[116:119], v8, s[40:43], s4 offen sc1
    s_add_u32 s77, s77, 1
    s_cmp_ge_u32 s77, 50000
    s_waitcnt vmcnt(0)
    s_cbranch_scc1 L_back_g1_30_1
    v_cmp_eq_u32 vcc, -1, v116
    s_cbranch_vccnz L_retry_g1_30_1
    s_branch L_back_g1_30_1
L_retry_g1_31_1:
    s_add_u32 s4, s8, 30720
    buffer_load_dwordx4 v[124:127], v8, s[40:43], s4 offen sc1
    s_add_u32 s77, s77, 1
    s_cmp_ge_u32 s77, 50000
    s_waitcnt vmcnt(0)
    s_cbranch_scc1 L_back_g1_31_1
    v_cmp_eq_u32 vcc, -1, v124
    s_cbranch_vccnz L_retry_g1_31_1
    s_branch L_back_g1_31_1
L_retry_g1_26_0:
    s_add_u32 s4, s69, 24576
    buffer_load_dwordx4 v[192:195], v7, s[40:43], s4 offen sc1
    s_add_u32 s77, s77, 1
    s_cmp_ge_u32 s77, 50000
    s_waitcnt vmcnt(0)
    s_cbranch_scc1 L_back_g1_26_0
    v_cmp_eq_u32 vcc, -1, v192
    s_cbranch_vccnz L_retry_g1_26_0
    s_branch L_back_g1_26_0
L_retry_g1_27_0:
    s_add_u32 s4, s69, 26624
    buffer_load_dwordx4 v[200:203], v7, s[40:43], s4 offen sc1
    s_add_u32 s77, s77, 1
    s_cmp_ge_u32 s77, 50000
    s_waitcnt vmcnt(0)
    s_cbranch_scc1 L_back_g1_27_0
    v_cmp_eq_u32 vcc, -1, v200
    s_cbranch_vccnz L_retry_g1_27_0
    s_branch L_back_g1_27_0
L_retry_g1_28_0:
    s_add_u32 s4, s8, 61440
    buffer_load_dwordx4 v[96:99], v7, s[40:43], s4 offen sc1
    s_add_u32 s77, s77, 1
    s_cmp_ge_u32 s77, 50000
    s_waitcnt vmcnt(0)
    s_cbranch_scc1 L_back_g1_28_0
    v_cmp_eq_u32 vcc, -1, v96
    s_cbranch_vccnz L_retry_g1_28_0
    s_branch L_back_g1_28_0
L_retry_g1_29_0:
    s_add_u32 s4, s8, 63488
    buffer_load_dwordx4 v[104:107], v7, s[40:43], s4 offen sc1
    s_add_u32 s77, s77, 1
    s_cmp_ge_u32 s77, 50000
    s_waitcnt vmcnt(0)
    s_cbranch_scc1 L_back_g1_29_0
    v_cmp_eq_u32 vcc, -1, v104
    s_cbranch_vccnz L_retry_g1_29_0
    s_branch L_back_g1_29_0
L_retry_g1_30_0:
    s_add_u32 s4, s8, 28672
    buffer_load_dwordx4 v[112:115], v7, s[40:43], s4 offen sc1
    s_add_u32 s77, s77, 1
    s_cmp_ge_u32 s77, 50000
    s_waitcnt vmcnt(0)
    s_cbranch_scc1 L_back_g1_30_0
    v_cmp_eq_u32 vcc, -1, v112
    s_cbranch_vccnz L_retry_g1_30_0
    s_branch L_back_g1_30_0
L_retry_g1_31_0:
    s_add_u32 s4, s8, 30720
    buffer_load_dwordx4 v[120:123], v7, s[40:43], s4 offen sc1
    s_add_u32 s77, s77, 1
    s_cmp_ge_u32 s77, 50000
    s_waitcnt vmcnt(0)
    s_cbranch_scc1 L_back_g1_31_0
    v_cmp_eq_u32 vcc, -1, v120
    s_cbranch_vccnz L_retry_g1_31_0
    s_branch L_back_g1_31_0
L_retry_g2_0_0:
    s_add_u32 s4, s68, 0
    buffer_load_dwordx4 v[96:99], v7, s[40:43], s4 offen sc1
    buffer_load_dwordx4 v[100:103], v8, s[40:43], s4 offen sc1
    s_add_u32 s77, s77, 1
    s_cmp_ge_u32 s77, 50000
    s_waitcnt vmcnt(0)
    s_cbranch_scc1 L_back_g2_0_0
    v_max_u32 v20, v96, v100
    v_cmp_eq_u32 vcc, -1, v20
    s_cbranch_vccnz L_retry_g2_0_0
    s_branch L_back_g2_0_0
L_retry_g2_1_0:
    s_add_u32 s4, s68, 2048
    buffer_load_dwordx4 v[104:107], v7, s[40:43], s4 offen sc1
    buffer_load_dwordx4 v[108:111], v8, s[40:43], s4 offen sc1
    s_add_u32 s77, s77, 1
    s_cmp_ge_u32 s77, 50000
    s_waitcnt vmcnt(0)
    s_cbranch_scc1 L_back_g2_1_0
    v_max_u32 v20, v104, v108
    v_cmp_eq_u32 vcc, -1, v20
    s_cbranch_vccnz L_retry_g2_1_0
    s_branch L_back_g2_1_0
L_retry_g2_2_0:
    s_add_u32 s4, s68, 4096
    buffer_load_dwordx4 v[112:115], v7, s[40:43], s4 offen sc1
    buffer_load_dwordx4 v[116:119], v8, s[40:43], s4 offen sc1
    s_add_u32 s77, s77, 1
    s_cmp_ge_u32 s77, 50000
    s_waitcnt vmcnt(0)
    s_cbranch_scc1 L_back_g2_2_0
    v_max_u32 v20, v112, v116
    v_cmp_eq_u32 vcc, -1, v20
    s_cbranch_vccnz L_retry_g2_2_0
    s_branch L_back_g2_2_0
L_retry_g2_3_0:
    s_add_u32 s4, s68, 6144
    buffer_load_dwordx4 v[120:123], v7, s[40:43], s4 offen sc1
    buffer_load_dwordx4 v[124:127], v8, s[40:43], s4 offen sc1
    s_add_u32 s77, s77, 1
    s_cmp_ge_u32 s77, 50000
    s_waitcnt vmcnt(0)
    s_cbranch_scc1 L_back_g2_3_0
    v_max_u32 v20, v120, v124
    v_cmp_eq_u32 vcc, -1, v20
    s_cbranch_vccnz L_retry_g2_3_0
    s_branch L_back_g2_3_0
L_retry_g2_4_0:
    s_add_u32 s4, s68, 8192
    buffer_load_dwordx4 v[128:131], v7, s[40:43], s4 offen sc1
    buffer_load_dwordx4 v[132:135], v8, s[40:43], s4 offen sc1
    s_add_u32 s77, s77, 1
    s_cmp_ge_u32 s77, 50000
    s_waitcnt vmcnt(0)
    s_cbranch_scc1 L_back_g2_4_0
    v_max_u32 v20, v128, v132
    v_cmp_eq_u32 vcc, -1, v20
    s_cbranch_vccnz L_retry_g2_4_0
    s_branch L_back_g2_4_0
L_retry_g2_5_0:
    s_add_u32 s4, s68, 10240
    buffer_load_dwordx4 v[136:139], v7, s[40:43], s4 offen sc1
    buffer_load_dwordx4 v[140:143], v8, s[40:43], s4 offen sc1
    s_add_u32 s77, s77, 1
    s_cmp_ge_u32 s77, 50000
    s_waitcnt vmcnt(0)
    s_cbranch_scc1 L_back_g2_5_0
    v_max_u32 v20, v136, v140
    v_cmp_eq_u32 vcc, -1, v20
    s_cbranch_vccnz L_retry_g2_5_0
    s_branch L_back_g2_5_0
L_retry_g2_6_0:
    s_add_u32 s4, s68, 12288
    buffer_load_dwordx4 v[144:147], v7, s[40:43], s4 offen sc1
    buffer_load_dwordx4 v[148:151], v8, s[40:43], s4 offen sc1
    s_add_u32 s77, s77, 1
    s_cmp_ge_u32 s77, 50000
    s_waitcnt vmcnt(0)
    s_cbranch_scc1 L_back_g2_6_0
    v_max_u32 v20, v144, v148
    v_cmp_eq_u32 vcc, -1, v20
    s_cbranch_vccnz L_retry_g2_6_0
    s_branch L_back_g2_6_0
L_retry_g2_7_0:
    s_add_u32 s4, s68, 14336
    buffer_load_dwordx4 v[152:155], v7, s[40:43], s4 offen sc1
    buffer_load_dwordx4 v[156:159], v8, s[40:43], s4 offen sc1
    s_add_u32 s77, s77, 1
    s_cmp_ge_u32 s77, 50000
    s_waitcnt vmcnt(0)
    s_cbranch_scc1 L_back_g2_7_0
    v_max_u32 v20, v152, v156
    v_cmp_eq_u32 vcc, -1, v20
    s_cbranch_vccnz L_retry_g2_7_0
    s_branch L_back_g2_7_0
L_retry_g2_8_0:
    s_add_u32 s4, s68, 16384
    buffer_load_dwordx4 v[160:163], v7, s[40:43], s4 offen sc1
    buffer_load_dwordx4 v[164:167], v8, s[40:43], s4 offen sc1
    s_add_u32 s77, s77, 1
    s_cmp_ge_u32 s77, 50000
    s_waitcnt vmcnt(0)
    s_cbranch_scc1 L_back_g2_8_0
    v_max_u32 v20, v160, v164
    v_cmp_eq_u32 vcc, -1, v20
    s_cbranch_vccnz L_retry_g2_8_0
    s_branch L_back_g2_8_0
L_retry_g2_9_0:
    s_add_u32 s4, s68, 18432
    buffer_load_dwordx4 v[168:171], v7, s[40:43], s4 offen sc1
    buffer_load_dwordx4 v[172:175], v8, s[40:43], s4 offen sc1
    s_add_u32 s77, s77, 1
    s_cmp_ge_u32 s77, 50000
    s_waitcnt vmcnt(0)
    s_cbranch_scc1 L_back_g2_9_0
    v_max_u32 v20, v168, v172
    v_cmp_eq_u32 vcc, -1, v20
    s_cbranch_vccnz L_retry_g2_9_0
    s_branch L_back_g2_9_0
L_retry_g2_10_0:
    s_add_u32 s4, s68, 20480
    buffer_load_dwordx4 v[176:179], v7, s[40:43], s4 offen sc1
    buffer_load_dwordx4 v[180:183], v8, s[40:43], s4 offen sc1
    s_add_u32 s77, s77, 1
    s_cmp_ge_u32 s77, 50000
    s_waitcnt vmcnt(0)
    s_cbranch_scc1 L_back_g2_10_0
    v_max_u32 v20, v176, v180
    v_cmp_eq_u32 vcc, -1, v20
    s_cbranch_vccnz L_retry_g2_10_0
    s_branch L_back_g2_10_0
L_retry_g2_11_0:
    s_add_u32 s4, s68, 22528
    buffer_load_dwordx4 v[184:187], v7, s[40:43], s4 offen sc1
    buffer_load_dwordx4 v[188:191], v8, s[40:43], s4 offen sc1
    s_add_u32 s77, s77, 1
    s_cmp_ge_u32 s77, 50000
    s_waitcnt vmcnt(0)
    s_cbranch_scc1 L_back_g2_11_0
    v_max_u32 v20, v184, v188
    v_cmp_eq_u32 vcc, -1, v20
    s_cbranch_vccnz L_retry_g2_11_0
    s_branch L_back_g2_11_0
L_retry_g2_12_0:
    s_add_u32 s4, s68, 24576
    buffer_load_dwordx4 v[192:195], v7, s[40:43], s4 offen sc1
    buffer_load_dwordx4 v[196:199], v8, s[40:43], s4 offen sc1
    s_add_u32 s77, s77, 1
    s_cmp_ge_u32 s77, 50000
    s_waitcnt vmcnt(0)
    s_cbranch_scc1 L_back_g2_12_0
    v_max_u32 v20, v192, v196
    v_cmp_eq_u32 vcc, -1, v20
    s_cbranch_vccnz L_retry_g2_12_0
    s_branch L_back_g2_12_0
L_retry_g2_13_0:
    s_add_u32 s4, s68, 26624
    buffer_load_dwordx4 v[96:99], v7, s[40:43], s4 offen sc1
    buffer_load_dwordx4 v[100:103], v8, s[40:43], s4 offen sc1
    s_add_u32 s77, s77, 1
    s_cmp_ge_u32 s77, 50000
    s_waitcnt vmcnt(0)
    s_cbranch_scc1 L_back_g2_13_0
    v_max_u32 v20, v96, v100
    v_cmp_eq_u32 vcc, -1, v20
    s_cbranch_vccnz L_retry_g2_13_0
    s_branch L_back_g2_13_0
L_retry_g2_14_0:
    s_add_u32 s4, s69, 0
    buffer_load_dwordx4 v[104:107], v7, s[40:43], s4 offen sc1
    buffer_load_dwordx4 v[108:111], v8, s[40:43], s4 offen sc1
    s_add_u32 s77, s77, 1
    s_cmp_ge_u32 s77, 50000
    s_waitcnt vmcnt(0)
    s_cbranch_scc1 L_back_g2_14_0
    v_max_u32 v20, v104, v108
    v_cmp_eq_u32 vcc, -1, v20
    s_cbranch_vccnz L_retry_g2_14_0
    s_branch L_back_g2_14_0
L_retry_g2_15_0:
    s_add_u32 s4, s69, 2048
    buffer_load_dwordx4 v[112:115], v7, s[40:43], s4 offen sc1
    buffer_load_dwordx4 v[116:119], v8, s[40:43], s4 offen sc1
    s_add_u32 s77, s77, 1
    s_cmp_ge_u32 s77, 50000
    s_waitcnt vmcnt(0)
    s_cbranch_scc1 L_back_g2_15_0
    v_max_u32 v20, v112, v116
    v_cmp_eq_u32 vcc, -1, v20
    s_cbranch_vccnz L_retry_g2_15_0
    s_branch L_back_g2_15_0
L_retry_g2_16_0:
    s_add_u32 s4, s69, 4096
    buffer_load_dwordx4 v[120:123], v7, s[40:43], s4 offen sc1
    buffer_load_dwordx4 v[124:127], v8, s[40:43], s4 offen sc1
    s_add_u32 s77, s77, 1
    s_cmp_ge_u32 s77, 50000
    s_waitcnt vmcnt(0)
    s_cbranch_scc1 L_back_g2_16_0
    v_max_u32 v20, v120, v124
    v_cmp_eq_u32 vcc, -1, v20
    s_cbranch_vccnz L_retry_g2_16_0
    s_branch L_back_g2_16_0
L_retry_g2_17_0:
    s_add_u32 s4, s69, 6144
    buffer_load_dwordx4 v[128:131], v7, s[40:43], s4 offen sc1
    buffer_load_dwordx4 v[132:135], v8, s[40:43], s4 offen sc1
    s_add_u32 s77, s77, 1
    s_cmp_ge_u32 s77, 50000
    s_waitcnt vmcnt(0)
    s_cbranch_scc1 L_back_g2_17_0
    v_max_u32 v20, v128, v132
    v_cmp_eq_u32 vcc, -1, v20
    s_cbranch_vccnz L_retry_g2_17_0
    s_branch L_back_g2_17_0
L_retry_g2_18_0:
    s_add_u32 s4, s69, 8192
    buffer_load_dwordx4 v[136:139], v7, s[40:43], s4 offen sc1
    buffer_load_dwordx4 v[140:143], v8, s[40:43], s4 offen sc1
    s_add_u32 s77, s77, 1
    s_cmp_ge_u32 s77, 50000
    s_waitcnt vmcnt(0)
    s_cbranch_scc1 L_back_g2_18_0
    v_max_u32 v20, v136, v140
    v_cmp_eq_u32 vcc, -1, v20
    s_cbranch_vccnz L_retry_g2_18_0
    s_branch L_back_g2_18_0
L_retry_g2_19_0:
    s_add_u32 s4, s69, 10240
    buffer_load_dwordx4 v[144:147], v7, s[40:43], s4 offen sc1
    buffer_load_dwordx4 v[148:151], v8, s[40:43], s4 offen sc1
    s_add_u32 s77, s77, 1
    s_cmp_ge_u32 s77, 50000
    s_waitcnt vmcnt(0)
    s_cbranch_scc1 L_back_g2_19_0
    v_max_u32 v20, v144, v148
    v_cmp_eq_u32 vcc, -1, v20
    s_cbranch_vccnz L_retry_g2_19_0
    s_branch L_back_g2_19_0
L_retry_g2_20_0:
    s_add_u32 s4, s69, 12288
    buffer_load_dwordx4 v[152:155], v7, s[40:43], s4 offen sc1
    buffer_load_dwordx4 v[156:159], v8, s[40:43], s4 offen sc1
    s_add_u32 s77, s77, 1
    s_cmp_ge_u32 s77, 50000
    s_waitcnt vmcnt(0)
    s_cbranch_scc1 L_back_g2_20_0
    v_max_u32 v20, v152, v156
    v_cmp_eq_u32 vcc, -1, v20
    s_cbranch_vccnz L_retry_g2_20_0
    s_branch L_back_g2_20_0
L_retry_g2_21_0:
    s_add_u32 s4, s69, 14336
    buffer_load_dwordx4 v[160:163], v7, s[40:43], s4 offen sc1
    buffer_load_dwordx4 v[164:167], v8, s[40:43], s4 offen sc1
    s_add_u32 s77, s77, 1
    s_cmp_ge_u32 s77, 50000
    s_waitcnt vmcnt(0)
    s_cbranch_scc1 L_back_g2_21_0
    v_max_u32 v20, v160, v164
    v_cmp_eq_u32 vcc, -1, v20
    s_cbranch_vccnz L_retry_g2_21_0
    s_branch L_back_g2_21_0
L_retry_g2_22_1:
    s_add_u32 s4, s69, 16384
    buffer_load_dwordx4 v[172:175], v8, s[40:43], s4 offen sc1
    s_add_u32 s77, s77, 1
    s_cmp_ge_u32 s77, 50000
    s_waitcnt vmcnt(0)
    s_cbranch_scc1 L_back_g2_22_1
    v_cmp_eq_u32 vcc, -1, v172
    s_cbranch_vccnz L_retry_g2_22_1
    s_branch L_back_g2_22_1
L_retry_g2_23_1:
    s_add_u32 s4, s69, 18432
    buffer_load_dwordx4 v[180:183], v8, s[40:43], s4 offen sc1
    s_add_u32 s77, s77, 1
    s_cmp_ge_u32 s77, 50000
    s_waitcnt vmcnt(0)
    s_cbranch_scc1 L_back_g2_23_1
    v_cmp_eq_u32 vcc, -1, v180
    s_cbranch_vccnz L_retry_g2_23_1
    s_branch L_back_g2_23_1
L_retry_g2_24_1:
    s_add_u32 s4, s69, 20480
    buffer_load_dwordx4 v[188:191], v8, s[40:43], s4 offen sc1
    s_add_u32 s77, s77, 1
    s_cmp_ge_u32 s77, 50000
    s_waitcnt vmcnt(0)
    s_cbranch_scc1 L_back_g2_24_1
    v_cmp_eq_u32 vcc, -1, v188
    s_cbranch_vccnz L_retry_g2_24_1
    s_branch L_back_g2_24_1
L_retry_g2_25_1:
    s_add_u32 s4, s69, 22528
    buffer_load_dwordx4 v[196:199], v8, s[40:43], s4 offen sc1
    s_add_u32 s77, s77, 1
    s_cmp_ge_u32 s77, 50000
    s_waitcnt vmcnt(0)
    s_cbranch_scc1 L_back_g2_25_1
    v_cmp_eq_u32 vcc, -1, v196
    s_cbranch_vccnz L_retry_g2_25_1
    s_branch L_back_g2_25_1
L_retry_g2_26_1:
    s_add_u32 s4, s69, 24576
    buffer_load_dwordx4 v[100:103], v8, s[40:43], s4 offen sc1
    s_add_u32 s77, s77, 1
    s_cmp_ge_u32 s77, 50000
    s_waitcnt vmcnt(0)
    s_cbranch_scc1 L_back_g2_26_1
    v_cmp_eq_u32 vcc, -1, v100
    s_cbranch_vccnz L_retry_g2_26_1
    s_branch L_back_g2_26_1
L_retry_g2_27_1:
    s_add_u32 s4, s69, 26624
    buffer_load_dwordx4 v[108:111], v8, s[40:43], s4 offen sc1
    s_add_u32 s77, s77, 1
    s_cmp_ge_u32 s77, 50000
    s_waitcnt vmcnt(0)
    s_cbranch_scc1 L_back_g2_27_1
    v_cmp_eq_u32 vcc, -1, v108
    s_cbranch_vccnz L_retry_g2_27_1
    s_branch L_back_g2_27_1
L_retry_g2_22_0:
    s_add_u32 s4, s69, 16384
    buffer_load_dwordx4 v[168:171], v7, s[40:43], s4 offen sc1
    s_add_u32 s77, s77, 1
    s_cmp_ge_u32 s77, 50000
    s_waitcnt vmcnt(0)
    s_cbranch_scc1 L_back_g2_22_0
    v_cmp_eq_u32 vcc, -1, v168
    s_cbranch_vccnz L_retry_g2_22_0
    s_branch L_back_g2_22_0
L_retry_g2_23_0:
    s_add_u32 s4, s69, 18432
    buffer_load_dwordx4 v[176:179], v7, s[40:43], s4 offen sc1
    s_add_u32 s77, s77, 1
    s_cmp_ge_u32 s77, 50000
    s_waitcnt vmcnt(0)
    s_cbranch_scc1 L_back_g2_23_0
    v_cmp_eq_u32 vcc, -1, v176
    s_cbranch_vccnz L_retry_g2_23_0
    s_branch L_back_g2_23_0
L_retry_g2_24_0:
    s_add_u32 s4, s69, 20480
    buffer_load_dwordx4 v[184:187], v7, s[40:43], s4 offen sc1
    s_add_u32 s77, s77, 1
    s_cmp_ge_u32 s77, 50000
    s_waitcnt vmcnt(0)
    s_cbranch_scc1 L_back_g2_24_0
    v_cmp_eq_u32 vcc, -1, v184
    s_cbranch_vccnz L_retry_g2_24_0
    s_branch L_back_g2_24_0
L_retry_g2_25_0:
    s_add_u32 s4, s69, 22528
    buffer_load_dwordx4 v[192:195], v7, s[40:43], s4 offen sc1
    s_add_u32 s77, s77, 1
    s_cmp_ge_u32 s77, 50000
    s_waitcnt vmcnt(0)
    s_cbranch_scc1 L_back_g2_25_0
    v_cmp_eq_u32 vcc, -1, v192
    s_cbranch_vccnz L_retry_g2_25_0
    s_branch L_back_g2_25_0
L_retry_g2_26_0:
    s_add_u32 s4, s69, 24576
    buffer_load_dwordx4 v[96:99], v7, s[40:43], s4 offen sc1
    s_add_u32 s77, s77, 1
    s_cmp_ge_u32 s77, 50000
    s_waitcnt vmcnt(0)
    s_cbranch_scc1 L_back_g2_26_0
    v_cmp_eq_u32 vcc, -1, v96
    s_cbranch_vccnz L_retry_g2_26_0
    s_branch L_back_g2_26_0
L_retry_g2_27_0:
    s_add_u32 s4, s69, 26624
    buffer_load_dwordx4 v[104:107], v7, s[40:43], s4 offen sc1
    s_add_u32 s77, s77, 1
    s_cmp_ge_u32 s77, 50000
    s_waitcnt vmcnt(0)
    s_cbranch_scc1 L_back_g2_27_0
    v_cmp_eq_u32 vcc, -1, v104
    s_cbranch_vccnz L_retry_g2_27_0
    s_branch L_back_g2_27_0
L_exit:
    s_endpgm
.section .rodata,"a"
.p2align 6
.amdhsa_kernel sequential_preLN__sliding_local_dilated__mixer_token_mlp__prompt_kernel
  .amdhsa_next_free_vgpr 512
  .amdhsa_next_free_sgpr 102
  .amdhsa_accum_offset 256
  .amdhsa_group_segment_fixed_size 0
  .amdhsa_kernarg_size 88
  .amdhsa_user_sgpr_count 2
  .amdhsa_user_sgpr_kernarg_segment_ptr 1
  .amdhsa_system_sgpr_workgroup_id_x 1
.end_amdhsa_kernel
```
